```python
import torch

def _softmax(x, axis=-1):
    return torch.softmax(x, dim=axis)

def _gelu(x):
    return torch.nn.functional.gelu(x, approximate='tanh')

def _silu(x):
    return torch.nn.functional.silu(x)

def _sigmoid(x):
    return torch.sigmoid(x)

def _layernorm(x, axis=-1, eps=1e-05):
    m = x.mean(dim=axis, keepdim=True)
    v = x.var(dim=axis, keepdim=True, unbiased=False)
    return (x - m) / torch.sqrt(v + eps)

def _scatter_add(tgt, idx, src, axis=0):
    return tgt.clone().index_add_(axis, idx, src)

def _segment_sum(src, seg, n):
    out = torch.zeros((n,) + src.shape[1:], dtype=src.dtype)
    return out.index_add_(0, seg, src)

def _pad(x, pw):
    flat = tuple((v for pair in reversed(pw) for v in pair))
    return torch.nn.functional.pad(x, flat)
kernel_name = 'adaLN_cond__ssm_conv_h3__glu_gated_swiglu__prompt'

def setup_inputs():

    _w = lambda a: (lambda t: t.to(torch.bfloat16) if t.is_floating_point() else t)(torch.as_tensor(a))

    def _A_setup():
        B, S, D = (1, 2048, 576)
        ks = 4
        return {'q': _w((lambda *s: torch.randn(*s, dtype=torch.bfloat16) * 0.05)(B, S, D)), 'k': _w((lambda *s: torch.randn(*s, dtype=torch.bfloat16) * 0.8)(B, S, D)), 'v': _w((lambda *s: torch.randn(*s, dtype=torch.bfloat16) * 0.8)(B, S, D)), 'shift_k': _w((lambda *s: torch.randn(*s, dtype=torch.bfloat16) * 0.8)(D, ks) * 0.5), 'ssm_k': _w((lambda *s: torch.randn(*s, dtype=torch.bfloat16) * 0.8)(D, S) * (1.0 / S ** 0.5)), 'ssm_D': _w((lambda *s: torch.randn(*s, dtype=torch.bfloat16) * 0.8)(D))}
    _A_in = _A_setup()

    def _B_setup():
        B, S, D, F = (1, 2048, 576, 4608)
        return {'x': _w((lambda *s: torch.randn(*s, dtype=torch.bfloat16) * 0.05)(B, S, D)), 'w1': _w((lambda *s: torch.randn(*s, dtype=torch.bfloat16) * 0.8)(D, F) * (2.0 / D) ** 0.5), 'w3': _w((lambda *s: torch.randn(*s, dtype=torch.bfloat16) * 0.8)(D, F) * (2.0 / D) ** 0.5), 'w2': _w((lambda *s: torch.randn(*s, dtype=torch.bfloat16) * 0.8)(F, D) * (2.0 / F) ** 0.5)}
    _B_in = _B_setup()
    return {'A_q': _A_in['q'], 'A_k': _A_in['k'], 'A_v': _A_in['v'], 'A_shift_k': _A_in['shift_k'], 'A_ssm_k': _A_in['ssm_k'], 'A_ssm_D': _A_in['ssm_D'], 'B_x': _B_in['x'], 'B_w1': _B_in['w1'], 'B_w3': _B_in['w3'], 'B_w2': _B_in['w2'], 'c': _w((lambda *s: torch.randn(*s, dtype=torch.bfloat16) * 0.2)(1, 576) * 8.0), 'w_mod': _w((lambda *s: torch.randn(*s, dtype=torch.bfloat16) * 0.2)(576, 6 * 576) * 576 ** (-0.5) * 8.0)}

def reference(A_q, A_k, A_v, A_shift_k, A_ssm_k, A_ssm_D, B_x, B_w1, B_w3, B_w2, c, w_mod):

    def _A_ref(q, k, v, shift_k, ssm_k, ssm_D):
        B, S, D = q.shape
        ks = shift_k.shape[-1]
        k_pad = _pad(k, ((0, 0), (ks - 1, 0), (0, 0)))
        k_shift = torch.zeros_like(k)
        for t in range(ks):
            k_shift = k_shift + k_pad[:, t:t + S, :] * shift_k[:, ks - 1 - t][None, None, :]
        kv = k_shift * v
        L = 2 * S
        kv_pad = _pad(kv, ((0, 0), (0, S), (0, 0)))
        kf_pad = _pad(ssm_k, ((0, 0), (0, S)))
        kv_f = (lambda x, axes=(-2, -1): torch.fft.rfft2(x.float(), dim=axes))(kv_pad[:, None, :, :], axes=(1, 2))
        kf_f = (lambda x, axes=(-2, -1): torch.fft.rfft2(x.float(), dim=axes))(kf_pad[:, None, :], axes=(1, 2))
        kf_f = (lambda x, *d: x.permute(*d))(kf_f, 1, 2, 0)
        y_f = kv_f * kf_f[None, :, :, :]
        y = (lambda x, s, axes=(-2, -1): torch.fft.irfft2(x, s=s, dim=axes).to(torch.bfloat16))(y_f, (1, L), axes=(1, 2))[:, 0, :S, :]
        y = y + kv * ssm_D[None, None, :]
        return q * y

    def _B_ref(x, w1, w3, w2):
        gate = torch.einsum('bsd,df->bsf', x, w1)
        up = torch.einsum('bsd,df->bsf', x, w3)
        h = _silu(gate) * up
        out = torch.einsum('bsf,fd->bsd', h, w2)
        return out
    x = A_q
    mod = (_silu(c) @ w_mod).reshape(c.shape[0], 6, 1, -1)
    sa, ca, ga, sb, cb, gb = (mod[:, 0].clone(), mod[:, 1].clone(), mod[:, 2].clone(), mod[:, 3].clone(), mod[:, 4].clone(), mod[:, 5].clone())
    h = _layernorm(x, axis=-1) * (1 + ca) + sa
    x = x + ga * _A_ref(h, A_k, A_v, A_shift_k, A_ssm_k, A_ssm_D)
    h = _layernorm(x, axis=-1) * (1 + cb) + sb
    x = x + gb * _B_ref(h, B_w1, B_w3, B_w2)
    return x
```

```asm
; @launch kernel=k1_kernel grid=(382,1,1) block=(256,1,1) lds=8768
; @launch kernel=m_kernel grid=(256,1,1) block=(256,1,1) lds=163840
.amdgcn_target "amdgcn-amd-amdhsa--gfx950"
.text
.globl k1_kernel
.p2align 8
.type k1_kernel,@function
k1_kernel:
  s_cmp_ge_u32 s2, 382
  s_cbranch_scc1 end_k1_kernel
  s_cmp_ge_u32 s2, 342
  s_cbranch_scc1 keepid_k1_kernel
  s_sub_u32 s3, s2, 54
  s_add_u32 s2, s2, 288
  s_cmp_ge_u32 s2, 342
  s_cselect_b32 s2, s3, s2
keepid_k1_kernel:
  s_cmp_ge_u32 s2, 342
  s_cbranch_scc1 pf_k1_kernel
  s_cmp_ge_u32 s2, 288
  s_cbranch_scc1 mod_k1_kernel
  s_load_dwordx4 s[4:7], s[0:1], 8
  s_load_dwordx2 s[8:9], s[0:1], 24
  s_load_dwordx2 s[10:11], s[0:1], 112
  s_mul_hi_u32 s12, s2, 0x1c71c71d
  s_mul_i32 s13, s12, 9
  s_sub_u32 s13, s2, s13
  v_and_b32 v1, 7, v0
  v_lshrrev_b32 v2, 3, v0
  s_lshl_b32 s14, s12, 6
  s_lshl_b32 s15, s13, 7
  v_lshlrev_b32 v3, 1, v2
  v_add_u32 v3, s14, v3
  s_movk_i32 s16, 1152
  v_mul_lo_u32 v4, v3, s16
  v_lshlrev_b32 v5, 4, v1
  v_add_u32 v5, s15, v5
  v_add_u32 v4, v4, v5
  v_subrev_u32 v6, 3456, v4
  v_subrev_u32 v7, 2304, v4
  v_subrev_u32 v8, 1152, v4
  v_lshlrev_b32 v9, 2, v5
  s_waitcnt lgkmcnt(0)
  s_mov_b32 s16, s4
  s_mov_b32 s17, s5
  s_mov_b32 s18, 0x240000
  s_mov_b32 s19, 0x20000
  s_mov_b32 s20, s6
  s_mov_b32 s21, s7
  s_mov_b32 s22, 0x240000
  s_mov_b32 s23, 0x20000
  s_mov_b32 s24, s8
  s_mov_b32 s25, s9
  s_mov_b32 s26, 0x1200
  s_mov_b32 s27, 0x20000
  s_mov_b32 s28, s10
  s_mov_b32 s29, s11
  s_mov_b32 s30, 0x240000
  s_mov_b32 s31, 0x20000
  buffer_load_dwordx4 v[12:15], v6, s[16:19], 0 offen
  buffer_load_dwordx4 v[16:19], v7, s[16:19], 0 offen
  buffer_load_dwordx4 v[20:23], v8, s[16:19], 0 offen
  buffer_load_dwordx4 v[24:27], v4, s[16:19], 0 offen
  buffer_load_dwordx4 v[28:31], v4, s[16:19], 0 offen offset:1152
  buffer_load_dwordx4 v[32:35], v4, s[20:23], 0 offen
  buffer_load_dwordx4 v[36:39], v4, s[20:23], 0 offen offset:1152
  buffer_load_dwordx4 v[40:43], v9, s[24:27], 0 offen offset:0
  buffer_load_dwordx4 v[44:47], v9, s[24:27], 0 offen offset:16
  buffer_load_dwordx4 v[48:51], v9, s[24:27], 0 offen offset:32
  buffer_load_dwordx4 v[52:55], v9, s[24:27], 0 offen offset:48
  v_mul_u32_u24 v10, 1088, v1
  v_sub_u32 v11, 31, v2
  v_lshlrev_b32 v11, 2, v11
  v_add_u32 v10, v10, v11
  s_waitcnt vmcnt(0)
  v_lshlrev_b32 v56, 16, v40
  v_and_b32 v57, 0xffff0000, v40
  v_lshlrev_b32 v58, 16, v41
  v_and_b32 v59, 0xffff0000, v41
  v_lshlrev_b32 v60, 16, v12
  v_lshlrev_b32 v61, 16, v16
  v_lshlrev_b32 v62, 16, v20
  v_lshlrev_b32 v63, 16, v24
  v_lshlrev_b32 v64, 16, v28
  v_lshlrev_b32 v65, 16, v32
  v_lshlrev_b32 v66, 16, v36
  v_mul_f32 v67, v60, v59
  v_mul_f32 v68, v61, v59
  v_fmac_f32 v67, v61, v58
  v_fmac_f32 v68, v62, v58
  v_fmac_f32 v67, v62, v57
  v_fmac_f32 v68, v63, v57
  v_fmac_f32 v67, v63, v56
  v_fmac_f32 v68, v64, v56
  v_mul_f32 v67, v67, v65
  v_mul_f32 v68, v68, v66
  v_cvt_pk_bf16_f32 v70, v68, v67
  ds_write_b32 v10, v70 offset:0
  v_lshlrev_b32 v56, 16, v42
  v_and_b32 v57, 0xffff0000, v42
  v_lshlrev_b32 v58, 16, v43
  v_and_b32 v59, 0xffff0000, v43
  v_and_b32 v60, 0xffff0000, v12
  v_and_b32 v61, 0xffff0000, v16
  v_and_b32 v62, 0xffff0000, v20
  v_and_b32 v63, 0xffff0000, v24
  v_and_b32 v64, 0xffff0000, v28
  v_and_b32 v65, 0xffff0000, v32
  v_and_b32 v66, 0xffff0000, v36
  v_mul_f32 v67, v60, v59
  v_mul_f32 v68, v61, v59
  v_fmac_f32 v67, v61, v58
  v_fmac_f32 v68, v62, v58
  v_fmac_f32 v67, v62, v57
  v_fmac_f32 v68, v63, v57
  v_fmac_f32 v67, v63, v56
  v_fmac_f32 v68, v64, v56
  v_mul_f32 v67, v67, v65
  v_mul_f32 v68, v68, v66
  v_cvt_pk_bf16_f32 v71, v68, v67
  ds_write_b32 v10, v71 offset:136
  v_lshlrev_b32 v56, 16, v44
  v_and_b32 v57, 0xffff0000, v44
  v_lshlrev_b32 v58, 16, v45
  v_and_b32 v59, 0xffff0000, v45
  v_lshlrev_b32 v60, 16, v13
  v_lshlrev_b32 v61, 16, v17
  v_lshlrev_b32 v62, 16, v21
  v_lshlrev_b32 v63, 16, v25
  v_lshlrev_b32 v64, 16, v29
  v_lshlrev_b32 v65, 16, v33
  v_lshlrev_b32 v66, 16, v37
  v_mul_f32 v67, v60, v59
  v_mul_f32 v68, v61, v59
  v_fmac_f32 v67, v61, v58
  v_fmac_f32 v68, v62, v58
  v_fmac_f32 v67, v62, v57
  v_fmac_f32 v68, v63, v57
  v_fmac_f32 v67, v63, v56
  v_fmac_f32 v68, v64, v56
  v_mul_f32 v67, v67, v65
  v_mul_f32 v68, v68, v66
  v_cvt_pk_bf16_f32 v72, v68, v67
  ds_write_b32 v10, v72 offset:272
  v_lshlrev_b32 v56, 16, v46
  v_and_b32 v57, 0xffff0000, v46
  v_lshlrev_b32 v58, 16, v47
  v_and_b32 v59, 0xffff0000, v47
  v_and_b32 v60, 0xffff0000, v13
  v_and_b32 v61, 0xffff0000, v17
  v_and_b32 v62, 0xffff0000, v21
  v_and_b32 v63, 0xffff0000, v25
  v_and_b32 v64, 0xffff0000, v29
  v_and_b32 v65, 0xffff0000, v33
  v_and_b32 v66, 0xffff0000, v37
  v_mul_f32 v67, v60, v59
  v_mul_f32 v68, v61, v59
  v_fmac_f32 v67, v61, v58
  v_fmac_f32 v68, v62, v58
  v_fmac_f32 v67, v62, v57
  v_fmac_f32 v68, v63, v57
  v_fmac_f32 v67, v63, v56
  v_fmac_f32 v68, v64, v56
  v_mul_f32 v67, v67, v65
  v_mul_f32 v68, v68, v66
  v_cvt_pk_bf16_f32 v73, v68, v67
  ds_write_b32 v10, v73 offset:408
  v_lshlrev_b32 v56, 16, v48
  v_and_b32 v57, 0xffff0000, v48
  v_lshlrev_b32 v58, 16, v49
  v_and_b32 v59, 0xffff0000, v49
  v_lshlrev_b32 v60, 16, v14
  v_lshlrev_b32 v61, 16, v18
  v_lshlrev_b32 v62, 16, v22
  v_lshlrev_b32 v63, 16, v26
  v_lshlrev_b32 v64, 16, v30
  v_lshlrev_b32 v65, 16, v34
  v_lshlrev_b32 v66, 16, v38
  v_mul_f32 v67, v60, v59
  v_mul_f32 v68, v61, v59
  v_fmac_f32 v67, v61, v58
  v_fmac_f32 v68, v62, v58
  v_fmac_f32 v67, v62, v57
  v_fmac_f32 v68, v63, v57
  v_fmac_f32 v67, v63, v56
  v_fmac_f32 v68, v64, v56
  v_mul_f32 v67, v67, v65
  v_mul_f32 v68, v68, v66
  v_cvt_pk_bf16_f32 v74, v68, v67
  ds_write_b32 v10, v74 offset:544
  v_lshlrev_b32 v56, 16, v50
  v_and_b32 v57, 0xffff0000, v50
  v_lshlrev_b32 v58, 16, v51
  v_and_b32 v59, 0xffff0000, v51
  v_and_b32 v60, 0xffff0000, v14
  v_and_b32 v61, 0xffff0000, v18
  v_and_b32 v62, 0xffff0000, v22
  v_and_b32 v63, 0xffff0000, v26
  v_and_b32 v64, 0xffff0000, v30
  v_and_b32 v65, 0xffff0000, v34
  v_and_b32 v66, 0xffff0000, v38
  v_mul_f32 v67, v60, v59
  v_mul_f32 v68, v61, v59
  v_fmac_f32 v67, v61, v58
  v_fmac_f32 v68, v62, v58
  v_fmac_f32 v67, v62, v57
  v_fmac_f32 v68, v63, v57
  v_fmac_f32 v67, v63, v56
  v_fmac_f32 v68, v64, v56
  v_mul_f32 v67, v67, v65
  v_mul_f32 v68, v68, v66
  v_cvt_pk_bf16_f32 v75, v68, v67
  ds_write_b32 v10, v75 offset:680
  v_lshlrev_b32 v56, 16, v52
  v_and_b32 v57, 0xffff0000, v52
  v_lshlrev_b32 v58, 16, v53
  v_and_b32 v59, 0xffff0000, v53
  v_lshlrev_b32 v60, 16, v15
  v_lshlrev_b32 v61, 16, v19
  v_lshlrev_b32 v62, 16, v23
  v_lshlrev_b32 v63, 16, v27
  v_lshlrev_b32 v64, 16, v31
  v_lshlrev_b32 v65, 16, v35
  v_lshlrev_b32 v66, 16, v39
  v_mul_f32 v67, v60, v59
  v_mul_f32 v68, v61, v59
  v_fmac_f32 v67, v61, v58
  v_fmac_f32 v68, v62, v58
  v_fmac_f32 v67, v62, v57
  v_fmac_f32 v68, v63, v57
  v_fmac_f32 v67, v63, v56
  v_fmac_f32 v68, v64, v56
  v_mul_f32 v67, v67, v65
  v_mul_f32 v68, v68, v66
  v_cvt_pk_bf16_f32 v76, v68, v67
  ds_write_b32 v10, v76 offset:816
  v_lshlrev_b32 v56, 16, v54
  v_and_b32 v57, 0xffff0000, v54
  v_lshlrev_b32 v58, 16, v55
  v_and_b32 v59, 0xffff0000, v55
  v_and_b32 v60, 0xffff0000, v15
  v_and_b32 v61, 0xffff0000, v19
  v_and_b32 v62, 0xffff0000, v23
  v_and_b32 v63, 0xffff0000, v27
  v_and_b32 v64, 0xffff0000, v31
  v_and_b32 v65, 0xffff0000, v35
  v_and_b32 v66, 0xffff0000, v39
  v_mul_f32 v67, v60, v59
  v_mul_f32 v68, v61, v59
  v_fmac_f32 v67, v61, v58
  v_fmac_f32 v68, v62, v58
  v_fmac_f32 v67, v62, v57
  v_fmac_f32 v68, v63, v57
  v_fmac_f32 v67, v63, v56
  v_fmac_f32 v68, v64, v56
  v_mul_f32 v67, v67, v65
  v_mul_f32 v68, v68, v66
  v_cvt_pk_bf16_f32 v77, v68, v67
  ds_write_b32 v10, v77 offset:952
  s_waitcnt lgkmcnt(0)
  s_barrier
  v_mul_u32_u24 v11, 136, v2
  v_lshlrev_b32 v12, 4, v1
  v_add_u32 v11, v11, v12
  ds_read_b64 v[16:17], v11
  ds_read_b64 v[18:19], v11 offset:8
  ds_read_b64 v[20:21], v11 offset:4352
  ds_read_b64 v[22:23], v11 offset:4360
  s_lshl_b32 s32, s13, 18
  s_lshl_b32 s33, s14, 1
  s_sub_u32 s33, 3968, s33
  s_add_u32 s32, s32, s33
  v_lshlrev_b32 v13, 12, v2
  v_add_u32 v13, v13, v12
  v_add_u32 v13, s32, v13
  v_add_u32 v14, 0x20000, v13
  s_waitcnt lgkmcnt(2)
  buffer_store_dwordx4 v[16:19], v13, s[28:31], 0 offen
  s_waitcnt lgkmcnt(0)
  buffer_store_dwordx4 v[20:23], v14, s[28:31], 0 offen
  s_cmp_lg_u32 s2, 0
  s_cbranch_scc1 nocnt_k1_kernel
  s_add_u32 s32, s10, 0x904000
  s_addc_u32 s33, s11, 0
  s_mov_b32 s34, 0xc000
  s_mov_b32 s35, 0x20000
  v_lshlrev_b32 v13, 10, v0
  v_mov_b32 v14, 0
  buffer_store_dword v14, v13, s[32:35], 0 offen
  v_lshlrev_b32 v13, 8, v0
  v_add_u32 v13, 32768, v13
  buffer_store_dword v14, v13, s[32:35], 0 offen
  v_add_u32 v13, 128, v13
  buffer_store_dword v14, v13, s[32:35], 0 offen
  v_lshlrev_b32 v13, 7, v0
  v_add_u32 v13, 40960, v13
  buffer_store_dword v14, v13, s[32:35], 0 offen
  v_lshrrev_b32 v13, 1, v0
  v_lshlrev_b32 v13, 10, v13
  v_and_b32 v15, 1, v0
  v_lshl_add_u32 v13, v15, 8, v13
  v_add_u32 v13, 256, v13
  buffer_store_dword v14, v13, s[32:35], 0 offen
nocnt_k1_kernel:
  s_endpgm
mod_k1_kernel:
  s_load_dwordx4 s[4:7], s[0:1], 80
  s_load_dwordx2 s[10:11], s[0:1], 112
  s_sub_u32 s12, s2, 288
  v_and_b32 v1, 7, v0
  v_lshrrev_b32 v2, 3, v0
  v_lshlrev_b32 v3, 1, v0
  s_waitcnt lgkmcnt(0)
  s_mov_b32 s16, s4
  s_mov_b32 s17, s5
  s_mov_b32 s18, 0x480
  s_mov_b32 s19, 0x20000
  s_mov_b32 s20, s6
  s_mov_b32 s21, s7
  s_mov_b32 s22, 0x3cc000
  s_mov_b32 s23, 0x20000
  s_add_u32 s28, s10, 0x900000
  s_addc_u32 s29, s11, 0
  s_mov_b32 s30, 0x3600
  s_mov_b32 s31, 0x20000
  buffer_load_ushort v4, v3, s[16:19], 0 offen
  buffer_load_ushort v5, v3, s[16:19], 0 offen offset:512
  buffer_load_ushort v6, v3, s[16:19], 0 offen offset:1024
  v_mul_u32_u24 v7, 6912, v2
  v_lshlrev_b32 v8, 4, v1
  v_add_u32 v7, v7, v8
  s_lshl_b32 s13, s12, 7
  buffer_load_dwordx4 v[16:19], v7, s[20:23], s13 offen
  s_add_u32 s13, s13, 221184
  buffer_load_dwordx4 v[20:23], v7, s[20:23], s13 offen
  s_add_u32 s13, s13, 221184
  buffer_load_dwordx4 v[24:27], v7, s[20:23], s13 offen
  s_add_u32 s13, s13, 221184
  buffer_load_dwordx4 v[28:31], v7, s[20:23], s13 offen
  s_add_u32 s13, s13, 221184
  buffer_load_dwordx4 v[32:35], v7, s[20:23], s13 offen
  s_add_u32 s13, s13, 221184
  buffer_load_dwordx4 v[36:39], v7, s[20:23], s13 offen
  s_add_u32 s13, s13, 221184
  buffer_load_dwordx4 v[40:43], v7, s[20:23], s13 offen
  s_add_u32 s13, s13, 221184
  buffer_load_dwordx4 v[44:47], v7, s[20:23], s13 offen
  s_add_u32 s13, s13, 221184
  buffer_load_dwordx4 v[48:51], v7, s[20:23], s13 offen
  s_add_u32 s13, s13, 221184
  buffer_load_dwordx4 v[52:55], v7, s[20:23], s13 offen
  s_add_u32 s13, s13, 221184
  buffer_load_dwordx4 v[56:59], v7, s[20:23], s13 offen
  s_add_u32 s13, s13, 221184
  buffer_load_dwordx4 v[60:63], v7, s[20:23], s13 offen
  s_add_u32 s13, s13, 221184
  buffer_load_dwordx4 v[64:67], v7, s[20:23], s13 offen
  s_add_u32 s13, s13, 221184
  buffer_load_dwordx4 v[68:71], v7, s[20:23], s13 offen
  s_add_u32 s13, s13, 221184
  buffer_load_dwordx4 v[72:75], v7, s[20:23], s13 offen
  s_add_u32 s13, s13, 221184
  buffer_load_dwordx4 v[76:79], v7, s[20:23], s13 offen
  s_add_u32 s13, s13, 221184
  buffer_load_dwordx4 v[80:83], v7, s[20:23], s13 offen
  s_add_u32 s13, s13, 221184
  buffer_load_dwordx4 v[84:87], v7, s[20:23], s13 offen
  s_waitcnt vmcnt(18)
  v_lshlrev_b32 v4, 16, v4
  v_mul_f32 v9, 0xbfb8aa3b, v4
  v_exp_f32 v9, v9
  s_nop 0
  v_add_f32 v9, 1.0, v9
  v_rcp_f32 v9, v9
  s_nop 0
  v_mul_f32 v9, v4, v9
  v_cvt_pk_bf16_f32 v9, v9, v9
  v_lshlrev_b32 v4, 16, v9
  v_lshlrev_b32 v5, 16, v5
  v_mul_f32 v9, 0xbfb8aa3b, v5
  v_exp_f32 v9, v9
  s_nop 0
  v_add_f32 v9, 1.0, v9
  v_rcp_f32 v9, v9
  s_nop 0
  v_mul_f32 v9, v5, v9
  v_cvt_pk_bf16_f32 v9, v9, v9
  v_lshlrev_b32 v5, 16, v9
  v_lshlrev_b32 v6, 16, v6
  v_mul_f32 v9, 0xbfb8aa3b, v6
  v_exp_f32 v9, v9
  s_nop 0
  v_add_f32 v9, 1.0, v9
  v_rcp_f32 v9, v9
  s_nop 0
  v_mul_f32 v9, v6, v9
  v_cvt_pk_bf16_f32 v9, v9, v9
  v_lshlrev_b32 v6, 16, v9
  v_lshlrev_b32 v10, 2, v0
  ds_write_b32 v10, v4
  ds_write_b32 v10, v5 offset:1024
  ds_write_b32 v10, v6 offset:2048
  s_waitcnt lgkmcnt(0)
  s_barrier
  v_lshlrev_b32 v11, 2, v2
  ds_read_b32 v96, v11 offset:0
  ds_read_b32 v97, v11 offset:128
  ds_read_b32 v98, v11 offset:256
  ds_read_b32 v99, v11 offset:384
  ds_read_b32 v100, v11 offset:512
  ds_read_b32 v101, v11 offset:640
  ds_read_b32 v102, v11 offset:768
  ds_read_b32 v103, v11 offset:896
  ds_read_b32 v104, v11 offset:1024
  ds_read_b32 v105, v11 offset:1152
  ds_read_b32 v106, v11 offset:1280
  ds_read_b32 v107, v11 offset:1408
  ds_read_b32 v108, v11 offset:1536
  ds_read_b32 v109, v11 offset:1664
  ds_read_b32 v110, v11 offset:1792
  ds_read_b32 v111, v11 offset:1920
  ds_read_b32 v112, v11 offset:2048
  ds_read_b32 v113, v11 offset:2176
  v_mov_b32 v120, 0
  v_mov_b32 v121, 0
  v_mov_b32 v122, 0
  v_mov_b32 v123, 0
  v_mov_b32 v124, 0
  v_mov_b32 v125, 0
  v_mov_b32 v126, 0
  v_mov_b32 v127, 0
  s_waitcnt vmcnt(17) lgkmcnt(15)
  v_lshlrev_b32 v12, 16, v16
  v_fmac_f32 v120, v12, v96
  v_and_b32 v12, 0xffff0000, v16
  v_fmac_f32 v121, v12, v96
  v_lshlrev_b32 v12, 16, v17
  v_fmac_f32 v122, v12, v96
  v_and_b32 v12, 0xffff0000, v17
  v_fmac_f32 v123, v12, v96
  v_lshlrev_b32 v12, 16, v18
  v_fmac_f32 v124, v12, v96
  v_and_b32 v12, 0xffff0000, v18
  v_fmac_f32 v125, v12, v96
  v_lshlrev_b32 v12, 16, v19
  v_fmac_f32 v126, v12, v96
  v_and_b32 v12, 0xffff0000, v19
  v_fmac_f32 v127, v12, v96
  s_waitcnt vmcnt(16) lgkmcnt(15)
  v_lshlrev_b32 v12, 16, v20
  v_fmac_f32 v120, v12, v97
  v_and_b32 v12, 0xffff0000, v20
  v_fmac_f32 v121, v12, v97
  v_lshlrev_b32 v12, 16, v21
  v_fmac_f32 v122, v12, v97
  v_and_b32 v12, 0xffff0000, v21
  v_fmac_f32 v123, v12, v97
  v_lshlrev_b32 v12, 16, v22
  v_fmac_f32 v124, v12, v97
  v_and_b32 v12, 0xffff0000, v22
  v_fmac_f32 v125, v12, v97
  v_lshlrev_b32 v12, 16, v23
  v_fmac_f32 v126, v12, v97
  v_and_b32 v12, 0xffff0000, v23
  v_fmac_f32 v127, v12, v97
  s_waitcnt vmcnt(15) lgkmcnt(15)
  v_lshlrev_b32 v12, 16, v24
  v_fmac_f32 v120, v12, v98
  v_and_b32 v12, 0xffff0000, v24
  v_fmac_f32 v121, v12, v98
  v_lshlrev_b32 v12, 16, v25
  v_fmac_f32 v122, v12, v98
  v_and_b32 v12, 0xffff0000, v25
  v_fmac_f32 v123, v12, v98
  v_lshlrev_b32 v12, 16, v26
  v_fmac_f32 v124, v12, v98
  v_and_b32 v12, 0xffff0000, v26
  v_fmac_f32 v125, v12, v98
  v_lshlrev_b32 v12, 16, v27
  v_fmac_f32 v126, v12, v98
  v_and_b32 v12, 0xffff0000, v27
  v_fmac_f32 v127, v12, v98
  s_waitcnt vmcnt(14) lgkmcnt(14)
  v_lshlrev_b32 v12, 16, v28
  v_fmac_f32 v120, v12, v99
  v_and_b32 v12, 0xffff0000, v28
  v_fmac_f32 v121, v12, v99
  v_lshlrev_b32 v12, 16, v29
  v_fmac_f32 v122, v12, v99
  v_and_b32 v12, 0xffff0000, v29
  v_fmac_f32 v123, v12, v99
  v_lshlrev_b32 v12, 16, v30
  v_fmac_f32 v124, v12, v99
  v_and_b32 v12, 0xffff0000, v30
  v_fmac_f32 v125, v12, v99
  v_lshlrev_b32 v12, 16, v31
  v_fmac_f32 v126, v12, v99
  v_and_b32 v12, 0xffff0000, v31
  v_fmac_f32 v127, v12, v99
  s_waitcnt vmcnt(13) lgkmcnt(13)
  v_lshlrev_b32 v12, 16, v32
  v_fmac_f32 v120, v12, v100
  v_and_b32 v12, 0xffff0000, v32
  v_fmac_f32 v121, v12, v100
  v_lshlrev_b32 v12, 16, v33
  v_fmac_f32 v122, v12, v100
  v_and_b32 v12, 0xffff0000, v33
  v_fmac_f32 v123, v12, v100
  v_lshlrev_b32 v12, 16, v34
  v_fmac_f32 v124, v12, v100
  v_and_b32 v12, 0xffff0000, v34
  v_fmac_f32 v125, v12, v100
  v_lshlrev_b32 v12, 16, v35
  v_fmac_f32 v126, v12, v100
  v_and_b32 v12, 0xffff0000, v35
  v_fmac_f32 v127, v12, v100
  s_waitcnt vmcnt(12) lgkmcnt(12)
  v_lshlrev_b32 v12, 16, v36
  v_fmac_f32 v120, v12, v101
  v_and_b32 v12, 0xffff0000, v36
  v_fmac_f32 v121, v12, v101
  v_lshlrev_b32 v12, 16, v37
  v_fmac_f32 v122, v12, v101
  v_and_b32 v12, 0xffff0000, v37
  v_fmac_f32 v123, v12, v101
  v_lshlrev_b32 v12, 16, v38
  v_fmac_f32 v124, v12, v101
  v_and_b32 v12, 0xffff0000, v38
  v_fmac_f32 v125, v12, v101
  v_lshlrev_b32 v12, 16, v39
  v_fmac_f32 v126, v12, v101
  v_and_b32 v12, 0xffff0000, v39
  v_fmac_f32 v127, v12, v101
  s_waitcnt vmcnt(11) lgkmcnt(11)
  v_lshlrev_b32 v12, 16, v40
  v_fmac_f32 v120, v12, v102
  v_and_b32 v12, 0xffff0000, v40
  v_fmac_f32 v121, v12, v102
  v_lshlrev_b32 v12, 16, v41
  v_fmac_f32 v122, v12, v102
  v_and_b32 v12, 0xffff0000, v41
  v_fmac_f32 v123, v12, v102
  v_lshlrev_b32 v12, 16, v42
  v_fmac_f32 v124, v12, v102
  v_and_b32 v12, 0xffff0000, v42
  v_fmac_f32 v125, v12, v102
  v_lshlrev_b32 v12, 16, v43
  v_fmac_f32 v126, v12, v102
  v_and_b32 v12, 0xffff0000, v43
  v_fmac_f32 v127, v12, v102
  s_waitcnt vmcnt(10) lgkmcnt(10)
  v_lshlrev_b32 v12, 16, v44
  v_fmac_f32 v120, v12, v103
  v_and_b32 v12, 0xffff0000, v44
  v_fmac_f32 v121, v12, v103
  v_lshlrev_b32 v12, 16, v45
  v_fmac_f32 v122, v12, v103
  v_and_b32 v12, 0xffff0000, v45
  v_fmac_f32 v123, v12, v103
  v_lshlrev_b32 v12, 16, v46
  v_fmac_f32 v124, v12, v103
  v_and_b32 v12, 0xffff0000, v46
  v_fmac_f32 v125, v12, v103
  v_lshlrev_b32 v12, 16, v47
  v_fmac_f32 v126, v12, v103
  v_and_b32 v12, 0xffff0000, v47
  v_fmac_f32 v127, v12, v103
  s_waitcnt vmcnt(9) lgkmcnt(9)
  v_lshlrev_b32 v12, 16, v48
  v_fmac_f32 v120, v12, v104
  v_and_b32 v12, 0xffff0000, v48
  v_fmac_f32 v121, v12, v104
  v_lshlrev_b32 v12, 16, v49
  v_fmac_f32 v122, v12, v104
  v_and_b32 v12, 0xffff0000, v49
  v_fmac_f32 v123, v12, v104
  v_lshlrev_b32 v12, 16, v50
  v_fmac_f32 v124, v12, v104
  v_and_b32 v12, 0xffff0000, v50
  v_fmac_f32 v125, v12, v104
  v_lshlrev_b32 v12, 16, v51
  v_fmac_f32 v126, v12, v104
  v_and_b32 v12, 0xffff0000, v51
  v_fmac_f32 v127, v12, v104
  s_waitcnt vmcnt(8) lgkmcnt(8)
  v_lshlrev_b32 v12, 16, v52
  v_fmac_f32 v120, v12, v105
  v_and_b32 v12, 0xffff0000, v52
  v_fmac_f32 v121, v12, v105
  v_lshlrev_b32 v12, 16, v53
  v_fmac_f32 v122, v12, v105
  v_and_b32 v12, 0xffff0000, v53
  v_fmac_f32 v123, v12, v105
  v_lshlrev_b32 v12, 16, v54
  v_fmac_f32 v124, v12, v105
  v_and_b32 v12, 0xffff0000, v54
  v_fmac_f32 v125, v12, v105
  v_lshlrev_b32 v12, 16, v55
  v_fmac_f32 v126, v12, v105
  v_and_b32 v12, 0xffff0000, v55
  v_fmac_f32 v127, v12, v105
  s_waitcnt vmcnt(7) lgkmcnt(7)
  v_lshlrev_b32 v12, 16, v56
  v_fmac_f32 v120, v12, v106
  v_and_b32 v12, 0xffff0000, v56
  v_fmac_f32 v121, v12, v106
  v_lshlrev_b32 v12, 16, v57
  v_fmac_f32 v122, v12, v106
  v_and_b32 v12, 0xffff0000, v57
  v_fmac_f32 v123, v12, v106
  v_lshlrev_b32 v12, 16, v58
  v_fmac_f32 v124, v12, v106
  v_and_b32 v12, 0xffff0000, v58
  v_fmac_f32 v125, v12, v106
  v_lshlrev_b32 v12, 16, v59
  v_fmac_f32 v126, v12, v106
  v_and_b32 v12, 0xffff0000, v59
  v_fmac_f32 v127, v12, v106
  s_waitcnt vmcnt(6) lgkmcnt(6)
  v_lshlrev_b32 v12, 16, v60
  v_fmac_f32 v120, v12, v107
  v_and_b32 v12, 0xffff0000, v60
  v_fmac_f32 v121, v12, v107
  v_lshlrev_b32 v12, 16, v61
  v_fmac_f32 v122, v12, v107
  v_and_b32 v12, 0xffff0000, v61
  v_fmac_f32 v123, v12, v107
  v_lshlrev_b32 v12, 16, v62
  v_fmac_f32 v124, v12, v107
  v_and_b32 v12, 0xffff0000, v62
  v_fmac_f32 v125, v12, v107
  v_lshlrev_b32 v12, 16, v63
  v_fmac_f32 v126, v12, v107
  v_and_b32 v12, 0xffff0000, v63
  v_fmac_f32 v127, v12, v107
  s_waitcnt vmcnt(5) lgkmcnt(5)
  v_lshlrev_b32 v12, 16, v64
  v_fmac_f32 v120, v12, v108
  v_and_b32 v12, 0xffff0000, v64
  v_fmac_f32 v121, v12, v108
  v_lshlrev_b32 v12, 16, v65
  v_fmac_f32 v122, v12, v108
  v_and_b32 v12, 0xffff0000, v65
  v_fmac_f32 v123, v12, v108
  v_lshlrev_b32 v12, 16, v66
  v_fmac_f32 v124, v12, v108
  v_and_b32 v12, 0xffff0000, v66
  v_fmac_f32 v125, v12, v108
  v_lshlrev_b32 v12, 16, v67
  v_fmac_f32 v126, v12, v108
  v_and_b32 v12, 0xffff0000, v67
  v_fmac_f32 v127, v12, v108
  s_waitcnt vmcnt(4) lgkmcnt(4)
  v_lshlrev_b32 v12, 16, v68
  v_fmac_f32 v120, v12, v109
  v_and_b32 v12, 0xffff0000, v68
  v_fmac_f32 v121, v12, v109
  v_lshlrev_b32 v12, 16, v69
  v_fmac_f32 v122, v12, v109
  v_and_b32 v12, 0xffff0000, v69
  v_fmac_f32 v123, v12, v109
  v_lshlrev_b32 v12, 16, v70
  v_fmac_f32 v124, v12, v109
  v_and_b32 v12, 0xffff0000, v70
  v_fmac_f32 v125, v12, v109
  v_lshlrev_b32 v12, 16, v71
  v_fmac_f32 v126, v12, v109
  v_and_b32 v12, 0xffff0000, v71
  v_fmac_f32 v127, v12, v109
  s_waitcnt vmcnt(3) lgkmcnt(3)
  v_lshlrev_b32 v12, 16, v72
  v_fmac_f32 v120, v12, v110
  v_and_b32 v12, 0xffff0000, v72
  v_fmac_f32 v121, v12, v110
  v_lshlrev_b32 v12, 16, v73
  v_fmac_f32 v122, v12, v110
  v_and_b32 v12, 0xffff0000, v73
  v_fmac_f32 v123, v12, v110
  v_lshlrev_b32 v12, 16, v74
  v_fmac_f32 v124, v12, v110
  v_and_b32 v12, 0xffff0000, v74
  v_fmac_f32 v125, v12, v110
  v_lshlrev_b32 v12, 16, v75
  v_fmac_f32 v126, v12, v110
  v_and_b32 v12, 0xffff0000, v75
  v_fmac_f32 v127, v12, v110
  s_waitcnt vmcnt(2) lgkmcnt(2)
  v_lshlrev_b32 v12, 16, v76
  v_fmac_f32 v120, v12, v111
  v_and_b32 v12, 0xffff0000, v76
  v_fmac_f32 v121, v12, v111
  v_lshlrev_b32 v12, 16, v77
  v_fmac_f32 v122, v12, v111
  v_and_b32 v12, 0xffff0000, v77
  v_fmac_f32 v123, v12, v111
  v_lshlrev_b32 v12, 16, v78
  v_fmac_f32 v124, v12, v111
  v_and_b32 v12, 0xffff0000, v78
  v_fmac_f32 v125, v12, v111
  v_lshlrev_b32 v12, 16, v79
  v_fmac_f32 v126, v12, v111
  v_and_b32 v12, 0xffff0000, v79
  v_fmac_f32 v127, v12, v111
  s_waitcnt vmcnt(1) lgkmcnt(1)
  v_lshlrev_b32 v12, 16, v80
  v_fmac_f32 v120, v12, v112
  v_and_b32 v12, 0xffff0000, v80
  v_fmac_f32 v121, v12, v112
  v_lshlrev_b32 v12, 16, v81
  v_fmac_f32 v122, v12, v112
  v_and_b32 v12, 0xffff0000, v81
  v_fmac_f32 v123, v12, v112
  v_lshlrev_b32 v12, 16, v82
  v_fmac_f32 v124, v12, v112
  v_and_b32 v12, 0xffff0000, v82
  v_fmac_f32 v125, v12, v112
  v_lshlrev_b32 v12, 16, v83
  v_fmac_f32 v126, v12, v112
  v_and_b32 v12, 0xffff0000, v83
  v_fmac_f32 v127, v12, v112
  s_waitcnt vmcnt(0) lgkmcnt(0)
  v_lshlrev_b32 v12, 16, v84
  v_fmac_f32 v120, v12, v113
  v_and_b32 v12, 0xffff0000, v84
  v_fmac_f32 v121, v12, v113
  v_lshlrev_b32 v12, 16, v85
  v_fmac_f32 v122, v12, v113
  v_and_b32 v12, 0xffff0000, v85
  v_fmac_f32 v123, v12, v113
  v_lshlrev_b32 v12, 16, v86
  v_fmac_f32 v124, v12, v113
  v_and_b32 v12, 0xffff0000, v86
  v_fmac_f32 v125, v12, v113
  v_lshlrev_b32 v12, 16, v87
  v_fmac_f32 v126, v12, v113
  v_and_b32 v12, 0xffff0000, v87
  v_fmac_f32 v127, v12, v113
  s_barrier
  v_lshlrev_b32 v10, 8, v2
  v_lshlrev_b32 v11, 5, v1
  v_add_u32 v10, v10, v11
  ds_write_b128 v10, v[120:123]
  ds_write_b128 v10, v[124:127] offset:16
  s_waitcnt lgkmcnt(0)
  s_barrier
  v_cmp_gt_u32 vcc, 64, v0
  s_nop 1
  s_and_saveexec_b64 s[14:15], vcc
  s_cbranch_execz end_k1_kernel
  v_lshlrev_b32 v10, 2, v0
  ds_read_b32 v16, v10 offset:0
  ds_read_b32 v17, v10 offset:256
  ds_read_b32 v18, v10 offset:512
  ds_read_b32 v19, v10 offset:768
  ds_read_b32 v20, v10 offset:1024
  ds_read_b32 v21, v10 offset:1280
  ds_read_b32 v22, v10 offset:1536
  ds_read_b32 v23, v10 offset:1792
  ds_read_b32 v24, v10 offset:2048
  ds_read_b32 v25, v10 offset:2304
  ds_read_b32 v26, v10 offset:2560
  ds_read_b32 v27, v10 offset:2816
  ds_read_b32 v28, v10 offset:3072
  ds_read_b32 v29, v10 offset:3328
  ds_read_b32 v30, v10 offset:3584
  s_waitcnt lgkmcnt(0)
  ds_read_b32 v31, v10 offset:3840
  ds_read_b32 v32, v10 offset:4096
  ds_read_b32 v33, v10 offset:4352
  ds_read_b32 v34, v10 offset:4608
  ds_read_b32 v35, v10 offset:4864
  ds_read_b32 v36, v10 offset:5120
  ds_read_b32 v37, v10 offset:5376
  ds_read_b32 v38, v10 offset:5632
  ds_read_b32 v39, v10 offset:5888
  ds_read_b32 v40, v10 offset:6144
  ds_read_b32 v41, v10 offset:6400
  ds_read_b32 v42, v10 offset:6656
  ds_read_b32 v43, v10 offset:6912
  ds_read_b32 v44, v10 offset:7168
  ds_read_b32 v45, v10 offset:7424
  s_waitcnt lgkmcnt(0)
  ds_read_b32 v46, v10 offset:7680
  ds_read_b32 v47, v10 offset:7936
  s_waitcnt lgkmcnt(0)
  v_add_f32 v16, v16, v32
  v_add_f32 v17, v17, v33
  v_add_f32 v18, v18, v34
  v_add_f32 v19, v19, v35
  v_add_f32 v20, v20, v36
  v_add_f32 v21, v21, v37
  v_add_f32 v22, v22, v38
  v_add_f32 v23, v23, v39
  v_add_f32 v24, v24, v40
  v_add_f32 v25, v25, v41
  v_add_f32 v26, v26, v42
  v_add_f32 v27, v27, v43
  v_add_f32 v28, v28, v44
  v_add_f32 v29, v29, v45
  v_add_f32 v30, v30, v46
  v_add_f32 v31, v31, v47
  v_add_f32 v16, v16, v24
  v_add_f32 v17, v17, v25
  v_add_f32 v18, v18, v26
  v_add_f32 v19, v19, v27
  v_add_f32 v20, v20, v28
  v_add_f32 v21, v21, v29
  v_add_f32 v22, v22, v30
  v_add_f32 v23, v23, v31
  v_add_f32 v16, v16, v20
  v_add_f32 v17, v17, v21
  v_add_f32 v18, v18, v22
  v_add_f32 v19, v19, v23
  v_add_f32 v16, v16, v18
  v_add_f32 v17, v17, v19
  v_add_f32 v16, v16, v17
  v_cvt_pk_bf16_f32 v16, v16, v16
  v_lshlrev_b32 v16, 16, v16
  s_sub_u32 s13, s12, 9
  s_cmp_lt_u32 s13, 9
  s_cselect_b32 s36, 1, 0
  s_sub_u32 s13, s12, 36
  s_cmp_lt_u32 s13, 9
  s_cselect_b32 s36, 1, s36
  s_cmp_eq_u32 s36, 0
  s_cbranch_scc1 modst_k1_kernel
  v_add_f32 v16, 1.0, v16
  v_cvt_pk_bf16_f32 v16, v16, v16
  v_lshlrev_b32 v16, 16, v16
modst_k1_kernel:
  s_lshl_b32 s13, s12, 8
  v_add_u32 v10, s13, v10
  buffer_store_dword v16, v10, s[28:31], 0 offen
  s_endpgm
pf_k1_kernel:
  s_getpc_b64 s[20:21]
pc820_k1_kernel:
  s_add_u32 s20, s20, m_kernel-pc820_k1_kernel
  s_addc_u32 s21, s21, 0
  s_mov_b32 s22, m_kernel_codeend-m_kernel
  s_mov_b32 s23, 0x20000
  v_lshlrev_b32 v2, 7, v0
  buffer_load_dword v3, v2, s[20:23], 0 offen
  s_load_dwordx2 s[4:5], s[0:1], 32
  s_and_b32 s13, s2, 7
  s_mul_i32 s13, s13, 294912
  s_sub_u32 s12, s2, 342
  s_lshr_b32 s12, s12, 3
  s_lshl_b32 s12, s12, 8
  v_add_u32 v1, s12, v0
  v_add_u32 v4, 1280, v1
  v_lshlrev_b32 v1, 7, v1
  v_lshlrev_b32 v5, 7, v4
  v_mov_b32 v6, 0x7ff00000
  v_cmp_gt_u32 vcc, 2304, v4
  s_nop 1
  v_cndmask_b32 v5, v6, v5, vcc
  s_waitcnt lgkmcnt(0)
  s_mov_b32 s16, s4
  s_mov_b32 s17, s5
  s_mov_b32 s18, 0x240000
  s_mov_b32 s19, 0x20000
  buffer_load_dword v16, v1, s[16:19], s13 offen
  buffer_load_dword v17, v5, s[16:19], s13 offen
  s_waitcnt vmcnt(0)
end_k1_kernel:
  s_endpgm
k1_kernel_codeend:
.section .rodata,"a"
.p2align 6
.amdhsa_kernel k1_kernel
  .amdhsa_next_free_vgpr 128
  .amdhsa_next_free_sgpr 48
  .amdhsa_accum_offset 128
  .amdhsa_group_segment_fixed_size 0
  .amdhsa_kernarg_size 120
  .amdhsa_user_sgpr_count 2
  .amdhsa_user_sgpr_kernarg_segment_ptr 1
  .amdhsa_system_sgpr_workgroup_id_x 1
  .amdhsa_float_denorm_mode_32 3
.end_amdhsa_kernel
.text
.globl m_kernel
.p2align 8
.type m_kernel,@function
m_kernel:
  s_cmp_ge_u32 s2, 256
  s_cbranch_scc1 end_m_kernel
  v_mov_b32 v237, v0
  s_cmp_ge_u32 s2, 144
  s_cbranch_scc1 pf_m_kernel
  s_load_dwordx4 s[4:7], s[0:1], 32
  s_load_dwordx2 s[8:9], s[0:1], 112
  s_load_dwordx2 s[48:49], s[0:1], 0
  v_and_b32 v185, 63, v0
  v_lshrrev_b32 v1, 6, v0
  v_and_b32 v2, 63, v0
  v_readfirstlane_b32 s10, v1
  s_and_b32 s11, s2, 7
  s_mul_i32 s11, s11, 18
  s_lshr_b32 s12, s2, 3
  s_add_u32 s11, s11, s12
  s_lshl_b32 s11, s11, 2
  s_add_u32 s11, s11, s10
  s_mul_i32 s13, s10, 21248
  s_lshl_b32 s14, s11, 12
  v_lshlrev_b32 v3, 4, v2
  v_subrev_u32 v4, 32, v3
  v_add_u32 v8, 976, v3
  s_waitcnt lgkmcnt(0)
  s_add_u32 s16, s4, s14
  s_addc_u32 s17, s5, 0
  s_mov_b32 s18, 4096
  s_mov_b32 s19, 0x20000
  s_add_u32 s20, s8, s14
  s_addc_u32 s21, s9, 0
  s_mov_b32 s22, 4096
  s_mov_b32 s23, 0x20000
  s_add_u32 s24, s8, 0x240000
  s_addc_u32 s25, s9, 0
  s_mov_b32 s26, 0x240000
  s_mov_b32 s27, 0x20000
  s_and_b32 s15, s11, 0xfffe
  s_lshl_b32 s15, s15, 1
  s_add_u32 s28, s6, s15
  s_addc_u32 s29, s7, 0
  s_load_dword s30, s[28:29], 0
  buffer_load_dwordx4 v[32:35], v4, s[16:19], 0 offen
  buffer_load_dwordx4 v[36:39], v8, s[16:19], 0 offen offset:0
  buffer_load_dwordx4 v[40:43], v8, s[16:19], 0 offen offset:1008
  buffer_load_dwordx4 v[44:47], v8, s[16:19], 0 offen offset:2016
  buffer_load_dwordx4 v[48:51], v8, s[16:19], 0 offen offset:3024
  buffer_load_dwordx4 v[96:99], v3, s[20:23], 0 offen offset:0
  buffer_load_dwordx4 v[100:103], v3, s[20:23], 0 offen offset:1024
  buffer_load_dwordx4 v[104:107], v3, s[20:23], 0 offen offset:2048
  buffer_load_dwordx4 v[108:111], v3, s[20:23], 0 offen offset:3072
  v_add_u32 v10, s13, v3
  v_mov_b32 v12, 0
  v_mov_b32 v13, 0
  v_mov_b32 v14, 0
  v_mov_b32 v15, 0
  s_mov_b64 exec, 0x3fffffff
  ds_write_b128 v10, v[12:15] offset:20736
  s_mov_b64 exec, -1
  v_and_b32 v16, 15, v2
  v_lshrrev_b32 v17, 4, v2
  v_add_u32 v18, 1, v16
  v_and_b32 v19, 3, v18
  v_sub_u32 v18, v18, v19
  v_lshl_add_u32 v18, v17, 3, v18
  v_mul_u32_u24 v19, 4160, v19
  v_lshl_add_u32 v160, v18, 1, v19
  v_add_u32 v160, s13, v160
  v_lshlrev_b32 v18, 5, v16
  v_lshlrev_b32 v19, 4, v17
  v_sub_u32 v161, v19, v18
  s_add_u32 s31, s13, 17120
  v_add_u32 v161, s31, v161
  v_lshlrev_b32 v19, 3, v17
  v_add_u32 v162, v19, v18
  s_add_u32 s31, s13, 17144
  v_sub_u32 v162, s31, v162
  s_mul_i32 s31, s10, 21312
  v_lshlrev_b32 v18, 5, v16
  v_lshl_add_u32 v18, v17, 3, v18
  v_add_u32 v163, s31, v18
  v_bfe_u32 v18, v2, 2, 2
  v_mul_u32_u24 v18, 21312, v18
  v_lshl_add_u32 v18, v17, 5, v18
  v_and_b32 v19, 3, v2
  v_lshl_add_u32 v18, v19, 3, v18
  s_lshl_b32 s31, s10, 10
  v_add_u32 v164, s31, v18
  v_lshlrev_b32 v18, 3, v2
  s_lshl_b32 s31, s10, 12
  v_add_u32 v165, s31, v18
  s_waitcnt vmcnt(8)
  s_mov_b64 exec, -1
  v_mov_b32_dpp v59, v32 wave_shl:1 row_mask:0xf bank_mask:0xf
  v_mov_b32_dpp v68, v33 wave_shl:1 row_mask:0xf bank_mask:0xf
  v_mov_b32 v56, v33
  v_mov_b32 v57, v34
  v_mov_b32 v58, v35
  v_alignbit_b32 v60, v56, v32, 16
  v_alignbit_b32 v61, v57, v33, 16
  v_alignbit_b32 v62, v58, v34, 16
  v_alignbit_b32 v63, v59, v35, 16
  v_alignbit_b32 v64, v57, v56, 16
  v_alignbit_b32 v65, v58, v57, 16
  v_alignbit_b32 v66, v59, v58, 16
  v_alignbit_b32 v67, v68, v59, 16
  s_mov_b32 exec_hi, 0x7fffffff
  ds_write_b128 v10, v[32:35] offset:0
  ds_write_b128 v10, v[60:63] offset:4160
  ds_write_b128 v10, v[56:59] offset:8320
  ds_write_b128 v10, v[64:67] offset:12480
  s_waitcnt vmcnt(7)
  s_mov_b64 exec, -1
  v_mov_b32_dpp v75, v36 wave_shl:1 row_mask:0xf bank_mask:0xf
  v_mov_b32_dpp v84, v37 wave_shl:1 row_mask:0xf bank_mask:0xf
  v_mov_b32 v72, v37
  v_mov_b32 v73, v38
  v_mov_b32 v74, v39
  v_alignbit_b32 v76, v72, v36, 16
  v_alignbit_b32 v77, v73, v37, 16
  v_alignbit_b32 v78, v74, v38, 16
  v_alignbit_b32 v79, v75, v39, 16
  v_alignbit_b32 v80, v73, v72, 16
  v_alignbit_b32 v81, v74, v73, 16
  v_alignbit_b32 v82, v75, v74, 16
  v_alignbit_b32 v83, v84, v75, 16
  s_mov_b32 exec_hi, 0x7fffffff
  ds_write_b128 v10, v[36:39] offset:1008
  ds_write_b128 v10, v[76:79] offset:5168
  ds_write_b128 v10, v[72:75] offset:9328
  ds_write_b128 v10, v[80:83] offset:13488
  s_waitcnt vmcnt(6)
  s_mov_b64 exec, -1
  v_mov_b32_dpp v59, v40 wave_shl:1 row_mask:0xf bank_mask:0xf
  v_mov_b32_dpp v68, v41 wave_shl:1 row_mask:0xf bank_mask:0xf
  v_mov_b32 v56, v41
  v_mov_b32 v57, v42
  v_mov_b32 v58, v43
  v_alignbit_b32 v60, v56, v40, 16
  v_alignbit_b32 v61, v57, v41, 16
  v_alignbit_b32 v62, v58, v42, 16
  v_alignbit_b32 v63, v59, v43, 16
  v_alignbit_b32 v64, v57, v56, 16
  v_alignbit_b32 v65, v58, v57, 16
  v_alignbit_b32 v66, v59, v58, 16
  v_alignbit_b32 v67, v68, v59, 16
  s_mov_b32 exec_hi, 0x7fffffff
  ds_write_b128 v10, v[40:43] offset:2016
  ds_write_b128 v10, v[60:63] offset:6176
  ds_write_b128 v10, v[56:59] offset:10336
  ds_write_b128 v10, v[64:67] offset:14496
  s_waitcnt vmcnt(5)
  s_mov_b64 exec, -1
  v_mov_b32_dpp v75, v44 wave_shl:1 row_mask:0xf bank_mask:0xf
  v_mov_b32_dpp v84, v45 wave_shl:1 row_mask:0xf bank_mask:0xf
  v_mov_b32 v72, v45
  v_mov_b32 v73, v46
  v_mov_b32 v74, v47
  v_alignbit_b32 v76, v72, v44, 16
  v_alignbit_b32 v77, v73, v45, 16
  v_alignbit_b32 v78, v74, v46, 16
  v_alignbit_b32 v79, v75, v47, 16
  v_alignbit_b32 v80, v73, v72, 16
  v_alignbit_b32 v81, v74, v73, 16
  v_alignbit_b32 v82, v75, v74, 16
  v_alignbit_b32 v83, v84, v75, 16
  s_mov_b32 exec_hi, 0x7fffffff
  ds_write_b128 v10, v[44:47] offset:3024
  ds_write_b128 v10, v[76:79] offset:7184
  ds_write_b128 v10, v[72:75] offset:11344
  ds_write_b128 v10, v[80:83] offset:15504
  s_waitcnt vmcnt(4)
  s_mov_b64 exec, -1
  v_mov_b32_dpp v59, v48 wave_shl:1 row_mask:0xf bank_mask:0xf
  v_mov_b32_dpp v68, v49 wave_shl:1 row_mask:0xf bank_mask:0xf
  v_mov_b32 v56, v49
  v_mov_b32 v57, v50
  v_mov_b32 v58, v51
  v_alignbit_b32 v60, v56, v48, 16
  v_alignbit_b32 v61, v57, v49, 16
  v_alignbit_b32 v62, v58, v50, 16
  v_alignbit_b32 v63, v59, v51, 16
  v_alignbit_b32 v64, v57, v56, 16
  v_alignbit_b32 v65, v58, v57, 16
  v_alignbit_b32 v66, v59, v58, 16
  v_alignbit_b32 v67, v68, v59, 16
  s_mov_b64 exec, 63
  ds_write_b128 v10, v[48:51] offset:4032
  ds_write_b128 v10, v[60:63] offset:8192
  ds_write_b128 v10, v[56:59] offset:12352
  ds_write_b128 v10, v[64:67] offset:16512
  s_mov_b64 exec, -1
  s_waitcnt vmcnt(0)
  ds_write_b128 v10, v[96:99] offset:16640
  ds_write_b128 v10, v[100:103] offset:17664
  ds_write_b128 v10, v[104:107] offset:18688
  ds_write_b128 v10, v[108:111] offset:19712
  s_waitcnt lgkmcnt(0)
  ds_read_b64 v[32:33], v160 offset:0
  ds_read_b64 v[34:35], v160 offset:8
  ds_read_b128 v[96:99], v161 offset:3584
  ds_read_b64 v[36:37], v160 offset:512
  ds_read_b64 v[38:39], v160 offset:520
  ds_read_b128 v[100:103], v161 offset:3072
  ds_read_b64 v[40:41], v160 offset:1024
  ds_read_b64 v[42:43], v160 offset:1032
  ds_read_b128 v[104:107], v161 offset:2560
  ds_read_b64 v[44:45], v160 offset:1536
  ds_read_b64 v[46:47], v160 offset:1544
  ds_read_b128 v[108:111], v161 offset:2048
  ds_read_b64 v[48:49], v160 offset:2048
  ds_read_b64 v[50:51], v160 offset:2056
  ds_read_b128 v[112:115], v161 offset:1536
  ds_read_b64 v[52:53], v160 offset:2560
  ds_read_b64 v[54:55], v160 offset:2568
  ds_read_b128 v[116:119], v161 offset:1024
  ds_read_b64 v[56:57], v160 offset:3072
  ds_read_b64 v[58:59], v160 offset:3080
  ds_read_b128 v[120:123], v161 offset:512
  ds_read_b64 v[60:61], v160 offset:3584
  ds_read_b64 v[62:63], v160 offset:3592
  ds_read_b128 v[124:127], v161 offset:0
  s_waitcnt lgkmcnt(0)
  v_mfma_f32_16x16x32_bf16 v[28:31], v[32:35], v[124:127], 0
  ds_read_b64 v[64:65], v160 offset:64
  v_mfma_f32_16x16x32_bf16 v[24:27], v[32:35], v[120:123], 0
  ds_read_b64 v[66:67], v160 offset:72
  v_mfma_f32_16x16x32_bf16 v[28:31], v[36:39], v[120:123], v[28:31]
  ds_read_b128 v[128:131], v161 offset:3648
  v_mfma_f32_16x16x32_bf16 v[20:23], v[32:35], v[116:119], 0
  ds_read_b64 v[68:69], v160 offset:576
  v_mfma_f32_16x16x32_bf16 v[24:27], v[36:39], v[116:119], v[24:27]
  ds_read_b64 v[70:71], v160 offset:584
  v_mfma_f32_16x16x32_bf16 v[28:31], v[40:43], v[116:119], v[28:31]
  ds_read_b128 v[132:135], v161 offset:3136
  v_mfma_f32_16x16x32_bf16 v[16:19], v[32:35], v[112:115], 0
  ds_read_b64 v[72:73], v160 offset:1088
  v_mfma_f32_16x16x32_bf16 v[20:23], v[36:39], v[112:115], v[20:23]
  ds_read_b64 v[74:75], v160 offset:1096
  v_mfma_f32_16x16x32_bf16 v[24:27], v[40:43], v[112:115], v[24:27]
  ds_read_b128 v[136:139], v161 offset:2624
  v_mfma_f32_16x16x32_bf16 v[28:31], v[44:47], v[112:115], v[28:31]
  ds_read_b64 v[76:77], v160 offset:1600
  v_mfma_f32_16x16x32_bf16 v[12:15], v[32:35], v[108:111], 0
  ds_read_b64 v[78:79], v160 offset:1608
  v_mfma_f32_16x16x32_bf16 v[16:19], v[36:39], v[108:111], v[16:19]
  ds_read_b128 v[140:143], v161 offset:2112
  v_mfma_f32_16x16x32_bf16 v[20:23], v[40:43], v[108:111], v[20:23]
  ds_read_b64 v[80:81], v160 offset:2112
  v_mfma_f32_16x16x32_bf16 v[24:27], v[44:47], v[108:111], v[24:27]
  ds_read_b64 v[82:83], v160 offset:2120
  v_mfma_f32_16x16x32_bf16 v[28:31], v[48:51], v[108:111], v[28:31]
  ds_read_b128 v[144:147], v161 offset:1600
  v_mfma_f32_16x16x32_bf16 v[8:11], v[32:35], v[104:107], 0
  ds_read_b64 v[84:85], v160 offset:2624
  v_mfma_f32_16x16x32_bf16 v[12:15], v[36:39], v[104:107], v[12:15]
  ds_read_b64 v[86:87], v160 offset:2632
  v_mfma_f32_16x16x32_bf16 v[16:19], v[40:43], v[104:107], v[16:19]
  ds_read_b128 v[148:151], v161 offset:1088
  v_mfma_f32_16x16x32_bf16 v[20:23], v[44:47], v[104:107], v[20:23]
  ds_read_b64 v[88:89], v160 offset:3136
  v_mfma_f32_16x16x32_bf16 v[24:27], v[48:51], v[104:107], v[24:27]
  ds_read_b64 v[90:91], v160 offset:3144
  v_mfma_f32_16x16x32_bf16 v[28:31], v[52:55], v[104:107], v[28:31]
  ds_read_b128 v[152:155], v161 offset:576
  v_mfma_f32_16x16x32_bf16 v[4:7], v[32:35], v[100:103], 0
  ds_read_b64 v[92:93], v160 offset:3648
  v_mfma_f32_16x16x32_bf16 v[8:11], v[36:39], v[100:103], v[8:11]
  ds_read_b64 v[94:95], v160 offset:3656
  v_mfma_f32_16x16x32_bf16 v[12:15], v[40:43], v[100:103], v[12:15]
  ds_read_b128 v[156:159], v161 offset:64
  v_mfma_f32_16x16x32_bf16 v[16:19], v[44:47], v[100:103], v[16:19]
  v_mfma_f32_16x16x32_bf16 v[20:23], v[48:51], v[100:103], v[20:23]
  v_mfma_f32_16x16x32_bf16 v[24:27], v[52:55], v[100:103], v[24:27]
  v_mfma_f32_16x16x32_bf16 v[28:31], v[56:59], v[100:103], v[28:31]
  v_mfma_f32_16x16x32_bf16 v[0:3], v[32:35], v[96:99], 0
  v_mfma_f32_16x16x32_bf16 v[4:7], v[36:39], v[96:99], v[4:7]
  v_mfma_f32_16x16x32_bf16 v[8:11], v[40:43], v[96:99], v[8:11]
  v_mfma_f32_16x16x32_bf16 v[12:15], v[44:47], v[96:99], v[12:15]
  v_mfma_f32_16x16x32_bf16 v[16:19], v[48:51], v[96:99], v[16:19]
  v_mfma_f32_16x16x32_bf16 v[20:23], v[52:55], v[96:99], v[20:23]
  v_mfma_f32_16x16x32_bf16 v[24:27], v[56:59], v[96:99], v[24:27]
  v_mfma_f32_16x16x32_bf16 v[28:31], v[60:63], v[96:99], v[28:31]
  s_waitcnt lgkmcnt(0)
  v_mfma_f32_16x16x32_bf16 v[28:31], v[64:67], v[156:159], v[28:31]
  ds_read_b64 v[32:33], v160 offset:128
  v_mfma_f32_16x16x32_bf16 v[24:27], v[64:67], v[152:155], v[24:27]
  ds_read_b64 v[34:35], v160 offset:136
  v_mfma_f32_16x16x32_bf16 v[28:31], v[68:71], v[152:155], v[28:31]
  ds_read_b128 v[96:99], v161 offset:3712
  v_mfma_f32_16x16x32_bf16 v[20:23], v[64:67], v[148:151], v[20:23]
  ds_read_b64 v[36:37], v160 offset:640
  v_mfma_f32_16x16x32_bf16 v[24:27], v[68:71], v[148:151], v[24:27]
  ds_read_b64 v[38:39], v160 offset:648
  v_mfma_f32_16x16x32_bf16 v[28:31], v[72:75], v[148:151], v[28:31]
  ds_read_b128 v[100:103], v161 offset:3200
  v_mfma_f32_16x16x32_bf16 v[16:19], v[64:67], v[144:147], v[16:19]
  ds_read_b64 v[40:41], v160 offset:1152
  v_mfma_f32_16x16x32_bf16 v[20:23], v[68:71], v[144:147], v[20:23]
  ds_read_b64 v[42:43], v160 offset:1160
  v_mfma_f32_16x16x32_bf16 v[24:27], v[72:75], v[144:147], v[24:27]
  ds_read_b128 v[104:107], v161 offset:2688
  v_mfma_f32_16x16x32_bf16 v[28:31], v[76:79], v[144:147], v[28:31]
  ds_read_b64 v[44:45], v160 offset:1664
  v_mfma_f32_16x16x32_bf16 v[12:15], v[64:67], v[140:143], v[12:15]
  ds_read_b64 v[46:47], v160 offset:1672
  v_mfma_f32_16x16x32_bf16 v[16:19], v[68:71], v[140:143], v[16:19]
  ds_read_b128 v[108:111], v161 offset:2176
  v_mfma_f32_16x16x32_bf16 v[20:23], v[72:75], v[140:143], v[20:23]
  ds_read_b64 v[48:49], v160 offset:2176
  v_mfma_f32_16x16x32_bf16 v[24:27], v[76:79], v[140:143], v[24:27]
  ds_read_b64 v[50:51], v160 offset:2184
  v_mfma_f32_16x16x32_bf16 v[28:31], v[80:83], v[140:143], v[28:31]
  ds_read_b128 v[112:115], v161 offset:1664
  v_mfma_f32_16x16x32_bf16 v[8:11], v[64:67], v[136:139], v[8:11]
  ds_read_b64 v[52:53], v160 offset:2688
  v_mfma_f32_16x16x32_bf16 v[12:15], v[68:71], v[136:139], v[12:15]
  ds_read_b64 v[54:55], v160 offset:2696
  v_mfma_f32_16x16x32_bf16 v[16:19], v[72:75], v[136:139], v[16:19]
  ds_read_b128 v[116:119], v161 offset:1152
  v_mfma_f32_16x16x32_bf16 v[20:23], v[76:79], v[136:139], v[20:23]
  ds_read_b64 v[56:57], v160 offset:3200
  v_mfma_f32_16x16x32_bf16 v[24:27], v[80:83], v[136:139], v[24:27]
  ds_read_b64 v[58:59], v160 offset:3208
  v_mfma_f32_16x16x32_bf16 v[28:31], v[84:87], v[136:139], v[28:31]
  ds_read_b128 v[120:123], v161 offset:640
  v_mfma_f32_16x16x32_bf16 v[4:7], v[64:67], v[132:135], v[4:7]
  ds_read_b64 v[60:61], v160 offset:3712
  v_mfma_f32_16x16x32_bf16 v[8:11], v[68:71], v[132:135], v[8:11]
  ds_read_b64 v[62:63], v160 offset:3720
  v_mfma_f32_16x16x32_bf16 v[12:15], v[72:75], v[132:135], v[12:15]
  ds_read_b128 v[124:127], v161 offset:128
  s_mov_b32 s56, s48
  s_mov_b32 s57, s49
  s_mov_b32 s58, 0x240000
  s_mov_b32 s59, 0x20000
  s_add_u32 s60, s8, 0x900000
  s_addc_u32 s61, s9, 0
  s_mov_b32 s62, 0x2d00
  s_mov_b32 s63, 0x20000
  v_lshrrev_b32 v186, 5, v185
  s_lshl_b32 s64, s10, 1
  v_add_u32 v186, s64, v186
  v_and_b32 v187, 31, v185
  v_mul_u32_u24 v186, 1152, v186
  v_lshl_add_u32 v186, v187, 2, v186
  s_mul_i32 s64, s2, 9216
  buffer_load_dword v176, v186, s[56:59], s64 offen offset:0
  buffer_load_dword v177, v186, s[56:59], s64 offen offset:128
  buffer_load_dword v178, v186, s[56:59], s64 offen offset:256
  buffer_load_dword v179, v186, s[56:59], s64 offen offset:384
  buffer_load_dword v180, v186, s[56:59], s64 offen offset:512
  buffer_load_dword v181, v186, s[56:59], s64 offen offset:640
  buffer_load_dword v182, v186, s[56:59], s64 offen offset:768
  buffer_load_dword v183, v186, s[56:59], s64 offen offset:896
  buffer_load_dword v184, v186, s[56:59], s64 offen offset:1024
  v_lshlrev_b32 v188, 4, v185
  s_mul_i32 s64, s10, 3072
  s_add_u32 s65, s64, 0
  s_add_u32 m0, s64, 107520
  v_mfma_f32_16x16x32_bf16 v[16:19], v[76:79], v[132:135], v[16:19]
  s_nop 0
  v_mfma_f32_16x16x32_bf16 v[20:23], v[80:83], v[132:135], v[20:23]
  buffer_load_dwordx4 v188, s[60:63], s65 offen lds
  v_mfma_f32_16x16x32_bf16 v[24:27], v[84:87], v[132:135], v[24:27]
  s_mul_i32 s64, s10, 3072
  v_mfma_f32_16x16x32_bf16 v[28:31], v[88:91], v[132:135], v[28:31]
  s_add_u32 s65, s64, 1024
  v_mfma_f32_16x16x32_bf16 v[0:3], v[64:67], v[128:131], v[0:3]
  s_add_u32 m0, s64, 108544
  v_mfma_f32_16x16x32_bf16 v[4:7], v[68:71], v[128:131], v[4:7]
  s_nop 0
  v_mfma_f32_16x16x32_bf16 v[8:11], v[72:75], v[128:131], v[8:11]
  buffer_load_dwordx4 v188, s[60:63], s65 offen lds
  v_mfma_f32_16x16x32_bf16 v[12:15], v[76:79], v[128:131], v[12:15]
  s_mul_i32 s64, s10, 3072
  v_mfma_f32_16x16x32_bf16 v[16:19], v[80:83], v[128:131], v[16:19]
  s_add_u32 s65, s64, 2048
  v_mfma_f32_16x16x32_bf16 v[20:23], v[84:87], v[128:131], v[20:23]
  s_add_u32 m0, s64, 109568
  v_mfma_f32_16x16x32_bf16 v[24:27], v[88:91], v[128:131], v[24:27]
  s_nop 0
  v_mfma_f32_16x16x32_bf16 v[28:31], v[92:95], v[128:131], v[28:31]
  buffer_load_dwordx4 v188, s[60:63], s65 offen lds
  s_waitcnt lgkmcnt(0)
  v_mfma_f32_16x16x32_bf16 v[28:31], v[32:35], v[124:127], v[28:31]
  ds_read_b64 v[64:65], v160 offset:192
  v_mfma_f32_16x16x32_bf16 v[24:27], v[32:35], v[120:123], v[24:27]
  ds_read_b64 v[66:67], v160 offset:200
  v_mfma_f32_16x16x32_bf16 v[28:31], v[36:39], v[120:123], v[28:31]
  ds_read_b128 v[128:131], v161 offset:3776
  v_mfma_f32_16x16x32_bf16 v[20:23], v[32:35], v[116:119], v[20:23]
  ds_read_b64 v[68:69], v160 offset:704
  v_mfma_f32_16x16x32_bf16 v[24:27], v[36:39], v[116:119], v[24:27]
  ds_read_b64 v[70:71], v160 offset:712
  v_mfma_f32_16x16x32_bf16 v[28:31], v[40:43], v[116:119], v[28:31]
  ds_read_b128 v[132:135], v161 offset:3264
  v_mfma_f32_16x16x32_bf16 v[16:19], v[32:35], v[112:115], v[16:19]
  ds_read_b64 v[72:73], v160 offset:1216
  v_mfma_f32_16x16x32_bf16 v[20:23], v[36:39], v[112:115], v[20:23]
  ds_read_b64 v[74:75], v160 offset:1224
  v_mfma_f32_16x16x32_bf16 v[24:27], v[40:43], v[112:115], v[24:27]
  ds_read_b128 v[136:139], v161 offset:2752
  v_mfma_f32_16x16x32_bf16 v[28:31], v[44:47], v[112:115], v[28:31]
  ds_read_b64 v[76:77], v160 offset:1728
  v_mfma_f32_16x16x32_bf16 v[12:15], v[32:35], v[108:111], v[12:15]
  ds_read_b64 v[78:79], v160 offset:1736
  v_mfma_f32_16x16x32_bf16 v[16:19], v[36:39], v[108:111], v[16:19]
  ds_read_b128 v[140:143], v161 offset:2240
  v_mfma_f32_16x16x32_bf16 v[20:23], v[40:43], v[108:111], v[20:23]
  ds_read_b64 v[80:81], v160 offset:2240
  v_mfma_f32_16x16x32_bf16 v[24:27], v[44:47], v[108:111], v[24:27]
  ds_read_b64 v[82:83], v160 offset:2248
  v_mfma_f32_16x16x32_bf16 v[28:31], v[48:51], v[108:111], v[28:31]
  ds_read_b128 v[144:147], v161 offset:1728
  v_mfma_f32_16x16x32_bf16 v[8:11], v[32:35], v[104:107], v[8:11]
  ds_read_b64 v[84:85], v160 offset:2752
  v_mfma_f32_16x16x32_bf16 v[12:15], v[36:39], v[104:107], v[12:15]
  ds_read_b64 v[86:87], v160 offset:2760
  v_mfma_f32_16x16x32_bf16 v[16:19], v[40:43], v[104:107], v[16:19]
  ds_read_b128 v[148:151], v161 offset:1216
  v_mfma_f32_16x16x32_bf16 v[20:23], v[44:47], v[104:107], v[20:23]
  ds_read_b64 v[88:89], v160 offset:3264
  v_mfma_f32_16x16x32_bf16 v[24:27], v[48:51], v[104:107], v[24:27]
  ds_read_b64 v[90:91], v160 offset:3272
  v_mfma_f32_16x16x32_bf16 v[28:31], v[52:55], v[104:107], v[28:31]
  ds_read_b128 v[152:155], v161 offset:704
  v_mfma_f32_16x16x32_bf16 v[4:7], v[32:35], v[100:103], v[4:7]
  ds_read_b64 v[92:93], v160 offset:3776
  v_mfma_f32_16x16x32_bf16 v[8:11], v[36:39], v[100:103], v[8:11]
  ds_read_b64 v[94:95], v160 offset:3784
  v_mfma_f32_16x16x32_bf16 v[12:15], v[40:43], v[100:103], v[12:15]
  ds_read_b128 v[156:159], v161 offset:192
  v_mfma_f32_16x16x32_bf16 v[16:19], v[44:47], v[100:103], v[16:19]
  v_mfma_f32_16x16x32_bf16 v[20:23], v[48:51], v[100:103], v[20:23]
  v_mfma_f32_16x16x32_bf16 v[24:27], v[52:55], v[100:103], v[24:27]
  v_mfma_f32_16x16x32_bf16 v[28:31], v[56:59], v[100:103], v[28:31]
  v_mfma_f32_16x16x32_bf16 v[0:3], v[32:35], v[96:99], v[0:3]
  v_mfma_f32_16x16x32_bf16 v[4:7], v[36:39], v[96:99], v[4:7]
  v_mfma_f32_16x16x32_bf16 v[8:11], v[40:43], v[96:99], v[8:11]
  v_mfma_f32_16x16x32_bf16 v[12:15], v[44:47], v[96:99], v[12:15]
  v_mfma_f32_16x16x32_bf16 v[16:19], v[48:51], v[96:99], v[16:19]
  v_mfma_f32_16x16x32_bf16 v[20:23], v[52:55], v[96:99], v[20:23]
  v_mfma_f32_16x16x32_bf16 v[24:27], v[56:59], v[96:99], v[24:27]
  v_mfma_f32_16x16x32_bf16 v[28:31], v[60:63], v[96:99], v[28:31]
  s_waitcnt lgkmcnt(0)
  v_mfma_f32_16x16x32_bf16 v[28:31], v[64:67], v[156:159], v[28:31]
  ds_read_b64 v[32:33], v160 offset:256
  v_mfma_f32_16x16x32_bf16 v[24:27], v[64:67], v[152:155], v[24:27]
  ds_read_b64 v[34:35], v160 offset:264
  v_mfma_f32_16x16x32_bf16 v[28:31], v[68:71], v[152:155], v[28:31]
  ds_read_b128 v[96:99], v161 offset:3840
  v_mfma_f32_16x16x32_bf16 v[20:23], v[64:67], v[148:151], v[20:23]
  ds_read_b64 v[36:37], v160 offset:768
  v_mfma_f32_16x16x32_bf16 v[24:27], v[68:71], v[148:151], v[24:27]
  ds_read_b64 v[38:39], v160 offset:776
  v_mfma_f32_16x16x32_bf16 v[28:31], v[72:75], v[148:151], v[28:31]
  ds_read_b128 v[100:103], v161 offset:3328
  v_mfma_f32_16x16x32_bf16 v[16:19], v[64:67], v[144:147], v[16:19]
  ds_read_b64 v[40:41], v160 offset:1280
  v_mfma_f32_16x16x32_bf16 v[20:23], v[68:71], v[144:147], v[20:23]
  ds_read_b64 v[42:43], v160 offset:1288
  v_mfma_f32_16x16x32_bf16 v[24:27], v[72:75], v[144:147], v[24:27]
  ds_read_b128 v[104:107], v161 offset:2816
  v_mfma_f32_16x16x32_bf16 v[28:31], v[76:79], v[144:147], v[28:31]
  ds_read_b64 v[44:45], v160 offset:1792
  v_mfma_f32_16x16x32_bf16 v[12:15], v[64:67], v[140:143], v[12:15]
  ds_read_b64 v[46:47], v160 offset:1800
  v_mfma_f32_16x16x32_bf16 v[16:19], v[68:71], v[140:143], v[16:19]
  ds_read_b128 v[108:111], v161 offset:2304
  v_mfma_f32_16x16x32_bf16 v[20:23], v[72:75], v[140:143], v[20:23]
  ds_read_b64 v[48:49], v160 offset:2304
  v_mfma_f32_16x16x32_bf16 v[24:27], v[76:79], v[140:143], v[24:27]
  ds_read_b64 v[50:51], v160 offset:2312
  v_mfma_f32_16x16x32_bf16 v[28:31], v[80:83], v[140:143], v[28:31]
  ds_read_b128 v[112:115], v161 offset:1792
  v_mfma_f32_16x16x32_bf16 v[8:11], v[64:67], v[136:139], v[8:11]
  ds_read_b64 v[52:53], v160 offset:2816
  v_mfma_f32_16x16x32_bf16 v[12:15], v[68:71], v[136:139], v[12:15]
  ds_read_b64 v[54:55], v160 offset:2824
  v_mfma_f32_16x16x32_bf16 v[16:19], v[72:75], v[136:139], v[16:19]
  ds_read_b128 v[116:119], v161 offset:1280
  v_mfma_f32_16x16x32_bf16 v[20:23], v[76:79], v[136:139], v[20:23]
  ds_read_b64 v[56:57], v160 offset:3328
  v_mfma_f32_16x16x32_bf16 v[24:27], v[80:83], v[136:139], v[24:27]
  ds_read_b64 v[58:59], v160 offset:3336
  v_mfma_f32_16x16x32_bf16 v[28:31], v[84:87], v[136:139], v[28:31]
  ds_read_b128 v[120:123], v161 offset:768
  v_mfma_f32_16x16x32_bf16 v[4:7], v[64:67], v[132:135], v[4:7]
  ds_read_b64 v[60:61], v160 offset:3840
  v_mfma_f32_16x16x32_bf16 v[8:11], v[68:71], v[132:135], v[8:11]
  ds_read_b64 v[62:63], v160 offset:3848
  v_mfma_f32_16x16x32_bf16 v[12:15], v[72:75], v[132:135], v[12:15]
  ds_read_b128 v[124:127], v161 offset:256
  v_mfma_f32_16x16x32_bf16 v[16:19], v[76:79], v[132:135], v[16:19]
  v_mfma_f32_16x16x32_bf16 v[20:23], v[80:83], v[132:135], v[20:23]
  v_mfma_f32_16x16x32_bf16 v[24:27], v[84:87], v[132:135], v[24:27]
  v_mfma_f32_16x16x32_bf16 v[28:31], v[88:91], v[132:135], v[28:31]
  v_mfma_f32_16x16x32_bf16 v[0:3], v[64:67], v[128:131], v[0:3]
  v_mfma_f32_16x16x32_bf16 v[4:7], v[68:71], v[128:131], v[4:7]
  v_mfma_f32_16x16x32_bf16 v[8:11], v[72:75], v[128:131], v[8:11]
  v_mfma_f32_16x16x32_bf16 v[12:15], v[76:79], v[128:131], v[12:15]
  v_mfma_f32_16x16x32_bf16 v[16:19], v[80:83], v[128:131], v[16:19]
  v_mfma_f32_16x16x32_bf16 v[20:23], v[84:87], v[128:131], v[20:23]
  v_mfma_f32_16x16x32_bf16 v[24:27], v[88:91], v[128:131], v[24:27]
  v_mfma_f32_16x16x32_bf16 v[28:31], v[92:95], v[128:131], v[28:31]
  s_waitcnt lgkmcnt(0)
  v_mfma_f32_16x16x32_bf16 v[28:31], v[32:35], v[124:127], v[28:31]
  ds_read_b64 v[64:65], v160 offset:320
  v_mfma_f32_16x16x32_bf16 v[24:27], v[32:35], v[120:123], v[24:27]
  ds_read_b64 v[66:67], v160 offset:328
  v_mfma_f32_16x16x32_bf16 v[28:31], v[36:39], v[120:123], v[28:31]
  ds_read_b128 v[128:131], v161 offset:3904
  v_mfma_f32_16x16x32_bf16 v[20:23], v[32:35], v[116:119], v[20:23]
  ds_read_b64 v[68:69], v160 offset:832
  v_mfma_f32_16x16x32_bf16 v[24:27], v[36:39], v[116:119], v[24:27]
  ds_read_b64 v[70:71], v160 offset:840
  v_mfma_f32_16x16x32_bf16 v[28:31], v[40:43], v[116:119], v[28:31]
  ds_read_b128 v[132:135], v161 offset:3392
  v_mfma_f32_16x16x32_bf16 v[16:19], v[32:35], v[112:115], v[16:19]
  ds_read_b64 v[72:73], v160 offset:1344
  v_mfma_f32_16x16x32_bf16 v[20:23], v[36:39], v[112:115], v[20:23]
  ds_read_b64 v[74:75], v160 offset:1352
  v_mfma_f32_16x16x32_bf16 v[24:27], v[40:43], v[112:115], v[24:27]
  ds_read_b128 v[136:139], v161 offset:2880
  v_mfma_f32_16x16x32_bf16 v[28:31], v[44:47], v[112:115], v[28:31]
  ds_read_b64 v[76:77], v160 offset:1856
  v_mfma_f32_16x16x32_bf16 v[12:15], v[32:35], v[108:111], v[12:15]
  ds_read_b64 v[78:79], v160 offset:1864
  v_mfma_f32_16x16x32_bf16 v[16:19], v[36:39], v[108:111], v[16:19]
  ds_read_b128 v[140:143], v161 offset:2368
  v_mfma_f32_16x16x32_bf16 v[20:23], v[40:43], v[108:111], v[20:23]
  ds_read_b64 v[80:81], v160 offset:2368
  v_mfma_f32_16x16x32_bf16 v[24:27], v[44:47], v[108:111], v[24:27]
  ds_read_b64 v[82:83], v160 offset:2376
  v_mfma_f32_16x16x32_bf16 v[28:31], v[48:51], v[108:111], v[28:31]
  ds_read_b128 v[144:147], v161 offset:1856
  v_mfma_f32_16x16x32_bf16 v[8:11], v[32:35], v[104:107], v[8:11]
  ds_read_b64 v[84:85], v160 offset:2880
  v_mfma_f32_16x16x32_bf16 v[12:15], v[36:39], v[104:107], v[12:15]
  ds_read_b64 v[86:87], v160 offset:2888
  v_mfma_f32_16x16x32_bf16 v[16:19], v[40:43], v[104:107], v[16:19]
  ds_read_b128 v[148:151], v161 offset:1344
  v_mfma_f32_16x16x32_bf16 v[20:23], v[44:47], v[104:107], v[20:23]
  ds_read_b64 v[88:89], v160 offset:3392
  v_mfma_f32_16x16x32_bf16 v[24:27], v[48:51], v[104:107], v[24:27]
  ds_read_b64 v[90:91], v160 offset:3400
  v_mfma_f32_16x16x32_bf16 v[28:31], v[52:55], v[104:107], v[28:31]
  ds_read_b128 v[152:155], v161 offset:832
  v_mfma_f32_16x16x32_bf16 v[4:7], v[32:35], v[100:103], v[4:7]
  ds_read_b64 v[92:93], v160 offset:3904
  v_mfma_f32_16x16x32_bf16 v[8:11], v[36:39], v[100:103], v[8:11]
  ds_read_b64 v[94:95], v160 offset:3912
  v_mfma_f32_16x16x32_bf16 v[12:15], v[40:43], v[100:103], v[12:15]
  ds_read_b128 v[156:159], v161 offset:320
  v_mfma_f32_16x16x32_bf16 v[16:19], v[44:47], v[100:103], v[16:19]
  v_mfma_f32_16x16x32_bf16 v[20:23], v[48:51], v[100:103], v[20:23]
  v_mfma_f32_16x16x32_bf16 v[24:27], v[52:55], v[100:103], v[24:27]
  v_mfma_f32_16x16x32_bf16 v[28:31], v[56:59], v[100:103], v[28:31]
  v_mfma_f32_16x16x32_bf16 v[0:3], v[32:35], v[96:99], v[0:3]
  v_mfma_f32_16x16x32_bf16 v[4:7], v[36:39], v[96:99], v[4:7]
  v_mfma_f32_16x16x32_bf16 v[8:11], v[40:43], v[96:99], v[8:11]
  v_mfma_f32_16x16x32_bf16 v[12:15], v[44:47], v[96:99], v[12:15]
  v_mfma_f32_16x16x32_bf16 v[16:19], v[48:51], v[96:99], v[16:19]
  v_mfma_f32_16x16x32_bf16 v[20:23], v[52:55], v[96:99], v[20:23]
  v_mfma_f32_16x16x32_bf16 v[24:27], v[56:59], v[96:99], v[24:27]
  v_mfma_f32_16x16x32_bf16 v[28:31], v[60:63], v[96:99], v[28:31]
  s_waitcnt lgkmcnt(0)
  v_mfma_f32_16x16x32_bf16 v[28:31], v[64:67], v[156:159], v[28:31]
  ds_read_b64 v[32:33], v160 offset:384
  v_mfma_f32_16x16x32_bf16 v[24:27], v[64:67], v[152:155], v[24:27]
  ds_read_b64 v[34:35], v160 offset:392
  v_mfma_f32_16x16x32_bf16 v[28:31], v[68:71], v[152:155], v[28:31]
  ds_read_b128 v[96:99], v161 offset:3968
  v_mfma_f32_16x16x32_bf16 v[20:23], v[64:67], v[148:151], v[20:23]
  ds_read_b64 v[36:37], v160 offset:896
  v_mfma_f32_16x16x32_bf16 v[24:27], v[68:71], v[148:151], v[24:27]
  ds_read_b64 v[38:39], v160 offset:904
  v_mfma_f32_16x16x32_bf16 v[28:31], v[72:75], v[148:151], v[28:31]
  ds_read_b128 v[100:103], v161 offset:3456
  v_mfma_f32_16x16x32_bf16 v[16:19], v[64:67], v[144:147], v[16:19]
  ds_read_b64 v[40:41], v160 offset:1408
  v_mfma_f32_16x16x32_bf16 v[20:23], v[68:71], v[144:147], v[20:23]
  ds_read_b64 v[42:43], v160 offset:1416
  v_mfma_f32_16x16x32_bf16 v[24:27], v[72:75], v[144:147], v[24:27]
  ds_read_b128 v[104:107], v161 offset:2944
  v_mfma_f32_16x16x32_bf16 v[28:31], v[76:79], v[144:147], v[28:31]
  ds_read_b64 v[44:45], v160 offset:1920
  v_mfma_f32_16x16x32_bf16 v[12:15], v[64:67], v[140:143], v[12:15]
  ds_read_b64 v[46:47], v160 offset:1928
  v_mfma_f32_16x16x32_bf16 v[16:19], v[68:71], v[140:143], v[16:19]
  ds_read_b128 v[108:111], v161 offset:2432
  v_mfma_f32_16x16x32_bf16 v[20:23], v[72:75], v[140:143], v[20:23]
  ds_read_b64 v[48:49], v160 offset:2432
  v_mfma_f32_16x16x32_bf16 v[24:27], v[76:79], v[140:143], v[24:27]
  ds_read_b64 v[50:51], v160 offset:2440
  v_mfma_f32_16x16x32_bf16 v[28:31], v[80:83], v[140:143], v[28:31]
  ds_read_b128 v[112:115], v161 offset:1920
  v_mfma_f32_16x16x32_bf16 v[8:11], v[64:67], v[136:139], v[8:11]
  ds_read_b64 v[52:53], v160 offset:2944
  v_mfma_f32_16x16x32_bf16 v[12:15], v[68:71], v[136:139], v[12:15]
  ds_read_b64 v[54:55], v160 offset:2952
  v_mfma_f32_16x16x32_bf16 v[16:19], v[72:75], v[136:139], v[16:19]
  ds_read_b128 v[116:119], v161 offset:1408
  v_mfma_f32_16x16x32_bf16 v[20:23], v[76:79], v[136:139], v[20:23]
  ds_read_b64 v[56:57], v160 offset:3456
  v_mfma_f32_16x16x32_bf16 v[24:27], v[80:83], v[136:139], v[24:27]
  ds_read_b64 v[58:59], v160 offset:3464
  v_mfma_f32_16x16x32_bf16 v[28:31], v[84:87], v[136:139], v[28:31]
  ds_read_b128 v[120:123], v161 offset:896
  v_mfma_f32_16x16x32_bf16 v[4:7], v[64:67], v[132:135], v[4:7]
  ds_read_b64 v[60:61], v160 offset:3968
  v_mfma_f32_16x16x32_bf16 v[8:11], v[68:71], v[132:135], v[8:11]
  ds_read_b64 v[62:63], v160 offset:3976
  v_mfma_f32_16x16x32_bf16 v[12:15], v[72:75], v[132:135], v[12:15]
  ds_read_b128 v[124:127], v161 offset:384
  v_mfma_f32_16x16x32_bf16 v[16:19], v[76:79], v[132:135], v[16:19]
  v_mfma_f32_16x16x32_bf16 v[20:23], v[80:83], v[132:135], v[20:23]
  v_mfma_f32_16x16x32_bf16 v[24:27], v[84:87], v[132:135], v[24:27]
  v_mfma_f32_16x16x32_bf16 v[28:31], v[88:91], v[132:135], v[28:31]
  v_mfma_f32_16x16x32_bf16 v[0:3], v[64:67], v[128:131], v[0:3]
  v_mfma_f32_16x16x32_bf16 v[4:7], v[68:71], v[128:131], v[4:7]
  v_mfma_f32_16x16x32_bf16 v[8:11], v[72:75], v[128:131], v[8:11]
  v_mfma_f32_16x16x32_bf16 v[12:15], v[76:79], v[128:131], v[12:15]
  v_mfma_f32_16x16x32_bf16 v[16:19], v[80:83], v[128:131], v[16:19]
  v_mfma_f32_16x16x32_bf16 v[20:23], v[84:87], v[128:131], v[20:23]
  v_mfma_f32_16x16x32_bf16 v[24:27], v[88:91], v[128:131], v[24:27]
  v_mfma_f32_16x16x32_bf16 v[28:31], v[92:95], v[128:131], v[28:31]
  s_waitcnt lgkmcnt(0)
  v_mfma_f32_16x16x32_bf16 v[28:31], v[32:35], v[124:127], v[28:31]
  ds_read_b64 v[64:65], v160 offset:448
  v_mfma_f32_16x16x32_bf16 v[24:27], v[32:35], v[120:123], v[24:27]
  ds_read_b64 v[66:67], v160 offset:456
  v_mfma_f32_16x16x32_bf16 v[28:31], v[36:39], v[120:123], v[28:31]
  ds_read_b128 v[128:131], v161 offset:4032
  v_mfma_f32_16x16x32_bf16 v[20:23], v[32:35], v[116:119], v[20:23]
  ds_read_b64 v[68:69], v160 offset:960
  v_mfma_f32_16x16x32_bf16 v[24:27], v[36:39], v[116:119], v[24:27]
  ds_read_b64 v[70:71], v160 offset:968
  v_mfma_f32_16x16x32_bf16 v[28:31], v[40:43], v[116:119], v[28:31]
  ds_read_b128 v[132:135], v161 offset:3520
  v_mfma_f32_16x16x32_bf16 v[16:19], v[32:35], v[112:115], v[16:19]
  ds_read_b64 v[72:73], v160 offset:1472
  v_mfma_f32_16x16x32_bf16 v[20:23], v[36:39], v[112:115], v[20:23]
  ds_read_b64 v[74:75], v160 offset:1480
  v_mfma_f32_16x16x32_bf16 v[24:27], v[40:43], v[112:115], v[24:27]
  ds_read_b128 v[136:139], v161 offset:3008
  v_mfma_f32_16x16x32_bf16 v[28:31], v[44:47], v[112:115], v[28:31]
  ds_read_b64 v[76:77], v160 offset:1984
  v_mfma_f32_16x16x32_bf16 v[12:15], v[32:35], v[108:111], v[12:15]
  ds_read_b64 v[78:79], v160 offset:1992
  v_mfma_f32_16x16x32_bf16 v[16:19], v[36:39], v[108:111], v[16:19]
  ds_read_b128 v[140:143], v161 offset:2496
  v_mfma_f32_16x16x32_bf16 v[20:23], v[40:43], v[108:111], v[20:23]
  ds_read_b64 v[80:81], v160 offset:2496
  v_mfma_f32_16x16x32_bf16 v[24:27], v[44:47], v[108:111], v[24:27]
  ds_read_b64 v[82:83], v160 offset:2504
  v_mfma_f32_16x16x32_bf16 v[28:31], v[48:51], v[108:111], v[28:31]
  ds_read_b128 v[144:147], v161 offset:1984
  v_mfma_f32_16x16x32_bf16 v[8:11], v[32:35], v[104:107], v[8:11]
  ds_read_b64 v[84:85], v160 offset:3008
  v_mfma_f32_16x16x32_bf16 v[12:15], v[36:39], v[104:107], v[12:15]
  ds_read_b64 v[86:87], v160 offset:3016
  v_mfma_f32_16x16x32_bf16 v[16:19], v[40:43], v[104:107], v[16:19]
  ds_read_b128 v[148:151], v161 offset:1472
  v_mfma_f32_16x16x32_bf16 v[20:23], v[44:47], v[104:107], v[20:23]
  ds_read_b64 v[88:89], v160 offset:3520
  v_mfma_f32_16x16x32_bf16 v[24:27], v[48:51], v[104:107], v[24:27]
  ds_read_b64 v[90:91], v160 offset:3528
  v_mfma_f32_16x16x32_bf16 v[28:31], v[52:55], v[104:107], v[28:31]
  ds_read_b128 v[152:155], v161 offset:960
  v_mfma_f32_16x16x32_bf16 v[4:7], v[32:35], v[100:103], v[4:7]
  ds_read_b64 v[92:93], v160 offset:4032
  v_mfma_f32_16x16x32_bf16 v[8:11], v[36:39], v[100:103], v[8:11]
  ds_read_b64 v[94:95], v160 offset:4040
  v_mfma_f32_16x16x32_bf16 v[12:15], v[40:43], v[100:103], v[12:15]
  ds_read_b128 v[156:159], v161 offset:448
  v_mfma_f32_16x16x32_bf16 v[16:19], v[44:47], v[100:103], v[16:19]
  v_mfma_f32_16x16x32_bf16 v[20:23], v[48:51], v[100:103], v[20:23]
  v_mfma_f32_16x16x32_bf16 v[24:27], v[52:55], v[100:103], v[24:27]
  v_mfma_f32_16x16x32_bf16 v[28:31], v[56:59], v[100:103], v[28:31]
  v_mfma_f32_16x16x32_bf16 v[0:3], v[32:35], v[96:99], v[0:3]
  v_mfma_f32_16x16x32_bf16 v[4:7], v[36:39], v[96:99], v[4:7]
  v_mfma_f32_16x16x32_bf16 v[8:11], v[40:43], v[96:99], v[8:11]
  v_mfma_f32_16x16x32_bf16 v[12:15], v[44:47], v[96:99], v[12:15]
  v_mfma_f32_16x16x32_bf16 v[16:19], v[48:51], v[96:99], v[16:19]
  v_mfma_f32_16x16x32_bf16 v[20:23], v[52:55], v[96:99], v[20:23]
  v_mfma_f32_16x16x32_bf16 v[24:27], v[56:59], v[96:99], v[24:27]
  v_mfma_f32_16x16x32_bf16 v[28:31], v[60:63], v[96:99], v[28:31]
  s_waitcnt lgkmcnt(0)
  v_mfma_f32_16x16x32_bf16 v[28:31], v[64:67], v[156:159], v[28:31]
  ds_read_b64 v[32:33], v162 offset:3584
  v_mfma_f32_16x16x32_bf16 v[24:27], v[64:67], v[152:155], v[24:27]
  ds_read_b64 v[34:35], v162 offset:3072
  v_mfma_f32_16x16x32_bf16 v[28:31], v[68:71], v[152:155], v[28:31]
  ds_read_b64 v[36:37], v162 offset:2560
  v_mfma_f32_16x16x32_bf16 v[20:23], v[64:67], v[148:151], v[20:23]
  ds_read_b64 v[38:39], v162 offset:2048
  v_mfma_f32_16x16x32_bf16 v[24:27], v[68:71], v[148:151], v[24:27]
  ds_read_b64 v[40:41], v162 offset:1536
  v_mfma_f32_16x16x32_bf16 v[28:31], v[72:75], v[148:151], v[28:31]
  ds_read_b64 v[42:43], v162 offset:1024
  v_mfma_f32_16x16x32_bf16 v[16:19], v[64:67], v[144:147], v[16:19]
  ds_read_b64 v[44:45], v162 offset:512
  v_mfma_f32_16x16x32_bf16 v[20:23], v[68:71], v[144:147], v[20:23]
  ds_read_b64 v[46:47], v162 offset:0
  v_mfma_f32_16x16x32_bf16 v[24:27], v[72:75], v[144:147], v[24:27]
  v_mfma_f32_16x16x32_bf16 v[28:31], v[76:79], v[144:147], v[28:31]
  v_mfma_f32_16x16x32_bf16 v[12:15], v[64:67], v[140:143], v[12:15]
  v_mfma_f32_16x16x32_bf16 v[16:19], v[68:71], v[140:143], v[16:19]
  v_mfma_f32_16x16x32_bf16 v[20:23], v[72:75], v[140:143], v[20:23]
  v_mfma_f32_16x16x32_bf16 v[24:27], v[76:79], v[140:143], v[24:27]
  v_mfma_f32_16x16x32_bf16 v[28:31], v[80:83], v[140:143], v[28:31]
  v_mfma_f32_16x16x32_bf16 v[8:11], v[64:67], v[136:139], v[8:11]
  v_mfma_f32_16x16x32_bf16 v[12:15], v[68:71], v[136:139], v[12:15]
  v_mfma_f32_16x16x32_bf16 v[16:19], v[72:75], v[136:139], v[16:19]
  v_mfma_f32_16x16x32_bf16 v[20:23], v[76:79], v[136:139], v[20:23]
  v_mfma_f32_16x16x32_bf16 v[24:27], v[80:83], v[136:139], v[24:27]
  v_mfma_f32_16x16x32_bf16 v[28:31], v[84:87], v[136:139], v[28:31]
  v_mfma_f32_16x16x32_bf16 v[4:7], v[64:67], v[132:135], v[4:7]
  v_mfma_f32_16x16x32_bf16 v[8:11], v[68:71], v[132:135], v[8:11]
  v_mfma_f32_16x16x32_bf16 v[12:15], v[72:75], v[132:135], v[12:15]
  v_mfma_f32_16x16x32_bf16 v[16:19], v[76:79], v[132:135], v[16:19]
  v_mfma_f32_16x16x32_bf16 v[20:23], v[80:83], v[132:135], v[20:23]
  v_mfma_f32_16x16x32_bf16 v[24:27], v[84:87], v[132:135], v[24:27]
  v_mfma_f32_16x16x32_bf16 v[28:31], v[88:91], v[132:135], v[28:31]
  v_mfma_f32_16x16x32_bf16 v[0:3], v[64:67], v[128:131], v[0:3]
  v_mfma_f32_16x16x32_bf16 v[4:7], v[68:71], v[128:131], v[4:7]
  v_mfma_f32_16x16x32_bf16 v[8:11], v[72:75], v[128:131], v[8:11]
  v_mfma_f32_16x16x32_bf16 v[12:15], v[76:79], v[128:131], v[12:15]
  v_mfma_f32_16x16x32_bf16 v[16:19], v[80:83], v[128:131], v[16:19]
  v_mfma_f32_16x16x32_bf16 v[20:23], v[84:87], v[128:131], v[20:23]
  v_mfma_f32_16x16x32_bf16 v[24:27], v[88:91], v[128:131], v[24:27]
  v_mfma_f32_16x16x32_bf16 v[28:31], v[92:95], v[128:131], v[28:31]
  s_waitcnt lgkmcnt(0)
  s_and_b32 s31, s11, 1
  s_lshl_b32 s31, s31, 4
  s_lshr_b32 s30, s30, s31
  s_lshl_b32 s30, s30, 16
  s_mov_b32 s31, 0
  v_and_b32 v100, 0xffff0000, v33
  v_lshlrev_b32 v101, 16, v33
  v_and_b32 v102, 0xffff0000, v32
  v_lshlrev_b32 v103, 16, v32
  v_fmac_f32 v0, s30, v100
  v_fmac_f32 v1, s30, v101
  v_fmac_f32 v2, s30, v102
  v_fmac_f32 v3, s30, v103
  v_cvt_pk_bf16_f32 v104, v0, v1
  v_cvt_pk_bf16_f32 v105, v2, v3
  ds_write_b64 v163, v[104:105] offset:0
  v_and_b32 v100, 0xffff0000, v35
  v_lshlrev_b32 v101, 16, v35
  v_and_b32 v102, 0xffff0000, v34
  v_lshlrev_b32 v103, 16, v34
  v_fmac_f32 v4, s30, v100
  v_fmac_f32 v5, s30, v101
  v_fmac_f32 v6, s30, v102
  v_fmac_f32 v7, s30, v103
  v_cvt_pk_bf16_f32 v106, v4, v5
  v_cvt_pk_bf16_f32 v107, v6, v7
  ds_write_b64 v163, v[106:107] offset:512
  v_and_b32 v100, 0xffff0000, v37
  v_lshlrev_b32 v101, 16, v37
  v_and_b32 v102, 0xffff0000, v36
  v_lshlrev_b32 v103, 16, v36
  v_fmac_f32 v8, s30, v100
  v_fmac_f32 v9, s30, v101
  v_fmac_f32 v10, s30, v102
  v_fmac_f32 v11, s30, v103
  v_cvt_pk_bf16_f32 v108, v8, v9
  v_cvt_pk_bf16_f32 v109, v10, v11
  ds_write_b64 v163, v[108:109] offset:1024
  v_and_b32 v100, 0xffff0000, v39
  v_lshlrev_b32 v101, 16, v39
  v_and_b32 v102, 0xffff0000, v38
  v_lshlrev_b32 v103, 16, v38
  v_fmac_f32 v12, s30, v100
  v_fmac_f32 v13, s30, v101
  v_fmac_f32 v14, s30, v102
  v_fmac_f32 v15, s30, v103
  v_cvt_pk_bf16_f32 v110, v12, v13
  v_cvt_pk_bf16_f32 v111, v14, v15
  ds_write_b64 v163, v[110:111] offset:1536
  v_and_b32 v100, 0xffff0000, v41
  v_lshlrev_b32 v101, 16, v41
  v_and_b32 v102, 0xffff0000, v40
  v_lshlrev_b32 v103, 16, v40
  v_fmac_f32 v16, s30, v100
  v_fmac_f32 v17, s30, v101
  v_fmac_f32 v18, s30, v102
  v_fmac_f32 v19, s30, v103
  v_cvt_pk_bf16_f32 v112, v16, v17
  v_cvt_pk_bf16_f32 v113, v18, v19
  ds_write_b64 v163, v[112:113] offset:2048
  v_and_b32 v100, 0xffff0000, v43
  v_lshlrev_b32 v101, 16, v43
  v_and_b32 v102, 0xffff0000, v42
  v_lshlrev_b32 v103, 16, v42
  v_fmac_f32 v20, s30, v100
  v_fmac_f32 v21, s30, v101
  v_fmac_f32 v22, s30, v102
  v_fmac_f32 v23, s30, v103
  v_cvt_pk_bf16_f32 v114, v20, v21
  v_cvt_pk_bf16_f32 v115, v22, v23
  ds_write_b64 v163, v[114:115] offset:2560
  v_and_b32 v100, 0xffff0000, v45
  v_lshlrev_b32 v101, 16, v45
  v_and_b32 v102, 0xffff0000, v44
  v_lshlrev_b32 v103, 16, v44
  v_fmac_f32 v24, s30, v100
  v_fmac_f32 v25, s30, v101
  v_fmac_f32 v26, s30, v102
  v_fmac_f32 v27, s30, v103
  v_cvt_pk_bf16_f32 v116, v24, v25
  v_cvt_pk_bf16_f32 v117, v26, v27
  ds_write_b64 v163, v[116:117] offset:3072
  v_and_b32 v100, 0xffff0000, v47
  v_lshlrev_b32 v101, 16, v47
  v_and_b32 v102, 0xffff0000, v46
  v_lshlrev_b32 v103, 16, v46
  v_fmac_f32 v28, s30, v100
  v_fmac_f32 v29, s30, v101
  v_fmac_f32 v30, s30, v102
  v_fmac_f32 v31, s30, v103
  v_cvt_pk_bf16_f32 v118, v28, v29
  v_cvt_pk_bf16_f32 v119, v30, v31
  ds_write_b64 v163, v[118:119] offset:3584
  s_waitcnt vmcnt(0) lgkmcnt(0)
  s_barrier
  ds_read_b64_tr_b16 v[32:33], v164 offset:0
  ds_read_b64_tr_b16 v[34:35], v164 offset:128
  ds_read_b64_tr_b16 v[36:37], v164 offset:256
  ds_read_b64_tr_b16 v[38:39], v164 offset:384
  ds_read_b64_tr_b16 v[40:41], v164 offset:512
  ds_read_b64_tr_b16 v[42:43], v164 offset:640
  ds_read_b64_tr_b16 v[44:45], v164 offset:768
  ds_read_b64_tr_b16 v[46:47], v164 offset:896
  s_lshr_b32 s31, s11, 2
  s_lshl_b32 s31, s31, 14
  s_waitcnt lgkmcnt(7)
  buffer_store_dwordx2 v[32:33], v165, s[24:27], s31 offen offset:0 sc1
  s_waitcnt lgkmcnt(6)
  buffer_store_dwordx2 v[34:35], v165, s[24:27], s31 offen offset:512 sc1
  s_waitcnt lgkmcnt(5)
  buffer_store_dwordx2 v[36:37], v165, s[24:27], s31 offen offset:1024 sc1
  s_waitcnt lgkmcnt(4)
  buffer_store_dwordx2 v[38:39], v165, s[24:27], s31 offen offset:1536 sc1
  s_waitcnt lgkmcnt(3)
  buffer_store_dwordx2 v[40:41], v165, s[24:27], s31 offen offset:2048 sc1
  s_waitcnt lgkmcnt(2)
  buffer_store_dwordx2 v[42:43], v165, s[24:27], s31 offen offset:2560 sc1
  s_waitcnt lgkmcnt(1)
  buffer_store_dwordx2 v[44:45], v165, s[24:27], s31 offen offset:3072 sc1
  s_waitcnt lgkmcnt(0)
  buffer_store_dwordx2 v[46:47], v165, s[24:27], s31 offen offset:3584 sc1
  v_and_b32 v5, 31, v185
  v_lshlrev_b32 v5, 3, v5
  v_add_u32 v5, 107520, v5
  ds_read_b64 v[78:79], v5 offset:2304
  ds_read_b64 v[80:81], v5 offset:2560
  ds_read_b64 v[82:83], v5 offset:2816
  ds_read_b64 v[84:85], v5 offset:3072
  ds_read_b64 v[86:87], v5 offset:3328
  ds_read_b64 v[88:89], v5 offset:3584
  ds_read_b64 v[90:91], v5 offset:3840
  ds_read_b64 v[92:93], v5 offset:4096
  ds_read_b64 v[94:95], v5 offset:4352
  ds_read_b64 v[60:61], v5 offset:0
  ds_read_b64 v[62:63], v5 offset:256
  ds_read_b64 v[64:65], v5 offset:512
  ds_read_b64 v[66:67], v5 offset:768
  ds_read_b64 v[68:69], v5 offset:1024
  ds_read_b64 v[70:71], v5 offset:1280
  ds_read_b64 v[72:73], v5 offset:1536
  ds_read_b64 v[74:75], v5 offset:1792
  ds_read_b64 v[76:77], v5 offset:2048
  ds_read_b64 v[96:97], v5 offset:4608
  ds_read_b64 v[98:99], v5 offset:4864
  ds_read_b64 v[100:101], v5 offset:5120
  ds_read_b64 v[102:103], v5 offset:5376
  ds_read_b64 v[104:105], v5 offset:5632
  ds_read_b64 v[106:107], v5 offset:5888
  ds_read_b64 v[108:109], v5 offset:6144
  ds_read_b64 v[110:111], v5 offset:6400
  ds_read_b64 v[112:113], v5 offset:6656
  v_lshlrev_b32 v32, 16, v176
  v_and_b32 v33, 0xffff0000, v176
  v_lshlrev_b32 v34, 16, v177
  v_and_b32 v35, 0xffff0000, v177
  v_lshlrev_b32 v36, 16, v178
  v_and_b32 v37, 0xffff0000, v178
  v_lshlrev_b32 v38, 16, v179
  v_and_b32 v39, 0xffff0000, v179
  v_lshlrev_b32 v40, 16, v180
  v_and_b32 v41, 0xffff0000, v180
  v_lshlrev_b32 v42, 16, v181
  v_and_b32 v43, 0xffff0000, v181
  v_lshlrev_b32 v44, 16, v182
  v_and_b32 v45, 0xffff0000, v182
  v_lshlrev_b32 v46, 16, v183
  v_and_b32 v47, 0xffff0000, v183
  v_lshlrev_b32 v48, 16, v184
  v_and_b32 v49, 0xffff0000, v184
  v_pk_add_f32 v[180:181], v[32:33], v[34:35]
  v_pk_mul_f32 v[182:183], v[32:33], v[32:33]
  v_pk_fma_f32 v[182:183], v[34:35], v[34:35], v[182:183]
  v_pk_add_f32 v[180:181], v[180:181], v[36:37]
  v_pk_fma_f32 v[182:183], v[36:37], v[36:37], v[182:183]
  v_pk_add_f32 v[180:181], v[180:181], v[38:39]
  v_pk_fma_f32 v[182:183], v[38:39], v[38:39], v[182:183]
  v_pk_add_f32 v[180:181], v[180:181], v[40:41]
  v_pk_fma_f32 v[182:183], v[40:41], v[40:41], v[182:183]
  v_pk_add_f32 v[180:181], v[180:181], v[42:43]
  v_pk_fma_f32 v[182:183], v[42:43], v[42:43], v[182:183]
  v_pk_add_f32 v[180:181], v[180:181], v[44:45]
  v_pk_fma_f32 v[182:183], v[44:45], v[44:45], v[182:183]
  v_pk_add_f32 v[180:181], v[180:181], v[46:47]
  v_pk_fma_f32 v[182:183], v[46:47], v[46:47], v[182:183]
  v_pk_add_f32 v[180:181], v[180:181], v[48:49]
  v_pk_fma_f32 v[182:183], v[48:49], v[48:49], v[182:183]
  v_add_f32 v172, v180, v181
  v_add_f32 v173, v182, v183
  s_nop 0
  v_add_f32_dpp v172, v172, v172 quad_perm:[1,0,3,2] row_mask:0xf bank_mask:0xf
  v_add_f32_dpp v173, v173, v173 quad_perm:[1,0,3,2] row_mask:0xf bank_mask:0xf
  s_nop 0
  v_add_f32_dpp v172, v172, v172 quad_perm:[2,3,0,1] row_mask:0xf bank_mask:0xf
  v_add_f32_dpp v173, v173, v173 quad_perm:[2,3,0,1] row_mask:0xf bank_mask:0xf
  s_nop 0
  v_add_f32_dpp v172, v172, v172 row_half_mirror row_mask:0xf bank_mask:0xf
  v_add_f32_dpp v173, v173, v173 row_half_mirror row_mask:0xf bank_mask:0xf
  s_nop 0
  v_add_f32_dpp v172, v172, v172 row_mirror row_mask:0xf bank_mask:0xf
  v_add_f32_dpp v173, v173, v173 row_mirror row_mask:0xf bank_mask:0xf
  v_mov_b32 v174, v172
  v_mov_b32 v175, v173
  s_nop 0
  v_permlane16_swap_b32 v172, v174
  v_permlane16_swap_b32 v173, v175
  v_add_f32 v172, v172, v174
  v_add_f32 v173, v173, v175
  v_mul_f32 v172, 0x3ae38e39, v172
  v_mul_f32 v173, 0x3ae38e39, v173
  v_fma_f32 v173, -v172, v172, v173
  v_max_f32 v173, 0, v173
  v_add_f32 v173, 0x3727c5ac, v173
  v_rsq_f32 v178, v173
  s_nop 0
  v_mul_f32 v176, v172, v178
  v_sub_f32 v176, 0, v176
  s_waitcnt lgkmcnt(0)
  ds_read_b64 v[132:133], v5 offset:9216
  ds_read_b64 v[134:135], v5 offset:9472
  ds_read_b64 v[136:137], v5 offset:9728
  ds_read_b64 v[138:139], v5 offset:9984
  ds_read_b64 v[140:141], v5 offset:10240
  ds_read_b64 v[142:143], v5 offset:10496
  ds_read_b64 v[144:145], v5 offset:10752
  ds_read_b64 v[146:147], v5 offset:11008
  ds_read_b64 v[148:149], v5 offset:11264
  ds_read_b64 v[114:115], v5 offset:6912
  ds_read_b64 v[116:117], v5 offset:7168
  ds_read_b64 v[118:119], v5 offset:7424
  ds_read_b64 v[120:121], v5 offset:7680
  ds_read_b64 v[122:123], v5 offset:7936
  ds_read_b64 v[124:125], v5 offset:8192
  ds_read_b64 v[126:127], v5 offset:8448
  ds_read_b64 v[128:129], v5 offset:8704
  ds_read_b64 v[130:131], v5 offset:8960
  v_pk_fma_f32 v[182:183], v[32:33], v[178:179], v[176:177] op_sel_hi:[1,0,0]
  v_pk_fma_f32 v[182:183], v[182:183], v[78:79], v[60:61]
  v_pk_mul_f32 v[78:79], v[96:97], v[182:183]
  v_pk_fma_f32 v[182:183], v[34:35], v[178:179], v[176:177] op_sel_hi:[1,0,0]
  v_pk_fma_f32 v[182:183], v[182:183], v[80:81], v[62:63]
  v_pk_mul_f32 v[80:81], v[98:99], v[182:183]
  v_pk_fma_f32 v[182:183], v[36:37], v[178:179], v[176:177] op_sel_hi:[1,0,0]
  v_pk_fma_f32 v[182:183], v[182:183], v[82:83], v[64:65]
  v_pk_mul_f32 v[82:83], v[100:101], v[182:183]
  v_pk_fma_f32 v[182:183], v[38:39], v[178:179], v[176:177] op_sel_hi:[1,0,0]
  v_pk_fma_f32 v[182:183], v[182:183], v[84:85], v[66:67]
  v_pk_mul_f32 v[84:85], v[102:103], v[182:183]
  v_pk_fma_f32 v[182:183], v[40:41], v[178:179], v[176:177] op_sel_hi:[1,0,0]
  v_pk_fma_f32 v[182:183], v[182:183], v[86:87], v[68:69]
  v_pk_mul_f32 v[86:87], v[104:105], v[182:183]
  v_pk_fma_f32 v[182:183], v[42:43], v[178:179], v[176:177] op_sel_hi:[1,0,0]
  v_pk_fma_f32 v[182:183], v[182:183], v[88:89], v[70:71]
  v_pk_mul_f32 v[88:89], v[106:107], v[182:183]
  v_pk_fma_f32 v[182:183], v[44:45], v[178:179], v[176:177] op_sel_hi:[1,0,0]
  v_pk_fma_f32 v[182:183], v[182:183], v[90:91], v[72:73]
  v_pk_mul_f32 v[90:91], v[108:109], v[182:183]
  v_pk_fma_f32 v[182:183], v[46:47], v[178:179], v[176:177] op_sel_hi:[1,0,0]
  v_pk_fma_f32 v[182:183], v[182:183], v[92:93], v[74:75]
  v_pk_mul_f32 v[92:93], v[110:111], v[182:183]
  v_pk_fma_f32 v[182:183], v[48:49], v[178:179], v[176:177] op_sel_hi:[1,0,0]
  v_pk_fma_f32 v[182:183], v[182:183], v[94:95], v[76:77]
  v_pk_mul_f32 v[94:95], v[112:113], v[182:183]
  s_waitcnt lgkmcnt(0)
  s_waitcnt vmcnt(0)
  s_barrier
  s_cmp_lg_u32 s10, 0
  s_cbranch_scc1 fstart_m_kernel
  s_add_u32 s32, s8, 0x904000
  s_addc_u32 s33, s9, 0
  s_and_b32 s31, s2, 7
  v_and_b32 v2, 63, v237
  v_lshlrev_b32 v4, 3, v2
  v_add_u32 v4, s31, v4
  v_lshrrev_b32 v5, 1, v4
  v_lshlrev_b32 v5, 10, v5
  v_and_b32 v6, 1, v4
  v_lshl_add_u32 v5, v6, 8, v5
  v_add_u32 v5, 256, v5
  v_mov_b32 v6, 1
  s_mov_b64 exec, 255
  global_atomic_add v5, v6, s[32:33]
  s_mov_b64 exec, -1
  s_branch fstart_m_kernel
pf_m_kernel:
  s_getpc_b64 s[36:37]
pc1018_m_kernel:
  s_sub_u32 s36, s36, pc1018_m_kernel-m_kernel
  s_subb_u32 s37, s37, 0
  s_mov_b32 s38, m_kernel_codeend-m_kernel
  s_mov_b32 s39, 0x20000
  v_lshlrev_b32 v20, 7, v0
  buffer_load_dword v21, v20, s[36:39], 0 offen
  v_add_u32 v20, 0x8000, v20
  buffer_load_dword v21, v20, s[36:39], 0 offen
  s_load_dwordx2 s[4:5], s[0:1], 0
  s_load_dwordx4 s[8:11], s[0:1], 56
  s_and_b32 s12, s2, 7
  s_sub_u32 s13, s2, 144
  s_lshr_b32 s13, s13, 3
  s_lshl_b32 s13, s13, 8
  v_add_u32 v1, s13, v0
  s_mov_b32 s14, 0x1c71c71d
  s_movk_i32 s33, 9216
  s_waitcnt lgkmcnt(0)
  s_mov_b32 s16, s4
  s_mov_b32 s17, s5
  s_mov_b32 s18, 0x240000
  s_mov_b32 s19, 0x20000
  s_mov_b32 s20, s8
  s_mov_b32 s21, s9
  s_mov_b32 s22, 0x510000
  s_mov_b32 s23, 0x20000
  s_mov_b32 s24, s10
  s_mov_b32 s25, s11
  s_mov_b32 s26, 0x510000
  s_mov_b32 s27, 0x20000
  v_mul_hi_u32 v2, v1, s14
  v_mul_u32_u24 v3, 9, v2
  v_sub_u32 v3, v1, v3
  v_lshrrev_b32 v4, 3, v2
  v_and_b32 v5, 7, v2
  v_lshlrev_b32 v4, 6, v4
  s_lshl_b32 s15, s12, 3
  v_add3_u32 v4, v4, v5, s15
  v_mul_u32_u24 v4, 1152, v4
  v_lshl_add_u32 v4, v3, 7, v4
  v_mov_b32 v6, 0x7ff00000
  v_cmp_gt_u32 vcc, 2304, v1
  s_nop 1
  v_cndmask_b32 v4, v6, v4, vcc
  buffer_load_dword v10, v4, s[16:19], 0 offen
  s_mul_i32 s15, s12, 1152
  s_waitcnt vmcnt(0)
  v_mov_b32 v6, 0x7ff00000
  v_lshrrev_b32 v2, 2, v1
  v_and_b32 v3, 3, v1
  v_lshlrev_b32 v3, 8, v3
  v_cmp_gt_u32 vcc, 576, v2
  v_subrev_u32 v5, 576, v2
  s_nop 0
  v_cndmask_b32 v5, v5, v2, vcc
  v_add_u32 v7, 128, v3
  v_cndmask_b32 v3, v7, v3, vcc
  v_mad_u32_u24 v4, v5, s33, v3
  v_cmp_gt_u32 vcc, 3072, v1
  s_nop 1
  v_cndmask_b32 v4, v6, v4, vcc
  buffer_load_dword v11, v4, s[20:23], s15 offen
  buffer_load_dword v12, v4, s[24:27], s15 offen
  v_lshrrev_b32 v2, 2, v1
  v_add_u32 v2, 192, v2
  v_and_b32 v3, 3, v1
  v_lshlrev_b32 v3, 8, v3
  v_add_u32 v3, 128, v3
  v_mad_u32_u24 v4, v2, s33, v3
  v_subrev_u32 v2, 1536, v1
  v_mov_b32 v3, 1024
  v_mad_u32_u24 v5, v2, s33, v3
  v_cmp_gt_u32 vcc, 1536, v1
  s_nop 1
  v_cndmask_b32 v4, v5, v4, vcc
  v_cmp_gt_u32 vcc, 2112, v1
  s_nop 1
  v_cndmask_b32 v4, v6, v4, vcc
  buffer_load_dword v13, v4, s[20:23], s15 offen
  buffer_load_dword v14, v4, s[24:27], s15 offen
  s_waitcnt vmcnt(0)
  s_load_dwordx2 s[8:9], s[0:1], 112
  v_lshrrev_b32 v1, 6, v237
  v_and_b32 v185, 63, v237
  v_readfirstlane_b32 s10, v1
  s_waitcnt lgkmcnt(0)
  s_mov_b32 s56, s4
  s_mov_b32 s57, s5
  s_mov_b32 s58, 0x240000
  s_mov_b32 s59, 0x20000
  s_add_u32 s60, s8, 0x900000
  s_addc_u32 s61, s9, 0
  s_mov_b32 s62, 0x2d00
  s_mov_b32 s63, 0x20000
  v_lshrrev_b32 v186, 5, v185
  s_lshl_b32 s64, s10, 1
  v_add_u32 v186, s64, v186
  v_and_b32 v187, 31, v185
  v_mul_u32_u24 v186, 1152, v186
  v_lshl_add_u32 v186, v187, 2, v186
  s_mul_i32 s64, s2, 9216
  buffer_load_dword v176, v186, s[56:59], s64 offen offset:0
  buffer_load_dword v177, v186, s[56:59], s64 offen offset:128
  buffer_load_dword v178, v186, s[56:59], s64 offen offset:256
  buffer_load_dword v179, v186, s[56:59], s64 offen offset:384
  buffer_load_dword v180, v186, s[56:59], s64 offen offset:512
  buffer_load_dword v181, v186, s[56:59], s64 offen offset:640
  buffer_load_dword v182, v186, s[56:59], s64 offen offset:768
  buffer_load_dword v183, v186, s[56:59], s64 offen offset:896
  buffer_load_dword v184, v186, s[56:59], s64 offen offset:1024
  v_lshlrev_b32 v188, 4, v185
  s_mul_i32 s64, s10, 3072
  s_add_u32 s65, s64, 0
  s_add_u32 m0, s64, 107520
  s_nop 0
  buffer_load_dwordx4 v188, s[60:63], s65 offen lds
  s_mul_i32 s64, s10, 3072
  s_add_u32 s65, s64, 1024
  s_add_u32 m0, s64, 108544
  s_nop 0
  buffer_load_dwordx4 v188, s[60:63], s65 offen lds
  s_mul_i32 s64, s10, 3072
  s_add_u32 s65, s64, 2048
  s_add_u32 m0, s64, 109568
  s_nop 0
  buffer_load_dwordx4 v188, s[60:63], s65 offen lds
  s_waitcnt vmcnt(0)
  s_barrier
  v_and_b32 v5, 31, v185
  v_lshlrev_b32 v5, 3, v5
  v_add_u32 v5, 107520, v5
  ds_read_b64 v[78:79], v5 offset:2304
  ds_read_b64 v[80:81], v5 offset:2560
  ds_read_b64 v[82:83], v5 offset:2816
  ds_read_b64 v[84:85], v5 offset:3072
  ds_read_b64 v[86:87], v5 offset:3328
  ds_read_b64 v[88:89], v5 offset:3584
  ds_read_b64 v[90:91], v5 offset:3840
  ds_read_b64 v[92:93], v5 offset:4096
  ds_read_b64 v[94:95], v5 offset:4352
  ds_read_b64 v[60:61], v5 offset:0
  ds_read_b64 v[62:63], v5 offset:256
  ds_read_b64 v[64:65], v5 offset:512
  ds_read_b64 v[66:67], v5 offset:768
  ds_read_b64 v[68:69], v5 offset:1024
  ds_read_b64 v[70:71], v5 offset:1280
  ds_read_b64 v[72:73], v5 offset:1536
  ds_read_b64 v[74:75], v5 offset:1792
  ds_read_b64 v[76:77], v5 offset:2048
  ds_read_b64 v[96:97], v5 offset:4608
  ds_read_b64 v[98:99], v5 offset:4864
  ds_read_b64 v[100:101], v5 offset:5120
  ds_read_b64 v[102:103], v5 offset:5376
  ds_read_b64 v[104:105], v5 offset:5632
  ds_read_b64 v[106:107], v5 offset:5888
  ds_read_b64 v[108:109], v5 offset:6144
  ds_read_b64 v[110:111], v5 offset:6400
  ds_read_b64 v[112:113], v5 offset:6656
  v_lshlrev_b32 v32, 16, v176
  v_and_b32 v33, 0xffff0000, v176
  v_lshlrev_b32 v34, 16, v177
  v_and_b32 v35, 0xffff0000, v177
  v_lshlrev_b32 v36, 16, v178
  v_and_b32 v37, 0xffff0000, v178
  v_lshlrev_b32 v38, 16, v179
  v_and_b32 v39, 0xffff0000, v179
  v_lshlrev_b32 v40, 16, v180
  v_and_b32 v41, 0xffff0000, v180
  v_lshlrev_b32 v42, 16, v181
  v_and_b32 v43, 0xffff0000, v181
  v_lshlrev_b32 v44, 16, v182
  v_and_b32 v45, 0xffff0000, v182
  v_lshlrev_b32 v46, 16, v183
  v_and_b32 v47, 0xffff0000, v183
  v_lshlrev_b32 v48, 16, v184
  v_and_b32 v49, 0xffff0000, v184
  v_pk_add_f32 v[180:181], v[32:33], v[34:35]
  v_pk_mul_f32 v[182:183], v[32:33], v[32:33]
  v_pk_fma_f32 v[182:183], v[34:35], v[34:35], v[182:183]
  v_pk_add_f32 v[180:181], v[180:181], v[36:37]
  v_pk_fma_f32 v[182:183], v[36:37], v[36:37], v[182:183]
  v_pk_add_f32 v[180:181], v[180:181], v[38:39]
  v_pk_fma_f32 v[182:183], v[38:39], v[38:39], v[182:183]
  v_pk_add_f32 v[180:181], v[180:181], v[40:41]
  v_pk_fma_f32 v[182:183], v[40:41], v[40:41], v[182:183]
  v_pk_add_f32 v[180:181], v[180:181], v[42:43]
  v_pk_fma_f32 v[182:183], v[42:43], v[42:43], v[182:183]
  v_pk_add_f32 v[180:181], v[180:181], v[44:45]
  v_pk_fma_f32 v[182:183], v[44:45], v[44:45], v[182:183]
  v_pk_add_f32 v[180:181], v[180:181], v[46:47]
  v_pk_fma_f32 v[182:183], v[46:47], v[46:47], v[182:183]
  v_pk_add_f32 v[180:181], v[180:181], v[48:49]
  v_pk_fma_f32 v[182:183], v[48:49], v[48:49], v[182:183]
  v_add_f32 v172, v180, v181
  v_add_f32 v173, v182, v183
  s_nop 0
  v_add_f32_dpp v172, v172, v172 quad_perm:[1,0,3,2] row_mask:0xf bank_mask:0xf
  v_add_f32_dpp v173, v173, v173 quad_perm:[1,0,3,2] row_mask:0xf bank_mask:0xf
  s_nop 0
  v_add_f32_dpp v172, v172, v172 quad_perm:[2,3,0,1] row_mask:0xf bank_mask:0xf
  v_add_f32_dpp v173, v173, v173 quad_perm:[2,3,0,1] row_mask:0xf bank_mask:0xf
  s_nop 0
  v_add_f32_dpp v172, v172, v172 row_half_mirror row_mask:0xf bank_mask:0xf
  v_add_f32_dpp v173, v173, v173 row_half_mirror row_mask:0xf bank_mask:0xf
  s_nop 0
  v_add_f32_dpp v172, v172, v172 row_mirror row_mask:0xf bank_mask:0xf
  v_add_f32_dpp v173, v173, v173 row_mirror row_mask:0xf bank_mask:0xf
  v_mov_b32 v174, v172
  v_mov_b32 v175, v173
  s_nop 0
  v_permlane16_swap_b32 v172, v174
  v_permlane16_swap_b32 v173, v175
  v_add_f32 v172, v172, v174
  v_add_f32 v173, v173, v175
  v_mul_f32 v172, 0x3ae38e39, v172
  v_mul_f32 v173, 0x3ae38e39, v173
  v_fma_f32 v173, -v172, v172, v173
  v_max_f32 v173, 0, v173
  v_add_f32 v173, 0x3727c5ac, v173
  v_rsq_f32 v178, v173
  s_nop 0
  v_mul_f32 v176, v172, v178
  v_sub_f32 v176, 0, v176
  s_waitcnt lgkmcnt(0)
  ds_read_b64 v[132:133], v5 offset:9216
  ds_read_b64 v[134:135], v5 offset:9472
  ds_read_b64 v[136:137], v5 offset:9728
  ds_read_b64 v[138:139], v5 offset:9984
  ds_read_b64 v[140:141], v5 offset:10240
  ds_read_b64 v[142:143], v5 offset:10496
  ds_read_b64 v[144:145], v5 offset:10752
  ds_read_b64 v[146:147], v5 offset:11008
  ds_read_b64 v[148:149], v5 offset:11264
  ds_read_b64 v[114:115], v5 offset:6912
  ds_read_b64 v[116:117], v5 offset:7168
  ds_read_b64 v[118:119], v5 offset:7424
  ds_read_b64 v[120:121], v5 offset:7680
  ds_read_b64 v[122:123], v5 offset:7936
  ds_read_b64 v[124:125], v5 offset:8192
  ds_read_b64 v[126:127], v5 offset:8448
  ds_read_b64 v[128:129], v5 offset:8704
  ds_read_b64 v[130:131], v5 offset:8960
  v_pk_fma_f32 v[182:183], v[32:33], v[178:179], v[176:177] op_sel_hi:[1,0,0]
  v_pk_fma_f32 v[182:183], v[182:183], v[78:79], v[60:61]
  v_pk_mul_f32 v[78:79], v[96:97], v[182:183]
  v_pk_fma_f32 v[182:183], v[34:35], v[178:179], v[176:177] op_sel_hi:[1,0,0]
  v_pk_fma_f32 v[182:183], v[182:183], v[80:81], v[62:63]
  v_pk_mul_f32 v[80:81], v[98:99], v[182:183]
  v_pk_fma_f32 v[182:183], v[36:37], v[178:179], v[176:177] op_sel_hi:[1,0,0]
  v_pk_fma_f32 v[182:183], v[182:183], v[82:83], v[64:65]
  v_pk_mul_f32 v[82:83], v[100:101], v[182:183]
  v_pk_fma_f32 v[182:183], v[38:39], v[178:179], v[176:177] op_sel_hi:[1,0,0]
  v_pk_fma_f32 v[182:183], v[182:183], v[84:85], v[66:67]
  v_pk_mul_f32 v[84:85], v[102:103], v[182:183]
  v_pk_fma_f32 v[182:183], v[40:41], v[178:179], v[176:177] op_sel_hi:[1,0,0]
  v_pk_fma_f32 v[182:183], v[182:183], v[86:87], v[68:69]
  v_pk_mul_f32 v[86:87], v[104:105], v[182:183]
  v_pk_fma_f32 v[182:183], v[42:43], v[178:179], v[176:177] op_sel_hi:[1,0,0]
  v_pk_fma_f32 v[182:183], v[182:183], v[88:89], v[70:71]
  v_pk_mul_f32 v[88:89], v[106:107], v[182:183]
  v_pk_fma_f32 v[182:183], v[44:45], v[178:179], v[176:177] op_sel_hi:[1,0,0]
  v_pk_fma_f32 v[182:183], v[182:183], v[90:91], v[72:73]
  v_pk_mul_f32 v[90:91], v[108:109], v[182:183]
  v_pk_fma_f32 v[182:183], v[46:47], v[178:179], v[176:177] op_sel_hi:[1,0,0]
  v_pk_fma_f32 v[182:183], v[182:183], v[92:93], v[74:75]
  v_pk_mul_f32 v[92:93], v[110:111], v[182:183]
  v_pk_fma_f32 v[182:183], v[48:49], v[178:179], v[176:177] op_sel_hi:[1,0,0]
  v_pk_fma_f32 v[182:183], v[182:183], v[94:95], v[76:77]
  v_pk_mul_f32 v[94:95], v[112:113], v[182:183]
  s_waitcnt lgkmcnt(0)
fstart_m_kernel:
  v_mov_b32 v0, v237
  s_load_dwordx4 s[4:7], s[0:1], 56
  s_load_dwordx2 s[36:37], s[0:1], 112
  s_load_dwordx2 s[52:53], s[0:1], 72
  s_load_dwordx2 s[54:55], s[0:1], 0
  v_lshrrev_b32 v215, 6, v0
  v_and_b32 v216, 63, v0
  v_readfirstlane_b32 s38, v215
  s_waitcnt lgkmcnt(0)
  s_mov_b32 s70, s4
  s_mov_b32 s71, s5
  s_mov_b32 s8, s6
  s_mov_b32 s9, s7
  s_mov_b32 s24, s52
  s_mov_b32 s25, s53
  s_mov_b32 s26, 0x510000
  s_mov_b32 s27, 0x20000
  s_mov_b32 s60, s54
  s_mov_b32 s61, s55
  s_mov_b32 s62, 0x240000
  s_mov_b32 s63, 0x20000
  s_add_u32 s64, s36, 0x240000
  s_addc_u32 s65, s37, 0
  s_mov_b32 s66, 0x240000
  s_mov_b32 s67, 0x20000
  s_add_u32 s12, s36, 0x900000
  s_addc_u32 s13, s37, 0
  s_mov_b32 s14, 0x2d00
  s_mov_b32 s15, 0x20000
  s_add_u32 s4, s36, 0x480000
  s_addc_u32 s5, s37, 0
  s_mov_b32 s6, 0x240000
  s_mov_b32 s7, 0x20000
  s_add_u32 s52, s36, 0x904000
  s_addc_u32 s53, s37, 0
  s_mul_i32 s54, s2, 9216
  v_lshrrev_b32 v1, 5, v216
  s_lshl_b32 s55, s38, 1
  v_add_u32 v1, s55, v1
  v_and_b32 v2, 31, v216
  v_mul_u32_u24 v3, 1152, v1
  v_lshl_add_u32 v3, v2, 2, v3
  v_lshlrev_b32 v5, 4, v216
  s_mul_i32 s68, s38, 3072
  s_lshr_b32 s40, s2, 3
  s_and_b32 s41, s40, 3
  s_bfe_u32 s39, s40, 0x10002
  s_and_b32 s42, s2, 6
  s_add_u32 s39, s39, s42
  s_lshr_b32 s40, s40, 3
  s_and_b32 s42, s2, 1
  s_lshl_b32 s42, s42, 2
  s_add_u32 s40, s40, s42
  s_lshr_b32 s45, s38, 1
  s_and_b32 s44, s38, 1
  s_mul_i32 s42, s39, 1152
  s_lshl_b32 s43, s41, 8
  s_add_u32 s28, s42, s43
  s_mul_i32 s43, s44, 73728
  s_add_u32 s28, s28, s43
  s_lshl_b32 s43, s45, 11
  s_lshl_b32 s46, s44, 10
  s_add_u32 s29, s43, s46
  v_lshrrev_b32 v217, 3, v216
  v_mul_u32_u24 v217, 9216, v217
  v_bfe_u32 v218, v216, 4, 1
  s_lshl_b32 s47, s45, 1
  v_or_b32 v218, s47, v218
  v_bfe_u32 v219, v216, 1, 2
  v_xor_b32 v218, v218, v219
  v_lshl_add_u32 v217, v218, 5, v217
  v_and_b32 v219, 1, v216
  v_lshl_add_u32 v206, v219, 4, v217
  s_waitcnt lgkmcnt(0)
  s_cmp_lt_u32 s2, 128
  s_cselect_b32 s56, s70, s8
  s_cselect_b32 s57, s71, s9
  s_mov_b32 s58, 5308416
  s_mov_b32 s59, 0x20000
  s_cmp_eq_u32 s45, 0
  s_cselect_b32 s8, s70, s8
  s_cselect_b32 s9, s71, s9
  s_mov_b32 s10, 5308416
  s_mov_b32 s11, 0x20000
  s_add_u32 s16, s36, 0x6c0000
  s_addc_u32 s17, s37, 0
  s_mov_b32 s18, 0x240000
  s_mov_b32 s19, 0x20000
  s_add_u32 s20, s36, 0x910000
  s_addc_u32 s21, s37, 0
  s_mov_b32 s22, 0x1200000
  s_mov_b32 s23, 0x20000
  s_lshr_b32 s71, s2, 3
  s_or_b32 s71, s71, s38
  v_and_b32 v6, 3, v0
  v_mul_u32_u24 v6, 2304, v6
  v_lshrrev_b32 v7, 2, v0
  v_lshl_add_u32 v6, v7, 3, v6
  v_add_u32 v6, 98304, v6
  v_add_u32 v7, 98304, v3
  s_add_u32 m0, s29, 0
  s_add_u32 s33, s28, 0
  buffer_load_dwordx4 v206, s[8:11], s33 offen lds
  s_add_u32 m0, s29, 4096
  s_add_u32 s33, s28, 147456
  buffer_load_dwordx4 v206, s[8:11], s33 offen lds
  s_add_u32 m0, s29, 8192
  s_add_u32 s33, s28, 294912
  buffer_load_dwordx4 v206, s[8:11], s33 offen lds
  s_add_u32 m0, s29, 12288
  s_add_u32 s33, s28, 442368
  buffer_load_dwordx4 v206, s[8:11], s33 offen lds
  s_add_u32 m0, s29, 16384
  s_add_u32 s33, s28, 589824
  buffer_load_dwordx4 v206, s[8:11], s33 offen lds
  s_add_u32 m0, s29, 20480
  s_add_u32 s33, s28, 737280
  buffer_load_dwordx4 v206, s[8:11], s33 offen lds
  s_add_u32 m0, s29, 24576
  s_add_u32 s33, s28, 884736
  buffer_load_dwordx4 v206, s[8:11], s33 offen lds
  s_add_u32 m0, s29, 28672
  s_add_u32 s33, s28, 1032192
  buffer_load_dwordx4 v206, s[8:11], s33 offen lds
  s_add_u32 m0, s29, 32768
  s_add_u32 s33, s28, 1179648
  buffer_load_dwordx4 v206, s[8:11], s33 offen lds
  s_add_u32 m0, s29, 36864
  s_add_u32 s33, s28, 1327104
  buffer_load_dwordx4 v206, s[8:11], s33 offen lds
  s_add_u32 m0, s29, 40960
  s_add_u32 s33, s28, 1474560
  buffer_load_dwordx4 v206, s[8:11], s33 offen lds
  s_add_u32 m0, s29, 45056
  s_add_u32 s33, s28, 1622016
  buffer_load_dwordx4 v206, s[8:11], s33 offen lds
  s_add_u32 m0, s29, 49152
  s_add_u32 s33, s28, 1769472
  buffer_load_dwordx4 v206, s[8:11], s33 offen lds
  s_add_u32 m0, s29, 53248
  s_add_u32 s33, s28, 1916928
  buffer_load_dwordx4 v206, s[8:11], s33 offen lds
  s_add_u32 m0, s29, 57344
  s_add_u32 s33, s28, 2064384
  buffer_load_dwordx4 v206, s[8:11], s33 offen lds
  s_add_u32 m0, s29, 61440
  s_add_u32 s33, s28, 2211840
  buffer_load_dwordx4 v206, s[8:11], s33 offen lds
  s_add_u32 m0, s29, 65536
  s_add_u32 s33, s28, 2359296
  buffer_load_dwordx4 v206, s[8:11], s33 offen lds
  s_add_u32 m0, s29, 69632
  s_add_u32 s33, s28, 2506752
  buffer_load_dwordx4 v206, s[8:11], s33 offen lds
  s_add_u32 m0, s29, 73728
  s_add_u32 s33, s28, 2654208
  buffer_load_dwordx4 v206, s[8:11], s33 offen lds
  s_add_u32 m0, s29, 77824
  s_add_u32 s33, s28, 2801664
  buffer_load_dwordx4 v206, s[8:11], s33 offen lds
  s_add_u32 m0, s29, 81920
  s_add_u32 s33, s28, 2949120
  buffer_load_dwordx4 v206, s[8:11], s33 offen lds
  s_add_u32 m0, s29, 86016
  s_add_u32 s33, s28, 3096576
  buffer_load_dwordx4 v206, s[8:11], s33 offen lds
  s_add_u32 m0, s29, 90112
  s_add_u32 s33, s28, 3244032
  buffer_load_dwordx4 v206, s[8:11], s33 offen lds
  s_add_u32 m0, s29, 94208
  s_add_u32 s33, s28, 3391488
  buffer_load_dwordx4 v206, s[8:11], s33 offen lds
  s_cmp_lg_u32 s38, 0
  s_cbranch_scc1 zready_m_kernel
  s_bfe_u32 s68, s2, 0x30003
  s_lshl_b32 s68, s68, 3
  v_add_u32 v4, s68, v216
  v_lshrrev_b32 v5, 1, v4
  v_lshlrev_b32 v5, 10, v5
  v_and_b32 v6, 1, v4
  v_lshl_add_u32 v5, v6, 8, v5
  v_add_u32 v5, 256, v5
  s_mov_b64 exec, 0xff
  s_mov_b32 s69, 0
zpoll_m_kernel:
  global_load_dword v6, v5, s[52:53] sc1
  s_waitcnt vmcnt(0)
  v_cmp_le_u32 vcc, 18, v6
  s_add_u32 s69, s69, 1
  s_nop 0
  s_cmp_eq_u32 vcc_lo, 0xff
  s_cbranch_scc1 zpolled_m_kernel
  s_sleep 2
  s_cmp_lt_u32 s69, 40000
  s_cbranch_scc1 zpoll_m_kernel
zpolled_m_kernel:
  s_mov_b64 exec, -1
zready_m_kernel:
  s_barrier
  v_lshrrev_b32 v4, 2, v0
  v_lshlrev_b32 v4, 14, v4
  v_and_b32 v6, 3, v0
  v_lshl_add_u32 v4, v6, 4, v4
  s_lshl_b32 s55, s2, 6
  buffer_load_dwordx4 v[20:23], v4, s[64:67], s55 offen sc1
  s_add_u32 s55, s55, 0x100000
  buffer_load_dwordx4 v[24:27], v4, s[64:67], s55 offen sc1
  s_add_u32 s55, s55, 0x100000
  buffer_load_dwordx4 v[28:31], v4, s[64:67], s55 offen sc1
  v_and_b32 v6, 3, v0
  v_mul_u32_u24 v6, 2304, v6
  v_lshrrev_b32 v5, 2, v0
  v_lshl_add_u32 v6, v5, 3, v6
  v_add_u32 v6, 98304, v6
  s_waitcnt vmcnt(0)
  ds_write_b64 v6, v[20:21] offset:0
  ds_write_b64 v6, v[22:23] offset:1152
  ds_write_b64 v6, v[24:25] offset:512
  ds_write_b64 v6, v[26:27] offset:1664
  s_cmp_lg_u32 s38, 0
  s_cbranch_scc1 z2_m_kernel
  ds_write_b64 v6, v[28:29] offset:1024
  ds_write_b64 v6, v[30:31] offset:2176
z2_m_kernel:
  s_waitcnt vmcnt(0) lgkmcnt(0)
  s_barrier
  ds_read_b32 v50, v7 offset:0
  ds_read_b32 v51, v7 offset:128
  ds_read_b32 v52, v7 offset:256
  ds_read_b32 v53, v7 offset:384
  ds_read_b32 v54, v7 offset:512
  ds_read_b32 v55, v7 offset:640
  ds_read_b32 v56, v7 offset:768
  ds_read_b32 v57, v7 offset:896
  ds_read_b32 v58, v7 offset:1024
  s_waitcnt lgkmcnt(0)
  v_lshlrev_b32 v180, 16, v50
  v_and_b32 v181, 0xffff0000, v50
  v_pk_fma_f32 v[32:33], v[78:79], v[180:181], v[32:33]
  v_lshlrev_b32 v180, 16, v51
  v_and_b32 v181, 0xffff0000, v51
  v_pk_fma_f32 v[34:35], v[80:81], v[180:181], v[34:35]
  v_lshlrev_b32 v180, 16, v52
  v_and_b32 v181, 0xffff0000, v52
  v_pk_fma_f32 v[36:37], v[82:83], v[180:181], v[36:37]
  v_lshlrev_b32 v180, 16, v53
  v_and_b32 v181, 0xffff0000, v53
  v_pk_fma_f32 v[38:39], v[84:85], v[180:181], v[38:39]
  v_lshlrev_b32 v180, 16, v54
  v_and_b32 v181, 0xffff0000, v54
  v_pk_fma_f32 v[40:41], v[86:87], v[180:181], v[40:41]
  v_lshlrev_b32 v180, 16, v55
  v_and_b32 v181, 0xffff0000, v55
  v_pk_fma_f32 v[42:43], v[88:89], v[180:181], v[42:43]
  v_lshlrev_b32 v180, 16, v56
  v_and_b32 v181, 0xffff0000, v56
  v_pk_fma_f32 v[44:45], v[90:91], v[180:181], v[44:45]
  v_lshlrev_b32 v180, 16, v57
  v_and_b32 v181, 0xffff0000, v57
  v_pk_fma_f32 v[46:47], v[92:93], v[180:181], v[46:47]
  v_lshlrev_b32 v180, 16, v58
  v_and_b32 v181, 0xffff0000, v58
  v_pk_fma_f32 v[48:49], v[94:95], v[180:181], v[48:49]
  v_cvt_pk_bf16_f32 v152, v32, v33
  v_cvt_pk_bf16_f32 v153, v34, v35
  v_cvt_pk_bf16_f32 v154, v36, v37
  v_cvt_pk_bf16_f32 v155, v38, v39
  v_cvt_pk_bf16_f32 v156, v40, v41
  v_cvt_pk_bf16_f32 v157, v42, v43
  v_cvt_pk_bf16_f32 v158, v44, v45
  v_cvt_pk_bf16_f32 v159, v46, v47
  v_cvt_pk_bf16_f32 v160, v48, v49
  v_add_u32 v6, 129152, v3
  ds_write_b32 v6, v152 offset:0
  v_lshlrev_b32 v32, 16, v152
  v_and_b32 v33, 0xffff0000, v152
  ds_write_b32 v6, v153 offset:128
  v_lshlrev_b32 v34, 16, v153
  v_and_b32 v35, 0xffff0000, v153
  ds_write_b32 v6, v154 offset:256
  v_lshlrev_b32 v36, 16, v154
  v_and_b32 v37, 0xffff0000, v154
  ds_write_b32 v6, v155 offset:384
  v_lshlrev_b32 v38, 16, v155
  v_and_b32 v39, 0xffff0000, v155
  ds_write_b32 v6, v156 offset:512
  v_lshlrev_b32 v40, 16, v156
  v_and_b32 v41, 0xffff0000, v156
  ds_write_b32 v6, v157 offset:640
  v_lshlrev_b32 v42, 16, v157
  v_and_b32 v43, 0xffff0000, v157
  ds_write_b32 v6, v158 offset:768
  v_lshlrev_b32 v44, 16, v158
  v_and_b32 v45, 0xffff0000, v158
  ds_write_b32 v6, v159 offset:896
  v_lshlrev_b32 v46, 16, v159
  v_and_b32 v47, 0xffff0000, v159
  ds_write_b32 v6, v160 offset:1024
  v_lshlrev_b32 v48, 16, v160
  v_and_b32 v49, 0xffff0000, v160
  v_pk_add_f32 v[180:181], v[32:33], v[34:35]
  v_pk_mul_f32 v[182:183], v[32:33], v[32:33]
  v_pk_fma_f32 v[182:183], v[34:35], v[34:35], v[182:183]
  v_pk_add_f32 v[180:181], v[180:181], v[36:37]
  v_pk_fma_f32 v[182:183], v[36:37], v[36:37], v[182:183]
  v_pk_add_f32 v[180:181], v[180:181], v[38:39]
  v_pk_fma_f32 v[182:183], v[38:39], v[38:39], v[182:183]
  v_pk_add_f32 v[180:181], v[180:181], v[40:41]
  v_pk_fma_f32 v[182:183], v[40:41], v[40:41], v[182:183]
  v_pk_add_f32 v[180:181], v[180:181], v[42:43]
  v_pk_fma_f32 v[182:183], v[42:43], v[42:43], v[182:183]
  v_pk_add_f32 v[180:181], v[180:181], v[44:45]
  v_pk_fma_f32 v[182:183], v[44:45], v[44:45], v[182:183]
  v_pk_add_f32 v[180:181], v[180:181], v[46:47]
  v_pk_fma_f32 v[182:183], v[46:47], v[46:47], v[182:183]
  v_pk_add_f32 v[180:181], v[180:181], v[48:49]
  v_pk_fma_f32 v[182:183], v[48:49], v[48:49], v[182:183]
  v_add_f32 v172, v180, v181
  v_add_f32 v173, v182, v183
  s_nop 0
  v_add_f32_dpp v172, v172, v172 quad_perm:[1,0,3,2] row_mask:0xf bank_mask:0xf
  v_add_f32_dpp v173, v173, v173 quad_perm:[1,0,3,2] row_mask:0xf bank_mask:0xf
  s_nop 0
  v_add_f32_dpp v172, v172, v172 quad_perm:[2,3,0,1] row_mask:0xf bank_mask:0xf
  v_add_f32_dpp v173, v173, v173 quad_perm:[2,3,0,1] row_mask:0xf bank_mask:0xf
  s_nop 0
  v_add_f32_dpp v172, v172, v172 row_half_mirror row_mask:0xf bank_mask:0xf
  v_add_f32_dpp v173, v173, v173 row_half_mirror row_mask:0xf bank_mask:0xf
  s_nop 0
  v_add_f32_dpp v172, v172, v172 row_mirror row_mask:0xf bank_mask:0xf
  v_add_f32_dpp v173, v173, v173 row_mirror row_mask:0xf bank_mask:0xf
  v_mov_b32 v174, v172
  v_mov_b32 v175, v173
  s_nop 0
  v_permlane16_swap_b32 v172, v174
  v_permlane16_swap_b32 v173, v175
  v_add_f32 v172, v172, v174
  v_add_f32 v173, v173, v175
  v_mul_f32 v172, 0x3ae38e39, v172
  v_mul_f32 v173, 0x3ae38e39, v173
  v_fma_f32 v173, -v172, v172, v173
  v_max_f32 v173, 0, v173
  v_add_f32 v173, 0x3727c5ac, v173
  v_rsq_f32 v178, v173
  s_nop 0
  v_mul_f32 v176, v172, v178
  v_sub_f32 v176, 0, v176
  s_waitcnt lgkmcnt(0)
  v_pk_fma_f32 v[32:33], v[32:33], v[178:179], v[176:177] op_sel_hi:[1,0,0]
  v_pk_fma_f32 v[32:33], v[32:33], v[132:133], v[114:115]
  v_pk_fma_f32 v[34:35], v[34:35], v[178:179], v[176:177] op_sel_hi:[1,0,0]
  v_pk_fma_f32 v[34:35], v[34:35], v[134:135], v[116:117]
  v_pk_fma_f32 v[36:37], v[36:37], v[178:179], v[176:177] op_sel_hi:[1,0,0]
  v_pk_fma_f32 v[36:37], v[36:37], v[136:137], v[118:119]
  v_pk_fma_f32 v[38:39], v[38:39], v[178:179], v[176:177] op_sel_hi:[1,0,0]
  v_pk_fma_f32 v[38:39], v[38:39], v[138:139], v[120:121]
  v_pk_fma_f32 v[40:41], v[40:41], v[178:179], v[176:177] op_sel_hi:[1,0,0]
  v_pk_fma_f32 v[40:41], v[40:41], v[140:141], v[122:123]
  v_pk_fma_f32 v[42:43], v[42:43], v[178:179], v[176:177] op_sel_hi:[1,0,0]
  v_pk_fma_f32 v[42:43], v[42:43], v[142:143], v[124:125]
  v_pk_fma_f32 v[44:45], v[44:45], v[178:179], v[176:177] op_sel_hi:[1,0,0]
  v_pk_fma_f32 v[44:45], v[44:45], v[144:145], v[126:127]
  v_pk_fma_f32 v[46:47], v[46:47], v[178:179], v[176:177] op_sel_hi:[1,0,0]
  v_pk_fma_f32 v[46:47], v[46:47], v[146:147], v[128:129]
  v_pk_fma_f32 v[48:49], v[48:49], v[178:179], v[176:177] op_sel_hi:[1,0,0]
  v_pk_fma_f32 v[48:49], v[48:49], v[148:149], v[130:131]
  v_mul_u32_u24 v7, 1168, v1
  v_lshl_add_u32 v7, v2, 2, v7
  v_add_u32 v7, 119808, v7
  v_cvt_pk_bf16_f32 v162, v32, v33
  ds_write_b32 v7, v162 offset:0
  v_cvt_pk_bf16_f32 v163, v34, v35
  ds_write_b32 v7, v163 offset:128
  v_cvt_pk_bf16_f32 v164, v36, v37
  ds_write_b32 v7, v164 offset:256
  v_cvt_pk_bf16_f32 v165, v38, v39
  ds_write_b32 v7, v165 offset:384
  v_cvt_pk_bf16_f32 v166, v40, v41
  ds_write_b32 v7, v166 offset:512
  v_cvt_pk_bf16_f32 v167, v42, v43
  ds_write_b32 v7, v167 offset:640
  v_cvt_pk_bf16_f32 v168, v44, v45
  ds_write_b32 v7, v168 offset:768
  v_cvt_pk_bf16_f32 v169, v46, v47
  ds_write_b32 v7, v169 offset:896
  v_cvt_pk_bf16_f32 v170, v48, v49
  ds_write_b32 v7, v170 offset:1024
  s_waitcnt lgkmcnt(0)
  s_barrier
  v_and_b32 v1, 7, v0
  v_lshrrev_b32 v2, 3, v0
  v_mul_u32_u24 v6, 1168, v1
  v_lshl_add_u32 v6, v2, 4, v6
  v_add_u32 v6, 119808, v6
  v_lshlrev_b32 v4, 9, v2
  v_lshl_add_u32 v4, v1, 4, v4
  s_lshr_b32 s54, s2, 2
  s_mul_i32 s54, s54, 36864
  s_and_b32 s55, s2, 3
  s_lshl_b32 s55, s55, 7
  s_add_u32 s54, s54, s55
  ds_read_b128 v[8:11], v6 offset:0
  ds_read_b128 v[12:15], v6 offset:512
  ds_read_b128 v[16:19], v6 offset:1024
  v_lshlrev_b32 v5, 4, v0
  v_add_u32 v7, 129152, v5
  ds_read_b128 v[20:23], v7 offset:0
  ds_read_b128 v[24:27], v7 offset:4096
  ds_read_b128 v[28:31], v7 offset:8192
  s_mul_i32 s69, s2, 9216
  s_waitcnt lgkmcnt(0)
  s_add_u32 s68, s69, 0
  buffer_store_dwordx4 v[20:23], v5, s[4:7], s68 offen sc1
  s_add_u32 s68, s69, 4096
  buffer_store_dwordx4 v[24:27], v5, s[4:7], s68 offen sc1
  s_waitcnt lgkmcnt(2)
  s_add_u32 s55, s54, 0
  buffer_store_dwordx4 v[8:11], v4, s[16:19], s55 offen sc1
  s_waitcnt lgkmcnt(1)
  s_add_u32 s55, s54, 16384
  buffer_store_dwordx4 v[12:15], v4, s[16:19], s55 offen sc1
  s_waitcnt lgkmcnt(0)
  s_cmp_lg_u32 s38, 0
  s_cbranch_scc1 h2done_m_kernel
  s_add_u32 s55, s54, 32768
  buffer_store_dwordx4 v[16:19], v4, s[16:19], s55 offen sc1
  s_add_u32 s68, s69, 8192
  buffer_store_dwordx4 v[28:31], v5, s[4:7], s68 offen sc1
h2done_m_kernel:
  s_lshl_b32 s43, s41, 5
  s_add_u32 s43, s43, s42
  s_add_u32 s43, s43, 1024
  s_mul_i32 s46, s44, 294912
  s_add_u32 s30, s43, s46
  s_lshl_b32 s43, s44, 11
  s_lshl_b32 s46, s45, 10
  s_add_u32 s31, s43, s46
  s_lshl_b32 s46, s40, 3
  s_lshl_b32 s47, s38, 1
  s_add_u32 s46, s46, s47
  s_mul_i32 s32, s46, 294912
  s_mul_i32 s47, s39, 18432
  s_add_u32 s32, s32, s47
  s_lshl_b32 s47, s41, 12
  s_add_u32 s49, s32, s47
  s_lshl_b32 s47, s41, 9
  s_add_u32 s50, s32, s47
  s_add_u32 s50, s50, 16384
  s_mul_i32 s48, s46, 36864
  v_lshlrev_b32 v209, 4, v216
  v_add_u32 v209, s48, v209
  v_lshrrev_b32 v217, 1, v216
  s_lshl_b32 s47, s45, 2
  v_xor_b32 v217, s47, v217
  v_mul_u32_u24 v217, 9216, v217
  v_lshl_add_u32 v207, v219, 4, v217
  v_bfe_u32 v217, v216, 4, 1
  v_lshrrev_b32 v218, 5, v216
  v_bfe_u32 v219, v216, 2, 2
  v_and_b32 v220, 3, v216
  v_lshl_add_u32 v221, v218, 3, v219
  v_lshlrev_b32 v222, 11, v217
  v_lshl_add_u32 v222, v220, 3, v222
  v_lshl_add_u32 v222, v221, 7, v222
  v_lshrrev_b32 v223, 1, v219
  v_lshl_add_u32 v223, v217, 1, v223
  v_xor_b32 v224, 0, v223
  v_lshl_add_u32 v192, v224, 5, v222
  v_add_u32 v196, 49152, v192
  v_add_u32 v200, 98304, v192
  v_xor_b32 v224, 1, v223
  v_lshl_add_u32 v193, v224, 5, v222
  v_add_u32 v197, 49152, v193
  v_add_u32 v201, 98304, v193
  v_xor_b32 v224, 2, v223
  v_lshl_add_u32 v194, v224, 5, v222
  v_add_u32 v198, 49152, v194
  v_add_u32 v202, 98304, v194
  v_xor_b32 v224, 3, v223
  v_lshl_add_u32 v195, v224, 5, v222
  v_add_u32 v199, 49152, v195
  v_add_u32 v203, 98304, v195
  v_lshlrev_b32 v222, 10, v217
  v_lshl_add_u32 v222, v220, 3, v222
  v_lshl_add_u32 v222, v221, 5, v222
  v_lshl_add_u32 v204, v217, 7, v222
  v_xor_b32 v223, 1, v217
  v_lshl_add_u32 v205, v223, 7, v222
  v_add_u32 v212, 147456, v204
  v_add_u32 v213, 147456, v205
  v_mul_u32_u24 v222, 147456, v217
  v_lshl_add_u32 v222, v218, 8, v222
  v_and_b32 v223, 15, v216
  v_lshl_add_u32 v208, v223, 4, v222
  v_lshlrev_b32 v210, 7, v0
  v_mov_b32 v222, 0x7ff00000
  v_cmp_gt_u32 vcc, 162, v0
  s_nop 1
  v_cndmask_b32 v210, v222, v210, vcc
  s_bfe_u32 s47, s2, 0x20001
  s_mul_i32 s35, s47, 1327104
  s_lshr_b32 s47, s2, 3
  s_mul_i32 s47, s47, 41472
  s_add_u32 s35, s35, s47
  s_add_u32 s51, s35, 20736
  s_and_b32 s47, s2, 127
  s_mul_i32 s54, s47, 96
  v_add_u32 v222, s54, v0
  v_lshrrev_b32 v223, 5, v222
  v_add_u32 v223, 192, v223
  v_bfe_u32 v224, v222, 2, 3
  v_and_b32 v222, 3, v222
  v_lshlrev_b32 v222, 1, v222
  v_add_u32 v222, 1, v222
  v_mad_u32_u24 v222, v224, 9, v222
  v_lshlrev_b32 v222, 7, v222
  s_movk_i32 s55, 9216
  v_mad_u32_u24 v214, v223, s55, v222
  s_mul_i32 s54, s47, 36
  s_sub_u32 s54, s54, 96
  v_add_u32 v222, s54, v0
  v_lshrrev_b32 v223, 3, v222
  v_and_b32 v222, 7, v222
  v_mul_u32_u24 v222, 9, v222
  v_add_u32 v222, 8, v222
  v_lshlrev_b32 v222, 7, v222
  v_mad_u32_u24 v222, v223, s55, v222
  v_cmp_gt_u32 vcc, 96, v0
  s_nop 1
  v_cndmask_b32 v214, v222, v214, vcc
  v_mov_b32 v222, 0x7ff00000
  v_cmp_gt_u32 vcc, 132, v0
  s_nop 1
  v_cndmask_b32 v214, v222, v214, vcc
  s_mul_i32 s68, s41, 224
  s_sub_u32 s68, 768, s68
  s_mov_b32 s69, 0xe38e38f
  v_add_u32 v222, 0, v216
  v_mul_hi_u32 v223, v222, s69
  v_mul_u32_u24 v224, 18, v223
  v_sub_u32 v224, v222, v224
  v_mul_u32_u24 v223, 1152, v223
  v_lshl_add_u32 v226, v224, 4, v223
  v_cmp_lt_u32 vcc, 15, v224
  v_add_u32 v223, s68, v226
  s_nop 0
  v_cndmask_b32 v226, v226, v223, vcc
  v_add_u32 v222, 64, v216
  v_mul_hi_u32 v223, v222, s69
  v_mul_u32_u24 v224, 18, v223
  v_sub_u32 v224, v222, v224
  v_mul_u32_u24 v223, 1152, v223
  v_lshl_add_u32 v227, v224, 4, v223
  v_cmp_lt_u32 vcc, 15, v224
  v_add_u32 v223, s68, v227
  s_nop 0
  v_cndmask_b32 v227, v227, v223, vcc
  v_add_u32 v222, 128, v216
  v_mul_hi_u32 v223, v222, s69
  v_mul_u32_u24 v224, 18, v223
  v_sub_u32 v224, v222, v224
  v_mul_u32_u24 v223, 1152, v223
  v_lshl_add_u32 v228, v224, 4, v223
  v_cmp_lt_u32 vcc, 15, v224
  v_add_u32 v223, s68, v228
  s_nop 0
  v_cndmask_b32 v228, v228, v223, vcc
  v_add_u32 v222, 192, v216
  v_mul_hi_u32 v223, v222, s69
  v_mul_u32_u24 v224, 18, v223
  v_sub_u32 v224, v222, v224
  v_mul_u32_u24 v223, 1152, v223
  v_lshl_add_u32 v229, v224, 4, v223
  v_cmp_lt_u32 vcc, 15, v224
  v_add_u32 v223, s68, v229
  s_nop 0
  v_cndmask_b32 v229, v229, v223, vcc
  v_add_u32 v222, 256, v216
  v_mul_hi_u32 v223, v222, s69
  v_mul_u32_u24 v224, 18, v223
  v_sub_u32 v224, v222, v224
  v_mul_u32_u24 v223, 1152, v223
  v_lshl_add_u32 v230, v224, 4, v223
  v_cmp_lt_u32 vcc, 15, v224
  v_add_u32 v223, s68, v230
  s_nop 0
  v_cndmask_b32 v230, v230, v223, vcc
  v_add_u32 v222, 320, v216
  v_mul_hi_u32 v223, v222, s69
  v_mul_u32_u24 v224, 18, v223
  v_sub_u32 v224, v222, v224
  v_mul_u32_u24 v223, 1152, v223
  v_lshl_add_u32 v231, v224, 4, v223
  v_cmp_lt_u32 vcc, 15, v224
  v_add_u32 v223, s68, v231
  s_nop 0
  v_cndmask_b32 v231, v231, v223, vcc
  v_add_u32 v222, 384, v216
  v_mul_hi_u32 v223, v222, s69
  v_mul_u32_u24 v224, 18, v223
  v_sub_u32 v224, v222, v224
  v_mul_u32_u24 v223, 1152, v223
  v_lshl_add_u32 v232, v224, 4, v223
  v_cmp_lt_u32 vcc, 15, v224
  v_add_u32 v223, s68, v232
  s_nop 0
  v_cndmask_b32 v232, v232, v223, vcc
  v_add_u32 v222, 448, v216
  v_mul_hi_u32 v223, v222, s69
  v_mul_u32_u24 v224, 18, v223
  v_sub_u32 v224, v222, v224
  v_mul_u32_u24 v223, 1152, v223
  v_lshl_add_u32 v233, v224, 4, v223
  v_cmp_lt_u32 vcc, 15, v224
  v_add_u32 v223, s68, v233
  s_nop 0
  v_cndmask_b32 v233, v233, v223, vcc
  v_add_u32 v222, 512, v216
  v_mul_hi_u32 v223, v222, s69
  v_mul_u32_u24 v224, 18, v223
  v_sub_u32 v224, v222, v224
  v_mul_u32_u24 v223, 1152, v223
  v_lshl_add_u32 v234, v224, 4, v223
  v_cmp_lt_u32 vcc, 15, v224
  v_add_u32 v223, s68, v234
  s_nop 0
  v_cndmask_b32 v234, v234, v223, vcc
  s_waitcnt vmcnt(0)
  s_barrier
  s_cmp_lg_u32 s38, 0
  s_cbranch_scc1 signalled_m_kernel
  s_mov_b64 exec, 1
  s_lshr_b32 s54, s2, 3
  s_lshl_b32 s54, s54, 10
  v_mov_b32 v1, s54
  v_mov_b32 v2, 1
  global_atomic_add v1, v2, s[52:53]
signalled_m_kernel:
  s_mov_b64 exec, 1
  s_lshl_b32 s54, s40, 2
  s_add_u32 s54, s54, s38
  s_lshl_b32 s54, s54, 10
  v_mov_b32 v1, s54
  s_mov_b32 s55, 0
poll_m_kernel:
  global_load_dword v2, v1, s[52:53] sc1
  s_waitcnt vmcnt(0)
  v_readfirstlane_b32 s68, v2
  s_add_u32 s55, s55, 1
  s_nop 0
  s_cmp_ge_u32 s68, 8
  s_cbranch_scc1 polled_m_kernel
  s_sleep 2
  s_cmp_lt_u32 s55, 40000
  s_cbranch_scc1 poll_m_kernel
polled_m_kernel:
  s_mov_b64 exec, -1
  s_mov_b32 s34, 0
  buffer_load_dwordx4 a[0:3], v209, s[16:19], s34 offen offset:0 sc1
  s_mov_b32 s34, 36864
  buffer_load_dwordx4 a[4:7], v209, s[16:19], s34 offen offset:0 sc1
  s_mov_b32 s34, 0
  buffer_load_dwordx4 a[8:11], v209, s[16:19], s34 offen offset:1024 sc1
  s_mov_b32 s34, 36864
  buffer_load_dwordx4 a[12:15], v209, s[16:19], s34 offen offset:1024 sc1
  s_mov_b32 s34, 0
  buffer_load_dwordx4 a[16:19], v209, s[16:19], s34 offen offset:2048 sc1
  s_mov_b32 s34, 36864
  buffer_load_dwordx4 a[20:23], v209, s[16:19], s34 offen offset:2048 sc1
  s_mov_b32 s34, 0
  buffer_load_dwordx4 a[24:27], v209, s[16:19], s34 offen offset:3072 sc1
  s_mov_b32 s34, 36864
  buffer_load_dwordx4 a[28:31], v209, s[16:19], s34 offen offset:3072 sc1
  ds_read_b64_tr_b16 v[128:129], v192 offset:0
  ds_read_b64_tr_b16 v[130:131], v192 offset:512
  ds_read_b64_tr_b16 v[132:133], v193 offset:0
  ds_read_b64_tr_b16 v[134:135], v193 offset:512
  ds_read_b64_tr_b16 v[136:137], v194 offset:0
  ds_read_b64_tr_b16 v[138:139], v194 offset:512
  ds_read_b64_tr_b16 v[140:141], v195 offset:0
  ds_read_b64_tr_b16 v[142:143], v195 offset:512
  s_waitcnt vmcnt(6) lgkmcnt(4)
  v_mfma_f32_32x32x16_bf16 v[0:15], v[128:131], a[0:3], 0
  ds_read_b64_tr_b16 v[144:145], v192 offset:4096
  s_mov_b32 s34, 4096
  buffer_load_dwordx4 a[32:35], v209, s[16:19], s34 offen offset:0 sc1
  v_mfma_f32_32x32x16_bf16 v[32:47], v[132:135], a[0:3], 0
  ds_read_b64_tr_b16 v[146:147], v192 offset:4608
  s_mov_b32 s34, 40960
  buffer_load_dwordx4 a[36:39], v209, s[16:19], s34 offen offset:0 sc1
  v_mfma_f32_32x32x16_bf16 v[48:63], v[132:135], a[4:7], 0
  ds_read_b64_tr_b16 v[148:149], v193 offset:4096
  s_mov_b32 s34, 4096
  buffer_load_dwordx4 a[40:43], v209, s[16:19], s34 offen offset:1024 sc1
  v_mfma_f32_32x32x16_bf16 v[16:31], v[128:131], a[4:7], 0
  ds_read_b64_tr_b16 v[150:151], v193 offset:4608
  s_mov_b32 s34, 40960
  buffer_load_dwordx4 a[44:47], v209, s[16:19], s34 offen offset:1024 sc1
  s_waitcnt lgkmcnt(4)
  v_mfma_f32_32x32x16_bf16 v[64:79], v[136:139], a[0:3], 0
  ds_read_b64_tr_b16 v[128:129], v194 offset:4096
  v_mfma_f32_32x32x16_bf16 v[96:111], v[140:143], a[0:3], 0
  ds_read_b64_tr_b16 v[130:131], v194 offset:4608
  v_mfma_f32_32x32x16_bf16 v[112:127], v[140:143], a[4:7], 0
  ds_read_b64_tr_b16 v[132:133], v195 offset:4096
  v_mfma_f32_32x32x16_bf16 v[80:95], v[136:139], a[4:7], 0
  ds_read_b64_tr_b16 v[134:135], v195 offset:4608
  s_waitcnt vmcnt(8) lgkmcnt(4)
  v_mfma_f32_32x32x16_bf16 v[0:15], v[144:147], a[8:11], v[0:15]
  ds_read_b64_tr_b16 v[136:137], v192 offset:8192
  s_mov_b32 s34, 4096
  buffer_load_dwordx4 a[48:51], v209, s[16:19], s34 offen offset:2048 sc1
  v_mfma_f32_32x32x16_bf16 v[32:47], v[148:151], a[8:11], v[32:47]
  ds_read_b64_tr_b16 v[138:139], v192 offset:8704
  s_mov_b32 s34, 40960
  buffer_load_dwordx4 a[52:55], v209, s[16:19], s34 offen offset:2048 sc1
  v_mfma_f32_32x32x16_bf16 v[48:63], v[148:151], a[12:15], v[48:63]
  ds_read_b64_tr_b16 v[140:141], v193 offset:8192
  s_mov_b32 s34, 4096
  buffer_load_dwordx4 a[56:59], v209, s[16:19], s34 offen offset:3072 sc1
  v_mfma_f32_32x32x16_bf16 v[16:31], v[144:147], a[12:15], v[16:31]
  ds_read_b64_tr_b16 v[142:143], v193 offset:8704
  s_mov_b32 s34, 40960
  buffer_load_dwordx4 a[60:63], v209, s[16:19], s34 offen offset:3072 sc1
  s_waitcnt lgkmcnt(4)
  v_mfma_f32_32x32x16_bf16 v[64:79], v[128:131], a[8:11], v[64:79]
  ds_read_b64_tr_b16 v[144:145], v194 offset:8192
  v_mfma_f32_32x32x16_bf16 v[96:111], v[132:135], a[8:11], v[96:111]
  ds_read_b64_tr_b16 v[146:147], v194 offset:8704
  v_mfma_f32_32x32x16_bf16 v[112:127], v[132:135], a[12:15], v[112:127]
  ds_read_b64_tr_b16 v[148:149], v195 offset:8192
  v_mfma_f32_32x32x16_bf16 v[80:95], v[128:131], a[12:15], v[80:95]
  ds_read_b64_tr_b16 v[150:151], v195 offset:8704
  s_waitcnt vmcnt(10) lgkmcnt(4)
  v_mfma_f32_32x32x16_bf16 v[0:15], v[136:139], a[16:19], v[0:15]
  ds_read_b64_tr_b16 v[128:129], v192 offset:12288
  s_mov_b32 s34, 8192
  v_mfma_f32_32x32x16_bf16 v[32:47], v[140:143], a[16:19], v[32:47]
  ds_read_b64_tr_b16 v[130:131], v192 offset:12800
  buffer_load_dwordx4 a[64:67], v209, s[16:19], s34 offen offset:0 sc1
  v_mfma_f32_32x32x16_bf16 v[48:63], v[140:143], a[20:23], v[48:63]
  ds_read_b64_tr_b16 v[132:133], v193 offset:12288
  s_mov_b32 s34, 45056
  v_mfma_f32_32x32x16_bf16 v[16:31], v[136:139], a[20:23], v[16:31]
  ds_read_b64_tr_b16 v[134:135], v193 offset:12800
  buffer_load_dwordx4 a[68:71], v209, s[16:19], s34 offen offset:0 sc1
  s_waitcnt lgkmcnt(4)
  v_mfma_f32_32x32x16_bf16 v[64:79], v[144:147], a[16:19], v[64:79]
  ds_read_b64_tr_b16 v[136:137], v194 offset:12288
  v_mfma_f32_32x32x16_bf16 v[96:111], v[148:151], a[16:19], v[96:111]
  ds_read_b64_tr_b16 v[138:139], v194 offset:12800
  v_mfma_f32_32x32x16_bf16 v[112:127], v[148:151], a[20:23], v[112:127]
  ds_read_b64_tr_b16 v[140:141], v195 offset:12288
  v_mfma_f32_32x32x16_bf16 v[80:95], v[144:147], a[20:23], v[80:95]
  ds_read_b64_tr_b16 v[142:143], v195 offset:12800
  s_waitcnt vmcnt(10) lgkmcnt(4)
  v_mfma_f32_32x32x16_bf16 v[0:15], v[128:131], a[24:27], v[0:15]
  ds_read_b64_tr_b16 v[144:145], v192 offset:16384
  s_mov_b32 s34, 8192
  v_mfma_f32_32x32x16_bf16 v[32:47], v[132:135], a[24:27], v[32:47]
  ds_read_b64_tr_b16 v[146:147], v192 offset:16896
  buffer_load_dwordx4 a[72:75], v209, s[16:19], s34 offen offset:1024 sc1
  v_mfma_f32_32x32x16_bf16 v[48:63], v[132:135], a[28:31], v[48:63]
  ds_read_b64_tr_b16 v[148:149], v193 offset:16384
  s_mov_b32 s34, 45056
  v_mfma_f32_32x32x16_bf16 v[16:31], v[128:131], a[28:31], v[16:31]
  ds_read_b64_tr_b16 v[150:151], v193 offset:16896
  buffer_load_dwordx4 a[76:79], v209, s[16:19], s34 offen offset:1024 sc1
  s_waitcnt lgkmcnt(4)
  v_mfma_f32_32x32x16_bf16 v[64:79], v[136:139], a[24:27], v[64:79]
  ds_read_b64_tr_b16 v[128:129], v194 offset:16384
  v_mfma_f32_32x32x16_bf16 v[96:111], v[140:143], a[24:27], v[96:111]
  ds_read_b64_tr_b16 v[130:131], v194 offset:16896
  v_mfma_f32_32x32x16_bf16 v[112:127], v[140:143], a[28:31], v[112:127]
  ds_read_b64_tr_b16 v[132:133], v195 offset:16384
  v_mfma_f32_32x32x16_bf16 v[80:95], v[136:139], a[28:31], v[80:95]
  ds_read_b64_tr_b16 v[134:135], v195 offset:16896
  s_waitcnt vmcnt(10) lgkmcnt(4)
  v_mfma_f32_32x32x16_bf16 v[0:15], v[144:147], a[32:35], v[0:15]
  ds_read_b64_tr_b16 v[136:137], v192 offset:20480
  s_add_u32 m0, s29, 98304
  s_add_u32 s33, s28, 3538944
  v_mfma_f32_32x32x16_bf16 v[32:47], v[148:151], a[32:35], v[32:47]
  ds_read_b64_tr_b16 v[138:139], v192 offset:20992
  buffer_load_dwordx4 v206, s[8:11], s33 offen lds
  s_mov_b32 s34, 8192
  v_mfma_f32_32x32x16_bf16 v[48:63], v[148:151], a[36:39], v[48:63]
  ds_read_b64_tr_b16 v[140:141], v193 offset:20480
  buffer_load_dwordx4 a[80:83], v209, s[16:19], s34 offen offset:2048 sc1
  s_mov_b32 s34, 45056
  v_mfma_f32_32x32x16_bf16 v[16:31], v[144:147], a[36:39], v[16:31]
  ds_read_b64_tr_b16 v[142:143], v193 offset:20992
  buffer_load_dwordx4 a[84:87], v209, s[16:19], s34 offen offset:2048 sc1
  s_waitcnt lgkmcnt(4)
  v_mfma_f32_32x32x16_bf16 v[64:79], v[128:131], a[32:35], v[64:79]
  ds_read_b64_tr_b16 v[144:145], v194 offset:20480
  v_mfma_f32_32x32x16_bf16 v[96:111], v[132:135], a[32:35], v[96:111]
  ds_read_b64_tr_b16 v[146:147], v194 offset:20992
  v_mfma_f32_32x32x16_bf16 v[112:127], v[132:135], a[36:39], v[112:127]
  ds_read_b64_tr_b16 v[148:149], v195 offset:20480
  v_mfma_f32_32x32x16_bf16 v[80:95], v[128:131], a[36:39], v[80:95]
  ds_read_b64_tr_b16 v[150:151], v195 offset:20992
  s_waitcnt vmcnt(11) lgkmcnt(4)
  v_mfma_f32_32x32x16_bf16 v[0:15], v[136:139], a[40:43], v[0:15]
  ds_read_b64_tr_b16 v[128:129], v192 offset:24576
  s_add_u32 m0, s29, 102400
  s_add_u32 s33, s28, 3686400
  v_mfma_f32_32x32x16_bf16 v[32:47], v[140:143], a[40:43], v[32:47]
  ds_read_b64_tr_b16 v[130:131], v192 offset:25088
  buffer_load_dwordx4 v206, s[8:11], s33 offen lds
  s_mov_b32 s34, 8192
  v_mfma_f32_32x32x16_bf16 v[48:63], v[140:143], a[44:47], v[48:63]
  ds_read_b64_tr_b16 v[132:133], v193 offset:24576
  buffer_load_dwordx4 a[88:91], v209, s[16:19], s34 offen offset:3072 sc1
  s_mov_b32 s34, 45056
  v_mfma_f32_32x32x16_bf16 v[16:31], v[136:139], a[44:47], v[16:31]
  ds_read_b64_tr_b16 v[134:135], v193 offset:25088
  buffer_load_dwordx4 a[92:95], v209, s[16:19], s34 offen offset:3072 sc1
  s_waitcnt lgkmcnt(4)
  v_mfma_f32_32x32x16_bf16 v[64:79], v[144:147], a[40:43], v[64:79]
  ds_read_b64_tr_b16 v[136:137], v194 offset:24576
  v_mfma_f32_32x32x16_bf16 v[96:111], v[148:151], a[40:43], v[96:111]
  ds_read_b64_tr_b16 v[138:139], v194 offset:25088
  v_mfma_f32_32x32x16_bf16 v[112:127], v[148:151], a[44:47], v[112:127]
  ds_read_b64_tr_b16 v[140:141], v195 offset:24576
  v_mfma_f32_32x32x16_bf16 v[80:95], v[144:147], a[44:47], v[80:95]
  ds_read_b64_tr_b16 v[142:143], v195 offset:25088
  s_waitcnt vmcnt(12) lgkmcnt(4)
  v_mfma_f32_32x32x16_bf16 v[0:15], v[128:131], a[48:51], v[0:15]
  ds_read_b64_tr_b16 v[144:145], v192 offset:28672
  s_add_u32 m0, s29, 106496
  s_add_u32 s33, s28, 3833856
  v_mfma_f32_32x32x16_bf16 v[32:47], v[132:135], a[48:51], v[32:47]
  ds_read_b64_tr_b16 v[146:147], v192 offset:29184
  buffer_load_dwordx4 v206, s[8:11], s33 offen lds
  s_mov_b32 s34, 12288
  v_mfma_f32_32x32x16_bf16 v[48:63], v[132:135], a[52:55], v[48:63]
  ds_read_b64_tr_b16 v[148:149], v193 offset:28672
  buffer_load_dwordx4 a[96:99], v209, s[16:19], s34 offen offset:0 sc1
  s_mov_b32 s34, 49152
  v_mfma_f32_32x32x16_bf16 v[16:31], v[128:131], a[52:55], v[16:31]
  ds_read_b64_tr_b16 v[150:151], v193 offset:29184
  buffer_load_dwordx4 a[100:103], v209, s[16:19], s34 offen offset:0 sc1
  s_waitcnt lgkmcnt(4)
  v_mfma_f32_32x32x16_bf16 v[64:79], v[136:139], a[48:51], v[64:79]
  ds_read_b64_tr_b16 v[128:129], v194 offset:28672
  v_mfma_f32_32x32x16_bf16 v[96:111], v[140:143], a[48:51], v[96:111]
  ds_read_b64_tr_b16 v[130:131], v194 offset:29184
  v_mfma_f32_32x32x16_bf16 v[112:127], v[140:143], a[52:55], v[112:127]
  ds_read_b64_tr_b16 v[132:133], v195 offset:28672
  v_mfma_f32_32x32x16_bf16 v[80:95], v[136:139], a[52:55], v[80:95]
  ds_read_b64_tr_b16 v[134:135], v195 offset:29184
  s_waitcnt vmcnt(13) lgkmcnt(4)
  v_mfma_f32_32x32x16_bf16 v[0:15], v[144:147], a[56:59], v[0:15]
  ds_read_b64_tr_b16 v[136:137], v192 offset:32768
  s_add_u32 m0, s29, 110592
  s_add_u32 s33, s28, 3981312
  v_mfma_f32_32x32x16_bf16 v[32:47], v[148:151], a[56:59], v[32:47]
  ds_read_b64_tr_b16 v[138:139], v192 offset:33280
  buffer_load_dwordx4 v206, s[8:11], s33 offen lds
  s_mov_b32 s34, 12288
  v_mfma_f32_32x32x16_bf16 v[48:63], v[148:151], a[60:63], v[48:63]
  ds_read_b64_tr_b16 v[140:141], v193 offset:32768
  buffer_load_dwordx4 a[104:107], v209, s[16:19], s34 offen offset:1024 sc1
  s_mov_b32 s34, 49152
  v_mfma_f32_32x32x16_bf16 v[16:31], v[144:147], a[60:63], v[16:31]
  ds_read_b64_tr_b16 v[142:143], v193 offset:33280
  buffer_load_dwordx4 a[108:111], v209, s[16:19], s34 offen offset:1024 sc1
  s_waitcnt lgkmcnt(4)
  v_mfma_f32_32x32x16_bf16 v[64:79], v[128:131], a[56:59], v[64:79]
  ds_read_b64_tr_b16 v[144:145], v194 offset:32768
  v_mfma_f32_32x32x16_bf16 v[96:111], v[132:135], a[56:59], v[96:111]
  ds_read_b64_tr_b16 v[146:147], v194 offset:33280
  v_mfma_f32_32x32x16_bf16 v[112:127], v[132:135], a[60:63], v[112:127]
  ds_read_b64_tr_b16 v[148:149], v195 offset:32768
  v_mfma_f32_32x32x16_bf16 v[80:95], v[128:131], a[60:63], v[80:95]
  ds_read_b64_tr_b16 v[150:151], v195 offset:33280
  s_waitcnt vmcnt(14) lgkmcnt(4)
  v_mfma_f32_32x32x16_bf16 v[0:15], v[136:139], a[64:67], v[0:15]
  ds_read_b64_tr_b16 v[128:129], v192 offset:36864
  s_add_u32 m0, s29, 114688
  s_add_u32 s33, s28, 4128768
  v_mfma_f32_32x32x16_bf16 v[32:47], v[140:143], a[64:67], v[32:47]
  ds_read_b64_tr_b16 v[130:131], v192 offset:37376
  buffer_load_dwordx4 v206, s[8:11], s33 offen lds
  s_mov_b32 s34, 12288
  v_mfma_f32_32x32x16_bf16 v[48:63], v[140:143], a[68:71], v[48:63]
  ds_read_b64_tr_b16 v[132:133], v193 offset:36864
  buffer_load_dwordx4 a[112:115], v209, s[16:19], s34 offen offset:2048 sc1
  s_mov_b32 s34, 49152
  v_mfma_f32_32x32x16_bf16 v[16:31], v[136:139], a[68:71], v[16:31]
  ds_read_b64_tr_b16 v[134:135], v193 offset:37376
  buffer_load_dwordx4 a[116:119], v209, s[16:19], s34 offen offset:2048 sc1
  s_waitcnt lgkmcnt(4)
  v_mfma_f32_32x32x16_bf16 v[64:79], v[144:147], a[64:67], v[64:79]
  ds_read_b64_tr_b16 v[136:137], v194 offset:36864
  v_mfma_f32_32x32x16_bf16 v[96:111], v[148:151], a[64:67], v[96:111]
  ds_read_b64_tr_b16 v[138:139], v194 offset:37376
  v_mfma_f32_32x32x16_bf16 v[112:127], v[148:151], a[68:71], v[112:127]
  ds_read_b64_tr_b16 v[140:141], v195 offset:36864
  v_mfma_f32_32x32x16_bf16 v[80:95], v[144:147], a[68:71], v[80:95]
  ds_read_b64_tr_b16 v[142:143], v195 offset:37376
  s_waitcnt vmcnt(15) lgkmcnt(4)
  v_mfma_f32_32x32x16_bf16 v[0:15], v[128:131], a[72:75], v[0:15]
  ds_read_b64_tr_b16 v[144:145], v192 offset:40960
  s_add_u32 m0, s29, 118784
  s_add_u32 s33, s28, 4276224
  v_mfma_f32_32x32x16_bf16 v[32:47], v[132:135], a[72:75], v[32:47]
  ds_read_b64_tr_b16 v[146:147], v192 offset:41472
  buffer_load_dwordx4 v206, s[8:11], s33 offen lds
  s_mov_b32 s34, 12288
  v_mfma_f32_32x32x16_bf16 v[48:63], v[132:135], a[76:79], v[48:63]
  ds_read_b64_tr_b16 v[148:149], v193 offset:40960
  buffer_load_dwordx4 a[120:123], v209, s[16:19], s34 offen offset:3072 sc1
  s_mov_b32 s34, 49152
  v_mfma_f32_32x32x16_bf16 v[16:31], v[128:131], a[76:79], v[16:31]
  ds_read_b64_tr_b16 v[150:151], v193 offset:41472
  buffer_load_dwordx4 a[124:127], v209, s[16:19], s34 offen offset:3072 sc1
  s_waitcnt lgkmcnt(4)
  v_mfma_f32_32x32x16_bf16 v[64:79], v[136:139], a[72:75], v[64:79]
  ds_read_b64_tr_b16 v[128:129], v194 offset:40960
  v_mfma_f32_32x32x16_bf16 v[96:111], v[140:143], a[72:75], v[96:111]
  ds_read_b64_tr_b16 v[130:131], v194 offset:41472
  v_mfma_f32_32x32x16_bf16 v[112:127], v[140:143], a[76:79], v[112:127]
  ds_read_b64_tr_b16 v[132:133], v195 offset:40960
  v_mfma_f32_32x32x16_bf16 v[80:95], v[136:139], a[76:79], v[80:95]
  ds_read_b64_tr_b16 v[134:135], v195 offset:41472
  s_waitcnt vmcnt(15) lgkmcnt(4)
  v_mfma_f32_32x32x16_bf16 v[0:15], v[144:147], a[80:83], v[0:15]
  ds_read_b64_tr_b16 v[136:137], v192 offset:45056
  s_add_u32 m0, s29, 122880
  s_add_u32 s33, s28, 4423680
  v_mfma_f32_32x32x16_bf16 v[32:47], v[148:151], a[80:83], v[32:47]
  ds_read_b64_tr_b16 v[138:139], v192 offset:45568
  buffer_load_dwordx4 v206, s[8:11], s33 offen lds
  s_mov_b32 s34, 16384
  v_mfma_f32_32x32x16_bf16 v[48:63], v[148:151], a[84:87], v[48:63]
  ds_read_b64_tr_b16 v[140:141], v193 offset:45056
  buffer_load_dwordx4 a[128:131], v209, s[16:19], s34 offen offset:0 sc1
  s_mov_b32 s34, 53248
  v_mfma_f32_32x32x16_bf16 v[16:31], v[144:147], a[84:87], v[16:31]
  ds_read_b64_tr_b16 v[142:143], v193 offset:45568
  buffer_load_dwordx4 a[132:135], v209, s[16:19], s34 offen offset:0 sc1
  s_waitcnt lgkmcnt(4)
  v_mfma_f32_32x32x16_bf16 v[64:79], v[128:131], a[80:83], v[64:79]
  ds_read_b64_tr_b16 v[144:145], v194 offset:45056
  v_mfma_f32_32x32x16_bf16 v[96:111], v[132:135], a[80:83], v[96:111]
  ds_read_b64_tr_b16 v[146:147], v194 offset:45568
  v_mfma_f32_32x32x16_bf16 v[112:127], v[132:135], a[84:87], v[112:127]
  ds_read_b64_tr_b16 v[148:149], v195 offset:45056
  v_mfma_f32_32x32x16_bf16 v[80:95], v[128:131], a[84:87], v[80:95]
  ds_read_b64_tr_b16 v[150:151], v195 offset:45568
  s_waitcnt vmcnt(15) lgkmcnt(4)
  v_mfma_f32_32x32x16_bf16 v[0:15], v[136:139], a[88:91], v[0:15]
  ds_read_b64_tr_b16 v[128:129], v196 offset:0
  s_add_u32 m0, s29, 126976
  s_add_u32 s33, s28, 4571136
  v_mfma_f32_32x32x16_bf16 v[32:47], v[140:143], a[88:91], v[32:47]
  ds_read_b64_tr_b16 v[130:131], v196 offset:512
  buffer_load_dwordx4 v206, s[8:11], s33 offen lds
  s_mov_b32 s34, 16384
  v_mfma_f32_32x32x16_bf16 v[48:63], v[140:143], a[92:95], v[48:63]
  ds_read_b64_tr_b16 v[132:133], v197 offset:0
  buffer_load_dwordx4 a[136:139], v209, s[16:19], s34 offen offset:1024 sc1
  s_mov_b32 s34, 53248
  v_mfma_f32_32x32x16_bf16 v[16:31], v[136:139], a[92:95], v[16:31]
  ds_read_b64_tr_b16 v[134:135], v197 offset:512
  buffer_load_dwordx4 a[140:143], v209, s[16:19], s34 offen offset:1024 sc1
  s_waitcnt lgkmcnt(4)
  v_mfma_f32_32x32x16_bf16 v[64:79], v[144:147], a[88:91], v[64:79]
  ds_read_b64_tr_b16 v[136:137], v198 offset:0
  v_mfma_f32_32x32x16_bf16 v[96:111], v[148:151], a[88:91], v[96:111]
  ds_read_b64_tr_b16 v[138:139], v198 offset:512
  v_mfma_f32_32x32x16_bf16 v[112:127], v[148:151], a[92:95], v[112:127]
  ds_read_b64_tr_b16 v[140:141], v199 offset:0
  v_mfma_f32_32x32x16_bf16 v[80:95], v[144:147], a[92:95], v[80:95]
  ds_read_b64_tr_b16 v[142:143], v199 offset:512
  s_waitcnt vmcnt(15) lgkmcnt(4)
  v_mfma_f32_32x32x16_bf16 v[0:15], v[128:131], a[96:99], v[0:15]
  ds_read_b64_tr_b16 v[144:145], v196 offset:4096
  s_add_u32 m0, s29, 131072
  s_add_u32 s33, s28, 4718592
  v_mfma_f32_32x32x16_bf16 v[32:47], v[132:135], a[96:99], v[32:47]
  ds_read_b64_tr_b16 v[146:147], v196 offset:4608
  buffer_load_dwordx4 v206, s[8:11], s33 offen lds
  s_mov_b32 s34, 16384
  v_mfma_f32_32x32x16_bf16 v[48:63], v[132:135], a[100:103], v[48:63]
  ds_read_b64_tr_b16 v[148:149], v197 offset:4096
  buffer_load_dwordx4 a[144:147], v209, s[16:19], s34 offen offset:2048 sc1
  s_mov_b32 s34, 53248
  v_mfma_f32_32x32x16_bf16 v[16:31], v[128:131], a[100:103], v[16:31]
  ds_read_b64_tr_b16 v[150:151], v197 offset:4608
  buffer_load_dwordx4 a[148:151], v209, s[16:19], s34 offen offset:2048 sc1
  s_waitcnt lgkmcnt(4)
  v_mfma_f32_32x32x16_bf16 v[64:79], v[136:139], a[96:99], v[64:79]
  ds_read_b64_tr_b16 v[128:129], v198 offset:4096
  v_mfma_f32_32x32x16_bf16 v[96:111], v[140:143], a[96:99], v[96:111]
  ds_read_b64_tr_b16 v[130:131], v198 offset:4608
  v_mfma_f32_32x32x16_bf16 v[112:127], v[140:143], a[100:103], v[112:127]
  ds_read_b64_tr_b16 v[132:133], v199 offset:4096
  v_mfma_f32_32x32x16_bf16 v[80:95], v[136:139], a[100:103], v[80:95]
  ds_read_b64_tr_b16 v[134:135], v199 offset:4608
  s_waitcnt vmcnt(15) lgkmcnt(4)
  v_mfma_f32_32x32x16_bf16 v[0:15], v[144:147], a[104:107], v[0:15]
  ds_read_b64_tr_b16 v[136:137], v196 offset:8192
  s_add_u32 m0, s29, 135168
  s_add_u32 s33, s28, 4866048
  v_mfma_f32_32x32x16_bf16 v[32:47], v[148:151], a[104:107], v[32:47]
  ds_read_b64_tr_b16 v[138:139], v196 offset:8704
  buffer_load_dwordx4 v206, s[8:11], s33 offen lds
  s_mov_b32 s34, 16384
  v_mfma_f32_32x32x16_bf16 v[48:63], v[148:151], a[108:111], v[48:63]
  ds_read_b64_tr_b16 v[140:141], v197 offset:8192
  buffer_load_dwordx4 a[152:155], v209, s[16:19], s34 offen offset:3072 sc1
  s_mov_b32 s34, 53248
  v_mfma_f32_32x32x16_bf16 v[16:31], v[144:147], a[108:111], v[16:31]
  ds_read_b64_tr_b16 v[142:143], v197 offset:8704
  buffer_load_dwordx4 a[156:159], v209, s[16:19], s34 offen offset:3072 sc1
  s_waitcnt lgkmcnt(4)
  v_mfma_f32_32x32x16_bf16 v[64:79], v[128:131], a[104:107], v[64:79]
  ds_read_b64_tr_b16 v[144:145], v198 offset:8192
  v_mfma_f32_32x32x16_bf16 v[96:111], v[132:135], a[104:107], v[96:111]
  ds_read_b64_tr_b16 v[146:147], v198 offset:8704
  v_mfma_f32_32x32x16_bf16 v[112:127], v[132:135], a[108:111], v[112:127]
  ds_read_b64_tr_b16 v[148:149], v199 offset:8192
  v_mfma_f32_32x32x16_bf16 v[80:95], v[128:131], a[108:111], v[80:95]
  ds_read_b64_tr_b16 v[150:151], v199 offset:8704
  s_waitcnt vmcnt(15) lgkmcnt(4)
  v_mfma_f32_32x32x16_bf16 v[0:15], v[136:139], a[112:115], v[0:15]
  ds_read_b64_tr_b16 v[128:129], v196 offset:12288
  s_add_u32 m0, s29, 139264
  s_add_u32 s33, s28, 5013504
  v_mfma_f32_32x32x16_bf16 v[32:47], v[140:143], a[112:115], v[32:47]
  ds_read_b64_tr_b16 v[130:131], v196 offset:12800
  buffer_load_dwordx4 v206, s[8:11], s33 offen lds
  s_mov_b32 s34, 20480
  v_mfma_f32_32x32x16_bf16 v[48:63], v[140:143], a[116:119], v[48:63]
  ds_read_b64_tr_b16 v[132:133], v197 offset:12288
  buffer_load_dwordx4 a[160:163], v209, s[16:19], s34 offen offset:0 sc1
  s_mov_b32 s34, 57344
  v_mfma_f32_32x32x16_bf16 v[16:31], v[136:139], a[116:119], v[16:31]
  ds_read_b64_tr_b16 v[134:135], v197 offset:12800
  buffer_load_dwordx4 a[164:167], v209, s[16:19], s34 offen offset:0 sc1
  s_waitcnt lgkmcnt(4)
  v_mfma_f32_32x32x16_bf16 v[64:79], v[144:147], a[112:115], v[64:79]
  ds_read_b64_tr_b16 v[136:137], v198 offset:12288
  v_mfma_f32_32x32x16_bf16 v[96:111], v[148:151], a[112:115], v[96:111]
  ds_read_b64_tr_b16 v[138:139], v198 offset:12800
  v_mfma_f32_32x32x16_bf16 v[112:127], v[148:151], a[116:119], v[112:127]
  ds_read_b64_tr_b16 v[140:141], v199 offset:12288
  v_mfma_f32_32x32x16_bf16 v[80:95], v[144:147], a[116:119], v[80:95]
  ds_read_b64_tr_b16 v[142:143], v199 offset:12800
  s_waitcnt vmcnt(15) lgkmcnt(4)
  v_mfma_f32_32x32x16_bf16 v[0:15], v[128:131], a[120:123], v[0:15]
  ds_read_b64_tr_b16 v[144:145], v196 offset:16384
  s_add_u32 m0, s29, 143360
  s_add_u32 s33, s28, 5160960
  v_mfma_f32_32x32x16_bf16 v[32:47], v[132:135], a[120:123], v[32:47]
  ds_read_b64_tr_b16 v[146:147], v196 offset:16896
  buffer_load_dwordx4 v206, s[8:11], s33 offen lds
  s_mov_b32 s34, 20480
  v_mfma_f32_32x32x16_bf16 v[48:63], v[132:135], a[124:127], v[48:63]
  ds_read_b64_tr_b16 v[148:149], v197 offset:16384
  buffer_load_dwordx4 a[168:171], v209, s[16:19], s34 offen offset:1024 sc1
  s_mov_b32 s34, 57344
  v_mfma_f32_32x32x16_bf16 v[16:31], v[128:131], a[124:127], v[16:31]
  ds_read_b64_tr_b16 v[150:151], v197 offset:16896
  buffer_load_dwordx4 a[172:175], v209, s[16:19], s34 offen offset:1024 sc1
  s_waitcnt lgkmcnt(4)
  v_mfma_f32_32x32x16_bf16 v[64:79], v[136:139], a[120:123], v[64:79]
  ds_read_b64_tr_b16 v[128:129], v198 offset:16384
  v_mfma_f32_32x32x16_bf16 v[96:111], v[140:143], a[120:123], v[96:111]
  ds_read_b64_tr_b16 v[130:131], v198 offset:16896
  v_mfma_f32_32x32x16_bf16 v[112:127], v[140:143], a[124:127], v[112:127]
  ds_read_b64_tr_b16 v[132:133], v199 offset:16384
  v_mfma_f32_32x32x16_bf16 v[80:95], v[136:139], a[124:127], v[80:95]
  ds_read_b64_tr_b16 v[134:135], v199 offset:16896
  s_waitcnt vmcnt(15) lgkmcnt(4)
  v_mfma_f32_32x32x16_bf16 v[0:15], v[144:147], a[128:131], v[0:15]
  ds_read_b64_tr_b16 v[136:137], v196 offset:20480
  s_mov_b32 s34, 20480
  v_mfma_f32_32x32x16_bf16 v[32:47], v[148:151], a[128:131], v[32:47]
  ds_read_b64_tr_b16 v[138:139], v196 offset:20992
  buffer_load_dwordx4 a[176:179], v209, s[16:19], s34 offen offset:2048 sc1
  v_mfma_f32_32x32x16_bf16 v[48:63], v[148:151], a[132:135], v[48:63]
  ds_read_b64_tr_b16 v[140:141], v197 offset:20480
  s_mov_b32 s34, 57344
  v_mfma_f32_32x32x16_bf16 v[16:31], v[144:147], a[132:135], v[16:31]
  ds_read_b64_tr_b16 v[142:143], v197 offset:20992
  buffer_load_dwordx4 a[180:183], v209, s[16:19], s34 offen offset:2048 sc1
  s_waitcnt lgkmcnt(4)
  v_mfma_f32_32x32x16_bf16 v[64:79], v[128:131], a[128:131], v[64:79]
  ds_read_b64_tr_b16 v[144:145], v198 offset:20480
  v_mfma_f32_32x32x16_bf16 v[96:111], v[132:135], a[128:131], v[96:111]
  ds_read_b64_tr_b16 v[146:147], v198 offset:20992
  v_mfma_f32_32x32x16_bf16 v[112:127], v[132:135], a[132:135], v[112:127]
  ds_read_b64_tr_b16 v[148:149], v199 offset:20480
  v_mfma_f32_32x32x16_bf16 v[80:95], v[128:131], a[132:135], v[80:95]
  ds_read_b64_tr_b16 v[150:151], v199 offset:20992
  s_waitcnt vmcnt(14) lgkmcnt(4)
  v_mfma_f32_32x32x16_bf16 v[0:15], v[136:139], a[136:139], v[0:15]
  ds_read_b64_tr_b16 v[128:129], v196 offset:24576
  s_mov_b32 s34, 20480
  v_mfma_f32_32x32x16_bf16 v[32:47], v[140:143], a[136:139], v[32:47]
  ds_read_b64_tr_b16 v[130:131], v196 offset:25088
  buffer_load_dwordx4 a[184:187], v209, s[16:19], s34 offen offset:3072 sc1
  v_mfma_f32_32x32x16_bf16 v[48:63], v[140:143], a[140:143], v[48:63]
  ds_read_b64_tr_b16 v[132:133], v197 offset:24576
  s_mov_b32 s34, 57344
  v_mfma_f32_32x32x16_bf16 v[16:31], v[136:139], a[140:143], v[16:31]
  ds_read_b64_tr_b16 v[134:135], v197 offset:25088
  buffer_load_dwordx4 a[188:191], v209, s[16:19], s34 offen offset:3072 sc1
  s_waitcnt lgkmcnt(4)
  v_mfma_f32_32x32x16_bf16 v[64:79], v[144:147], a[136:139], v[64:79]
  ds_read_b64_tr_b16 v[136:137], v198 offset:24576
  v_mfma_f32_32x32x16_bf16 v[96:111], v[148:151], a[136:139], v[96:111]
  ds_read_b64_tr_b16 v[138:139], v198 offset:25088
  v_mfma_f32_32x32x16_bf16 v[112:127], v[148:151], a[140:143], v[112:127]
  ds_read_b64_tr_b16 v[140:141], v199 offset:24576
  v_mfma_f32_32x32x16_bf16 v[80:95], v[144:147], a[140:143], v[80:95]
  ds_read_b64_tr_b16 v[142:143], v199 offset:25088
  s_waitcnt vmcnt(13) lgkmcnt(4)
  v_mfma_f32_32x32x16_bf16 v[0:15], v[128:131], a[144:147], v[0:15]
  ds_read_b64_tr_b16 v[144:145], v196 offset:28672
  s_mov_b32 s34, 24576
  v_mfma_f32_32x32x16_bf16 v[32:47], v[132:135], a[144:147], v[32:47]
  ds_read_b64_tr_b16 v[146:147], v196 offset:29184
  buffer_load_dwordx4 a[192:195], v209, s[16:19], s34 offen offset:0 sc1
  v_mfma_f32_32x32x16_bf16 v[48:63], v[132:135], a[148:151], v[48:63]
  ds_read_b64_tr_b16 v[148:149], v197 offset:28672
  s_mov_b32 s34, 61440
  v_mfma_f32_32x32x16_bf16 v[16:31], v[128:131], a[148:151], v[16:31]
  ds_read_b64_tr_b16 v[150:151], v197 offset:29184
  buffer_load_dwordx4 a[196:199], v209, s[16:19], s34 offen offset:0 sc1
  s_waitcnt lgkmcnt(4)
  v_mfma_f32_32x32x16_bf16 v[64:79], v[136:139], a[144:147], v[64:79]
  ds_read_b64_tr_b16 v[128:129], v198 offset:28672
  v_mfma_f32_32x32x16_bf16 v[96:111], v[140:143], a[144:147], v[96:111]
  ds_read_b64_tr_b16 v[130:131], v198 offset:29184
  v_mfma_f32_32x32x16_bf16 v[112:127], v[140:143], a[148:151], v[112:127]
  ds_read_b64_tr_b16 v[132:133], v199 offset:28672
  v_mfma_f32_32x32x16_bf16 v[80:95], v[136:139], a[148:151], v[80:95]
  ds_read_b64_tr_b16 v[134:135], v199 offset:29184
  s_waitcnt vmcnt(12) lgkmcnt(4)
  v_mfma_f32_32x32x16_bf16 v[0:15], v[144:147], a[152:155], v[0:15]
  ds_read_b64_tr_b16 v[136:137], v196 offset:32768
  s_mov_b32 s34, 24576
  v_mfma_f32_32x32x16_bf16 v[32:47], v[148:151], a[152:155], v[32:47]
  ds_read_b64_tr_b16 v[138:139], v196 offset:33280
  buffer_load_dwordx4 a[200:203], v209, s[16:19], s34 offen offset:1024 sc1
  v_mfma_f32_32x32x16_bf16 v[48:63], v[148:151], a[156:159], v[48:63]
  ds_read_b64_tr_b16 v[140:141], v197 offset:32768
  s_mov_b32 s34, 61440
  v_mfma_f32_32x32x16_bf16 v[16:31], v[144:147], a[156:159], v[16:31]
  ds_read_b64_tr_b16 v[142:143], v197 offset:33280
  buffer_load_dwordx4 a[204:207], v209, s[16:19], s34 offen offset:1024 sc1
  s_waitcnt lgkmcnt(4)
  v_mfma_f32_32x32x16_bf16 v[64:79], v[128:131], a[152:155], v[64:79]
  ds_read_b64_tr_b16 v[144:145], v198 offset:32768
  v_mfma_f32_32x32x16_bf16 v[96:111], v[132:135], a[152:155], v[96:111]
  ds_read_b64_tr_b16 v[146:147], v198 offset:33280
  v_mfma_f32_32x32x16_bf16 v[112:127], v[132:135], a[156:159], v[112:127]
  ds_read_b64_tr_b16 v[148:149], v199 offset:32768
  v_mfma_f32_32x32x16_bf16 v[80:95], v[128:131], a[156:159], v[80:95]
  ds_read_b64_tr_b16 v[150:151], v199 offset:33280
  s_waitcnt vmcnt(11) lgkmcnt(4)
  v_mfma_f32_32x32x16_bf16 v[0:15], v[136:139], a[160:163], v[0:15]
  ds_read_b64_tr_b16 v[128:129], v196 offset:36864
  s_mov_b32 s34, 24576
  v_mfma_f32_32x32x16_bf16 v[32:47], v[140:143], a[160:163], v[32:47]
  ds_read_b64_tr_b16 v[130:131], v196 offset:37376
  buffer_load_dwordx4 a[208:211], v209, s[16:19], s34 offen offset:2048 sc1
  v_mfma_f32_32x32x16_bf16 v[48:63], v[140:143], a[164:167], v[48:63]
  ds_read_b64_tr_b16 v[132:133], v197 offset:36864
  s_mov_b32 s34, 61440
  v_mfma_f32_32x32x16_bf16 v[16:31], v[136:139], a[164:167], v[16:31]
  ds_read_b64_tr_b16 v[134:135], v197 offset:37376
  buffer_load_dwordx4 a[212:215], v209, s[16:19], s34 offen offset:2048 sc1
  s_waitcnt lgkmcnt(4)
  v_mfma_f32_32x32x16_bf16 v[64:79], v[144:147], a[160:163], v[64:79]
  ds_read_b64_tr_b16 v[136:137], v198 offset:36864
  v_mfma_f32_32x32x16_bf16 v[96:111], v[148:151], a[160:163], v[96:111]
  ds_read_b64_tr_b16 v[138:139], v198 offset:37376
  v_mfma_f32_32x32x16_bf16 v[112:127], v[148:151], a[164:167], v[112:127]
  ds_read_b64_tr_b16 v[140:141], v199 offset:36864
  v_mfma_f32_32x32x16_bf16 v[80:95], v[144:147], a[164:167], v[80:95]
  ds_read_b64_tr_b16 v[142:143], v199 offset:37376
  s_waitcnt vmcnt(10) lgkmcnt(4)
  v_mfma_f32_32x32x16_bf16 v[0:15], v[128:131], a[168:171], v[0:15]
  ds_read_b64_tr_b16 v[144:145], v196 offset:40960
  s_mov_b32 s34, 24576
  v_mfma_f32_32x32x16_bf16 v[32:47], v[132:135], a[168:171], v[32:47]
  ds_read_b64_tr_b16 v[146:147], v196 offset:41472
  buffer_load_dwordx4 a[216:219], v209, s[16:19], s34 offen offset:3072 sc1
  v_mfma_f32_32x32x16_bf16 v[48:63], v[132:135], a[172:175], v[48:63]
  ds_read_b64_tr_b16 v[148:149], v197 offset:40960
  s_mov_b32 s34, 61440
  v_mfma_f32_32x32x16_bf16 v[16:31], v[128:131], a[172:175], v[16:31]
  ds_read_b64_tr_b16 v[150:151], v197 offset:41472
  buffer_load_dwordx4 a[220:223], v209, s[16:19], s34 offen offset:3072 sc1
  s_waitcnt lgkmcnt(4)
  v_mfma_f32_32x32x16_bf16 v[64:79], v[136:139], a[168:171], v[64:79]
  ds_read_b64_tr_b16 v[128:129], v196 offset:45056
  v_mfma_f32_32x32x16_bf16 v[96:111], v[140:143], a[168:171], v[96:111]
  ds_read_b64_tr_b16 v[130:131], v196 offset:45568
  v_mfma_f32_32x32x16_bf16 v[112:127], v[140:143], a[172:175], v[112:127]
  ds_read_b64_tr_b16 v[132:133], v197 offset:45056
  v_mfma_f32_32x32x16_bf16 v[80:95], v[136:139], a[172:175], v[80:95]
  ds_read_b64_tr_b16 v[134:135], v197 offset:45568
  s_barrier
  s_waitcnt vmcnt(10) lgkmcnt(4)
  v_mfma_f32_32x32x16_bf16 v[0:15], v[144:147], a[176:179], v[0:15]
  ds_read_b64_tr_b16 v[136:137], v200 offset:0
  s_mov_b32 s34, 28672
  v_mfma_f32_32x32x16_bf16 v[32:47], v[148:151], a[176:179], v[32:47]
  ds_read_b64_tr_b16 v[138:139], v200 offset:512
  buffer_load_dwordx4 a[224:227], v209, s[16:19], s34 offen offset:0 sc1
  v_mfma_f32_32x32x16_bf16 v[48:63], v[148:151], a[180:183], v[48:63]
  ds_read_b64_tr_b16 v[140:141], v201 offset:0
  s_mov_b32 s34, 65536
  v_mfma_f32_32x32x16_bf16 v[16:31], v[144:147], a[180:183], v[16:31]
  ds_read_b64_tr_b16 v[142:143], v201 offset:512
  buffer_load_dwordx4 a[228:231], v209, s[16:19], s34 offen offset:0 sc1
  s_waitcnt vmcnt(10) lgkmcnt(4)
  v_mfma_f32_32x32x16_bf16 v[0:15], v[128:131], a[184:187], v[0:15]
  ds_read_b64_tr_b16 v[144:145], v200 offset:4096
  s_mov_b32 s34, 28672
  v_mfma_f32_32x32x16_bf16 v[32:47], v[132:135], a[184:187], v[32:47]
  ds_read_b64_tr_b16 v[146:147], v200 offset:4608
  buffer_load_dwordx4 a[232:235], v209, s[16:19], s34 offen offset:1024 sc1
  v_mfma_f32_32x32x16_bf16 v[48:63], v[132:135], a[188:191], v[48:63]
  ds_read_b64_tr_b16 v[148:149], v201 offset:4096
  s_mov_b32 s34, 65536
  v_mfma_f32_32x32x16_bf16 v[16:31], v[128:131], a[188:191], v[16:31]
  ds_read_b64_tr_b16 v[150:151], v201 offset:4608
  buffer_load_dwordx4 a[236:239], v209, s[16:19], s34 offen offset:1024 sc1
  s_waitcnt vmcnt(10) lgkmcnt(4)
  v_mfma_f32_32x32x16_bf16 v[0:15], v[136:139], a[192:195], v[0:15]
  ds_read_b64_tr_b16 v[128:129], v200 offset:8192
  s_mov_b32 s34, 28672
  v_mfma_f32_32x32x16_bf16 v[32:47], v[140:143], a[192:195], v[32:47]
  ds_read_b64_tr_b16 v[130:131], v200 offset:8704
  buffer_load_dwordx4 a[240:243], v209, s[16:19], s34 offen offset:2048 sc1
  v_mfma_f32_32x32x16_bf16 v[48:63], v[140:143], a[196:199], v[48:63]
  ds_read_b64_tr_b16 v[132:133], v201 offset:8192
  s_mov_b32 s34, 65536
  v_mfma_f32_32x32x16_bf16 v[16:31], v[136:139], a[196:199], v[16:31]
  ds_read_b64_tr_b16 v[134:135], v201 offset:8704
  buffer_load_dwordx4 a[244:247], v209, s[16:19], s34 offen offset:2048 sc1
  s_waitcnt vmcnt(10) lgkmcnt(4)
  v_mfma_f32_32x32x16_bf16 v[0:15], v[144:147], a[200:203], v[0:15]
  ds_read_b64_tr_b16 v[136:137], v200 offset:12288
  s_mov_b32 s34, 28672
  v_mfma_f32_32x32x16_bf16 v[32:47], v[148:151], a[200:203], v[32:47]
  ds_read_b64_tr_b16 v[138:139], v200 offset:12800
  buffer_load_dwordx4 a[248:251], v209, s[16:19], s34 offen offset:3072 sc1
  v_mfma_f32_32x32x16_bf16 v[48:63], v[148:151], a[204:207], v[48:63]
  ds_read_b64_tr_b16 v[140:141], v201 offset:12288
  s_mov_b32 s34, 65536
  v_mfma_f32_32x32x16_bf16 v[16:31], v[144:147], a[204:207], v[16:31]
  ds_read_b64_tr_b16 v[142:143], v201 offset:12800
  buffer_load_dwordx4 a[252:255], v209, s[16:19], s34 offen offset:3072 sc1
  s_waitcnt vmcnt(10) lgkmcnt(4)
  v_mfma_f32_32x32x16_bf16 v[0:15], v[128:131], a[208:211], v[0:15]
  ds_read_b64_tr_b16 v[144:145], v200 offset:16384
  s_mov_b32 s34, 32768
  v_mfma_f32_32x32x16_bf16 v[32:47], v[132:135], a[208:211], v[32:47]
  ds_read_b64_tr_b16 v[146:147], v200 offset:16896
  buffer_load_dwordx4 v[152:155], v209, s[16:19], s34 offen offset:0 sc1
  v_mfma_f32_32x32x16_bf16 v[48:63], v[132:135], a[212:215], v[48:63]
  ds_read_b64_tr_b16 v[148:149], v201 offset:16384
  s_mov_b32 s34, 69632
  v_mfma_f32_32x32x16_bf16 v[16:31], v[128:131], a[212:215], v[16:31]
  ds_read_b64_tr_b16 v[150:151], v201 offset:16896
  buffer_load_dwordx4 v[156:159], v209, s[16:19], s34 offen offset:0 sc1
  s_waitcnt vmcnt(10) lgkmcnt(4)
  v_mfma_f32_32x32x16_bf16 v[0:15], v[136:139], a[216:219], v[0:15]
  ds_read_b64_tr_b16 v[128:129], v200 offset:20480
  s_mov_b32 s34, 32768
  v_mfma_f32_32x32x16_bf16 v[32:47], v[140:143], a[216:219], v[32:47]
  ds_read_b64_tr_b16 v[130:131], v200 offset:20992
  buffer_load_dwordx4 v[160:163], v209, s[16:19], s34 offen offset:1024 sc1
  v_mfma_f32_32x32x16_bf16 v[48:63], v[140:143], a[220:223], v[48:63]
  ds_read_b64_tr_b16 v[132:133], v201 offset:20480
  s_mov_b32 s34, 69632
  v_mfma_f32_32x32x16_bf16 v[16:31], v[136:139], a[220:223], v[16:31]
  ds_read_b64_tr_b16 v[134:135], v201 offset:20992
  buffer_load_dwordx4 v[164:167], v209, s[16:19], s34 offen offset:1024 sc1
  s_waitcnt vmcnt(10) lgkmcnt(4)
  v_mfma_f32_32x32x16_bf16 v[0:15], v[144:147], a[224:227], v[0:15]
  ds_read_b64_tr_b16 v[136:137], v200 offset:24576
  s_mov_b32 s34, 32768
  v_mfma_f32_32x32x16_bf16 v[32:47], v[148:151], a[224:227], v[32:47]
  ds_read_b64_tr_b16 v[138:139], v200 offset:25088
  buffer_load_dwordx4 v[168:171], v209, s[16:19], s34 offen offset:2048 sc1
  v_mfma_f32_32x32x16_bf16 v[48:63], v[148:151], a[228:231], v[48:63]
  ds_read_b64_tr_b16 v[140:141], v201 offset:24576
  s_mov_b32 s34, 69632
  v_mfma_f32_32x32x16_bf16 v[16:31], v[144:147], a[228:231], v[16:31]
  ds_read_b64_tr_b16 v[142:143], v201 offset:25088
  buffer_load_dwordx4 v[172:175], v209, s[16:19], s34 offen offset:2048 sc1
  s_waitcnt vmcnt(10) lgkmcnt(4)
  v_mfma_f32_32x32x16_bf16 v[0:15], v[128:131], a[232:235], v[0:15]
  ds_read_b64_tr_b16 v[144:145], v200 offset:28672
  s_mov_b32 s34, 32768
  v_mfma_f32_32x32x16_bf16 v[32:47], v[132:135], a[232:235], v[32:47]
  ds_read_b64_tr_b16 v[146:147], v200 offset:29184
  buffer_load_dwordx4 v[176:179], v209, s[16:19], s34 offen offset:3072 sc1
  v_mfma_f32_32x32x16_bf16 v[48:63], v[132:135], a[236:239], v[48:63]
  ds_read_b64_tr_b16 v[148:149], v201 offset:28672
  s_mov_b32 s34, 69632
  v_mfma_f32_32x32x16_bf16 v[16:31], v[128:131], a[236:239], v[16:31]
  ds_read_b64_tr_b16 v[150:151], v201 offset:29184
  buffer_load_dwordx4 v[180:183], v209, s[16:19], s34 offen offset:3072 sc1
  s_barrier
  s_waitcnt vmcnt(10) lgkmcnt(4)
  v_mfma_f32_32x32x16_bf16 v[0:15], v[136:139], a[240:243], v[0:15]
  ds_read_b64_tr_b16 v[128:129], v200 offset:32768
  s_add_u32 m0, s29, 0
  s_add_u32 s33, s28, 128
  v_mfma_f32_32x32x16_bf16 v[32:47], v[140:143], a[240:243], v[32:47]
  ds_read_b64_tr_b16 v[130:131], v200 offset:33280
  buffer_load_dwordx4 v206, s[8:11], s33 offen lds
  s_add_u32 m0, s29, 4096
  v_mfma_f32_32x32x16_bf16 v[48:63], v[140:143], a[244:247], v[48:63]
  ds_read_b64_tr_b16 v[132:133], v201 offset:32768
  s_add_u32 s33, s28, 147584
  v_mfma_f32_32x32x16_bf16 v[16:31], v[136:139], a[244:247], v[16:31]
  ds_read_b64_tr_b16 v[134:135], v201 offset:33280
  buffer_load_dwordx4 v206, s[8:11], s33 offen lds
  s_waitcnt vmcnt(10) lgkmcnt(4)
  v_mfma_f32_32x32x16_bf16 v[0:15], v[144:147], a[248:251], v[0:15]
  ds_read_b64_tr_b16 v[136:137], v200 offset:36864
  s_add_u32 m0, s29, 8192
  v_mfma_f32_32x32x16_bf16 v[32:47], v[148:151], a[248:251], v[32:47]
  ds_read_b64_tr_b16 v[138:139], v200 offset:37376
  s_add_u32 s33, s28, 295040
  v_mfma_f32_32x32x16_bf16 v[48:63], v[148:151], a[252:255], v[48:63]
  ds_read_b64_tr_b16 v[140:141], v201 offset:36864
  buffer_load_dwordx4 v206, s[8:11], s33 offen lds
  v_mfma_f32_32x32x16_bf16 v[16:31], v[144:147], a[252:255], v[16:31]
  ds_read_b64_tr_b16 v[142:143], v201 offset:37376
  s_waitcnt vmcnt(9) lgkmcnt(4)
  v_mfma_f32_32x32x16_bf16 v[0:15], v[128:131], v[152:155], v[0:15]
  ds_read_b64_tr_b16 v[144:145], v200 offset:40960
  s_add_u32 m0, s29, 12288
  s_add_u32 s33, s28, 442496
  v_mfma_f32_32x32x16_bf16 v[32:47], v[132:135], v[152:155], v[32:47]
  ds_read_b64_tr_b16 v[146:147], v200 offset:41472
  buffer_load_dwordx4 v206, s[8:11], s33 offen lds
  s_add_u32 m0, s29, 16384
  v_mfma_f32_32x32x16_bf16 v[48:63], v[132:135], v[156:159], v[48:63]
  ds_read_b64_tr_b16 v[148:149], v201 offset:40960
  s_add_u32 s33, s28, 589952
  v_mfma_f32_32x32x16_bf16 v[16:31], v[128:131], v[156:159], v[16:31]
  ds_read_b64_tr_b16 v[150:151], v201 offset:41472
  buffer_load_dwordx4 v206, s[8:11], s33 offen lds
  s_waitcnt vmcnt(9) lgkmcnt(4)
  v_mfma_f32_32x32x16_bf16 v[0:15], v[136:139], v[160:163], v[0:15]
  ds_read_b64_tr_b16 v[128:129], v200 offset:45056
  s_add_u32 m0, s29, 20480
  v_mfma_f32_32x32x16_bf16 v[32:47], v[140:143], v[160:163], v[32:47]
  ds_read_b64_tr_b16 v[130:131], v200 offset:45568
  s_add_u32 s33, s28, 737408
  v_mfma_f32_32x32x16_bf16 v[48:63], v[140:143], v[164:167], v[48:63]
  ds_read_b64_tr_b16 v[132:133], v201 offset:45056
  buffer_load_dwordx4 v206, s[8:11], s33 offen lds
  v_mfma_f32_32x32x16_bf16 v[16:31], v[136:139], v[164:167], v[16:31]
  ds_read_b64_tr_b16 v[134:135], v201 offset:45568
  s_waitcnt vmcnt(8) lgkmcnt(4)
  v_mfma_f32_32x32x16_bf16 v[0:15], v[144:147], v[168:171], v[0:15]
  ds_read_b64_tr_b16 v[136:137], v198 offset:40960
  s_add_u32 m0, s29, 24576
  s_add_u32 s33, s28, 884864
  v_mfma_f32_32x32x16_bf16 v[32:47], v[148:151], v[168:171], v[32:47]
  ds_read_b64_tr_b16 v[138:139], v198 offset:41472
  buffer_load_dwordx4 v206, s[8:11], s33 offen lds
  s_add_u32 m0, s29, 28672
  v_mfma_f32_32x32x16_bf16 v[48:63], v[148:151], v[172:175], v[48:63]
  ds_read_b64_tr_b16 v[140:141], v199 offset:40960
  s_add_u32 s33, s28, 1032320
  v_mfma_f32_32x32x16_bf16 v[16:31], v[144:147], v[172:175], v[16:31]
  ds_read_b64_tr_b16 v[142:143], v199 offset:41472
  buffer_load_dwordx4 v206, s[8:11], s33 offen lds
  s_waitcnt vmcnt(8) lgkmcnt(4)
  v_mfma_f32_32x32x16_bf16 v[0:15], v[128:131], v[176:179], v[0:15]
  ds_read_b64_tr_b16 v[144:145], v198 offset:45056
  s_add_u32 m0, s29, 32768
  v_mfma_f32_32x32x16_bf16 v[32:47], v[132:135], v[176:179], v[32:47]
  ds_read_b64_tr_b16 v[146:147], v198 offset:45568
  s_add_u32 s33, s28, 1179776
  v_mfma_f32_32x32x16_bf16 v[48:63], v[132:135], v[180:183], v[48:63]
  ds_read_b64_tr_b16 v[148:149], v199 offset:45056
  buffer_load_dwordx4 v206, s[8:11], s33 offen lds
  v_mfma_f32_32x32x16_bf16 v[16:31], v[128:131], v[180:183], v[16:31]
  ds_read_b64_tr_b16 v[150:151], v199 offset:45568
  s_waitcnt lgkmcnt(4)
  v_mfma_f32_32x32x16_bf16 v[64:79], v[136:139], a[176:179], v[64:79]
  ds_read_b64_tr_b16 v[128:129], v202 offset:0
  s_add_u32 m0, s29, 36864
  s_add_u32 s33, s28, 1327232
  v_mfma_f32_32x32x16_bf16 v[96:111], v[140:143], a[176:179], v[96:111]
  ds_read_b64_tr_b16 v[130:131], v202 offset:512
  buffer_load_dwordx4 v206, s[8:11], s33 offen lds
  s_add_u32 m0, s29, 40960
  v_mfma_f32_32x32x16_bf16 v[112:127], v[140:143], a[180:183], v[112:127]
  ds_read_b64_tr_b16 v[132:133], v203 offset:0
  s_add_u32 s33, s28, 1474688
  v_mfma_f32_32x32x16_bf16 v[80:95], v[136:139], a[180:183], v[80:95]
  ds_read_b64_tr_b16 v[134:135], v203 offset:512
  buffer_load_dwordx4 v206, s[8:11], s33 offen lds
  s_waitcnt lgkmcnt(4)
  v_mfma_f32_32x32x16_bf16 v[64:79], v[144:147], a[184:187], v[64:79]
  ds_read_b64_tr_b16 v[136:137], v202 offset:4096
  s_add_u32 m0, s29, 45056
  v_mul_f32 v184, 0xbfb8aa3b, v0
  v_mul_f32 v185, 0xbfb8aa3b, v1
  v_mul_f32 v186, 0xbfb8aa3b, v2
  v_mul_f32 v187, 0xbfb8aa3b, v3
  v_exp_f32 v184, v184
  v_mfma_f32_32x32x16_bf16 v[96:111], v[148:151], a[184:187], v[96:111]
  ds_read_b64_tr_b16 v[138:139], v202 offset:4608
  s_add_u32 s33, s28, 1622144
  v_exp_f32 v185, v185
  v_exp_f32 v186, v186
  v_exp_f32 v187, v187
  v_mfma_f32_32x32x16_bf16 v[112:127], v[148:151], a[188:191], v[112:127]
  ds_read_b64_tr_b16 v[140:141], v203 offset:4096
  buffer_load_dwordx4 v206, s[8:11], s33 offen lds
  v_mul_f32 v8, v0, v8
  v_mul_f32 v9, v1, v9
  v_mul_f32 v10, v2, v10
  v_mul_f32 v11, v3, v11
  v_add_f32 v184, 1.0, v184
  v_mfma_f32_32x32x16_bf16 v[80:95], v[144:147], a[188:191], v[80:95]
  ds_read_b64_tr_b16 v[142:143], v203 offset:4608
  v_add_f32 v185, 1.0, v185
  v_add_f32 v186, 1.0, v186
  v_add_f32 v187, 1.0, v187
  v_rcp_f32 v184, v184
  s_barrier
  s_waitcnt lgkmcnt(4)
  v_mfma_f32_32x32x16_bf16 v[64:79], v[128:131], a[192:195], v[64:79]
  ds_read_b64_tr_b16 v[144:145], v202 offset:8192
  s_add_u32 m0, s29, 49152
  s_add_u32 s33, s28, 1769600
  v_rcp_f32 v185, v185
  v_rcp_f32 v186, v186
  v_rcp_f32 v187, v187
  v_mfma_f32_32x32x16_bf16 v[96:111], v[132:135], a[192:195], v[96:111]
  ds_read_b64_tr_b16 v[146:147], v202 offset:8704
  buffer_load_dwordx4 v206, s[8:11], s33 offen lds
  s_add_u32 m0, s29, 53248
  v_mul_f32 v8, v8, v184
  v_mul_f32 v9, v9, v185
  v_mul_f32 v10, v10, v186
  v_mul_f32 v11, v11, v187
  v_cvt_pk_bf16_f32 v188, v8, v9
  v_cvt_pk_bf16_f32 v189, v10, v11
  v_mfma_f32_32x32x16_bf16 v[112:127], v[132:135], a[196:199], v[112:127]
  ds_read_b64_tr_b16 v[148:149], v203 offset:8192
  s_add_u32 s33, s28, 1917056
  v_mul_f32 v184, 0xbfb8aa3b, v4
  v_mul_f32 v185, 0xbfb8aa3b, v5
  v_mul_f32 v186, 0xbfb8aa3b, v6
  v_mul_f32 v187, 0xbfb8aa3b, v7
  v_exp_f32 v184, v184
  v_mfma_f32_32x32x16_bf16 v[80:95], v[128:131], a[196:199], v[80:95]
  ds_read_b64_tr_b16 v[150:151], v203 offset:8704
  buffer_load_dwordx4 v206, s[8:11], s33 offen lds
  v_exp_f32 v185, v185
  v_exp_f32 v186, v186
  s_waitcnt lgkmcnt(4)
  v_mfma_f32_32x32x16_bf16 v[64:79], v[136:139], a[200:203], v[64:79]
  ds_read_b64_tr_b16 v[128:129], v202 offset:12288
  s_add_u32 m0, s29, 57344
  v_exp_f32 v187, v187
  v_mul_f32 v12, v4, v12
  v_mul_f32 v13, v5, v13
  v_mul_f32 v14, v6, v14
  v_mul_f32 v15, v7, v15
  v_mfma_f32_32x32x16_bf16 v[96:111], v[140:143], a[200:203], v[96:111]
  ds_read_b64_tr_b16 v[130:131], v202 offset:12800
  s_add_u32 s33, s28, 2064512
  v_add_f32 v184, 1.0, v184
  v_add_f32 v185, 1.0, v185
  v_add_f32 v186, 1.0, v186
  v_add_f32 v187, 1.0, v187
  v_rcp_f32 v184, v184
  v_mfma_f32_32x32x16_bf16 v[112:127], v[140:143], a[204:207], v[112:127]
  ds_read_b64_tr_b16 v[132:133], v203 offset:12288
  buffer_load_dwordx4 v206, s[8:11], s33 offen lds
  v_rcp_f32 v185, v185
  v_rcp_f32 v186, v186
  v_rcp_f32 v187, v187
  v_mfma_f32_32x32x16_bf16 v[80:95], v[136:139], a[204:207], v[80:95]
  ds_read_b64_tr_b16 v[134:135], v203 offset:12800
  v_mul_f32 v12, v12, v184
  v_mul_f32 v13, v13, v185
  v_mul_f32 v14, v14, v186
  v_mul_f32 v15, v15, v187
  s_waitcnt lgkmcnt(4)
  v_mfma_f32_32x32x16_bf16 v[64:79], v[144:147], a[208:211], v[64:79]
  ds_read_b64_tr_b16 v[136:137], v202 offset:16384
  s_add_u32 m0, s29, 61440
  s_add_u32 s33, s28, 2211968
  v_cvt_pk_bf16_f32 v190, v12, v13
  v_cvt_pk_bf16_f32 v191, v14, v15
  s_add_u32 s34, s49, 0
  buffer_store_dwordx4 v[188:191], v208, s[20:23], s34 offen sc1
  v_mul_f32 v184, 0xbfb8aa3b, v16
  v_mul_f32 v185, 0xbfb8aa3b, v17
  v_mfma_f32_32x32x16_bf16 v[96:111], v[148:151], a[208:211], v[96:111]
  ds_read_b64_tr_b16 v[138:139], v202 offset:16896
  buffer_load_dwordx4 v206, s[8:11], s33 offen lds
  s_add_u32 m0, s29, 65536
  v_mul_f32 v186, 0xbfb8aa3b, v18
  v_mul_f32 v187, 0xbfb8aa3b, v19
  v_exp_f32 v184, v184
  v_exp_f32 v185, v185
  v_mfma_f32_32x32x16_bf16 v[112:127], v[148:151], a[212:215], v[112:127]
  ds_read_b64_tr_b16 v[140:141], v203 offset:16384
  s_add_u32 s33, s28, 2359424
  v_exp_f32 v186, v186
  v_exp_f32 v187, v187
  v_mul_f32 v24, v16, v24
  v_mfma_f32_32x32x16_bf16 v[80:95], v[144:147], a[212:215], v[80:95]
  ds_read_b64_tr_b16 v[142:143], v203 offset:16896
  buffer_load_dwordx4 v206, s[8:11], s33 offen lds
  v_mul_f32 v25, v17, v25
  v_mul_f32 v26, v18, v26
  v_mul_f32 v27, v19, v27
  v_add_f32 v184, 1.0, v184
  v_add_f32 v185, 1.0, v185
  s_waitcnt lgkmcnt(4)
  v_mfma_f32_32x32x16_bf16 v[64:79], v[128:131], a[216:219], v[64:79]
  ds_read_b64_tr_b16 v[144:145], v202 offset:20480
  s_add_u32 m0, s29, 69632
  v_add_f32 v186, 1.0, v186
  v_add_f32 v187, 1.0, v187
  v_rcp_f32 v184, v184
  v_rcp_f32 v185, v185
  v_mfma_f32_32x32x16_bf16 v[96:111], v[132:135], a[216:219], v[96:111]
  ds_read_b64_tr_b16 v[146:147], v202 offset:20992
  s_add_u32 s33, s28, 2506880
  v_rcp_f32 v186, v186
  v_rcp_f32 v187, v187
  v_mul_f32 v24, v24, v184
  v_mul_f32 v25, v25, v185
  v_mfma_f32_32x32x16_bf16 v[112:127], v[132:135], a[220:223], v[112:127]
  ds_read_b64_tr_b16 v[148:149], v203 offset:20480
  buffer_load_dwordx4 v206, s[8:11], s33 offen lds
  v_mul_f32 v26, v26, v186
  v_mul_f32 v27, v27, v187
  v_cvt_pk_bf16_f32 v188, v24, v25
  v_cvt_pk_bf16_f32 v189, v26, v27
  v_mul_f32 v184, 0xbfb8aa3b, v20
  v_mfma_f32_32x32x16_bf16 v[80:95], v[128:131], a[220:223], v[80:95]
  ds_read_b64_tr_b16 v[150:151], v203 offset:20992
  v_mul_f32 v185, 0xbfb8aa3b, v21
  v_mul_f32 v186, 0xbfb8aa3b, v22
  v_mul_f32 v187, 0xbfb8aa3b, v23
  v_exp_f32 v184, v184
  s_waitcnt lgkmcnt(4)
  v_mfma_f32_32x32x16_bf16 v[64:79], v[136:139], a[224:227], v[64:79]
  ds_read_b64_tr_b16 v[128:129], v202 offset:24576
  s_add_u32 m0, s29, 73728
  s_add_u32 s33, s28, 2654336
  v_exp_f32 v185, v185
  v_exp_f32 v186, v186
  v_exp_f32 v187, v187
  v_mfma_f32_32x32x16_bf16 v[96:111], v[140:143], a[224:227], v[96:111]
  ds_read_b64_tr_b16 v[130:131], v202 offset:25088
  buffer_load_dwordx4 v206, s[8:11], s33 offen lds
  s_add_u32 m0, s29, 77824
  v_mul_f32 v28, v20, v28
  v_mul_f32 v29, v21, v29
  v_mul_f32 v30, v22, v30
  v_mul_f32 v31, v23, v31
  v_add_f32 v184, 1.0, v184
  v_add_f32 v185, 1.0, v185
  v_mfma_f32_32x32x16_bf16 v[112:127], v[140:143], a[228:231], v[112:127]
  ds_read_b64_tr_b16 v[132:133], v203 offset:24576
  s_add_u32 s33, s28, 2801792
  v_add_f32 v186, 1.0, v186
  v_add_f32 v187, 1.0, v187
  v_rcp_f32 v184, v184
  v_rcp_f32 v185, v185
  v_mfma_f32_32x32x16_bf16 v[80:95], v[136:139], a[228:231], v[80:95]
  ds_read_b64_tr_b16 v[134:135], v203 offset:25088
  buffer_load_dwordx4 v206, s[8:11], s33 offen lds
  v_rcp_f32 v186, v186
  v_rcp_f32 v187, v187
  s_waitcnt lgkmcnt(4)
  v_mfma_f32_32x32x16_bf16 v[64:79], v[144:147], a[232:235], v[64:79]
  ds_read_b64_tr_b16 v[136:137], v202 offset:28672
  s_add_u32 m0, s29, 81920
  v_mul_f32 v28, v28, v184
  v_mul_f32 v29, v29, v185
  v_mul_f32 v30, v30, v186
  v_mul_f32 v31, v31, v187
  v_cvt_pk_bf16_f32 v190, v28, v29
  v_cvt_pk_bf16_f32 v191, v30, v31
  v_mfma_f32_32x32x16_bf16 v[96:111], v[148:151], a[232:235], v[96:111]
  ds_read_b64_tr_b16 v[138:139], v202 offset:29184
  s_add_u32 s33, s28, 2949248
  s_add_u32 s34, s49, 294912
  buffer_store_dwordx4 v[188:191], v208, s[20:23], s34 offen sc1
  v_mul_f32 v184, 0xbfb8aa3b, v32
  v_mul_f32 v185, 0xbfb8aa3b, v33
  v_mul_f32 v186, 0xbfb8aa3b, v34
  v_mul_f32 v187, 0xbfb8aa3b, v35
  v_mfma_f32_32x32x16_bf16 v[112:127], v[148:151], a[236:239], v[112:127]
  ds_read_b64_tr_b16 v[140:141], v203 offset:28672
  buffer_load_dwordx4 v206, s[8:11], s33 offen lds
  v_exp_f32 v184, v184
  v_exp_f32 v185, v185
  v_exp_f32 v186, v186
  v_mfma_f32_32x32x16_bf16 v[80:95], v[144:147], a[236:239], v[80:95]
  ds_read_b64_tr_b16 v[142:143], v203 offset:29184
  v_exp_f32 v187, v187
  v_mul_f32 v40, v32, v40
  v_mul_f32 v41, v33, v41
  s_waitcnt lgkmcnt(4)
  v_mfma_f32_32x32x16_bf16 v[64:79], v[128:131], a[240:243], v[64:79]
  ds_read_b64_tr_b16 v[144:145], v202 offset:32768
  s_add_u32 m0, s29, 86016
  s_add_u32 s33, s28, 3096704
  v_mul_f32 v42, v34, v42
  v_mul_f32 v43, v35, v43
  v_add_f32 v184, 1.0, v184
  v_add_f32 v185, 1.0, v185
  v_add_f32 v186, 1.0, v186
  v_add_f32 v187, 1.0, v187
  v_mfma_f32_32x32x16_bf16 v[96:111], v[132:135], a[240:243], v[96:111]
  ds_read_b64_tr_b16 v[146:147], v202 offset:33280
  buffer_load_dwordx4 v206, s[8:11], s33 offen lds
  s_add_u32 m0, s29, 90112
  v_rcp_f32 v184, v184
  v_rcp_f32 v185, v185
  v_rcp_f32 v186, v186
  v_mfma_f32_32x32x16_bf16 v[112:127], v[132:135], a[244:247], v[112:127]
  ds_read_b64_tr_b16 v[148:149], v203 offset:32768
  s_add_u32 s33, s28, 3244160
  v_rcp_f32 v187, v187
  v_mul_f32 v40, v40, v184
  v_mul_f32 v41, v41, v185
  v_mul_f32 v42, v42, v186
  v_mfma_f32_32x32x16_bf16 v[80:95], v[128:131], a[244:247], v[80:95]
  ds_read_b64_tr_b16 v[150:151], v203 offset:33280
  buffer_load_dwordx4 v206, s[8:11], s33 offen lds
  v_mul_f32 v43, v43, v187
  v_cvt_pk_bf16_f32 v188, v40, v41
  v_cvt_pk_bf16_f32 v189, v42, v43
  v_mul_f32 v184, 0xbfb8aa3b, v36
  s_waitcnt lgkmcnt(4)
  v_mfma_f32_32x32x16_bf16 v[64:79], v[136:139], a[248:251], v[64:79]
  ds_read_b64_tr_b16 v[128:129], v202 offset:36864
  s_add_u32 m0, s29, 94208
  v_mul_f32 v185, 0xbfb8aa3b, v37
  v_mul_f32 v186, 0xbfb8aa3b, v38
  v_mul_f32 v187, 0xbfb8aa3b, v39
  v_exp_f32 v184, v184
  v_exp_f32 v185, v185
  v_mfma_f32_32x32x16_bf16 v[96:111], v[140:143], a[248:251], v[96:111]
  ds_read_b64_tr_b16 v[130:131], v202 offset:37376
  s_add_u32 s33, s28, 3391616
  v_exp_f32 v186, v186
  v_exp_f32 v187, v187
  v_mul_f32 v44, v36, v44
  v_mfma_f32_32x32x16_bf16 v[112:127], v[140:143], a[252:255], v[112:127]
  ds_read_b64_tr_b16 v[132:133], v203 offset:36864
  buffer_load_dwordx4 v206, s[8:11], s33 offen lds
  v_mul_f32 v45, v37, v45
  v_mul_f32 v46, v38, v46
  v_mul_f32 v47, v39, v47
  v_add_f32 v184, 1.0, v184
  v_add_f32 v185, 1.0, v185
  v_mfma_f32_32x32x16_bf16 v[80:95], v[136:139], a[252:255], v[80:95]
  ds_read_b64_tr_b16 v[134:135], v203 offset:37376
  v_add_f32 v186, 1.0, v186
  v_add_f32 v187, 1.0, v187
  v_rcp_f32 v184, v184
  s_waitcnt lgkmcnt(4)
  v_mfma_f32_32x32x16_bf16 v[64:79], v[144:147], v[152:155], v[64:79]
  ds_read_b64_tr_b16 v[136:137], v202 offset:40960
  v_rcp_f32 v185, v185
  v_rcp_f32 v186, v186
  v_rcp_f32 v187, v187
  v_mfma_f32_32x32x16_bf16 v[96:111], v[148:151], v[152:155], v[96:111]
  ds_read_b64_tr_b16 v[138:139], v202 offset:41472
  v_mul_f32 v44, v44, v184
  v_mul_f32 v45, v45, v185
  v_mul_f32 v46, v46, v186
  v_mul_f32 v47, v47, v187
  v_cvt_pk_bf16_f32 v190, v44, v45
  v_mfma_f32_32x32x16_bf16 v[112:127], v[148:151], v[156:159], v[112:127]
  ds_read_b64_tr_b16 v[140:141], v203 offset:40960
  v_cvt_pk_bf16_f32 v191, v46, v47
  s_add_u32 s34, s49, 512
  buffer_store_dwordx4 v[188:191], v208, s[20:23], s34 offen sc1
  v_mul_f32 v184, 0xbfb8aa3b, v48
  v_mul_f32 v185, 0xbfb8aa3b, v49
  v_mfma_f32_32x32x16_bf16 v[80:95], v[144:147], v[156:159], v[80:95]
  ds_read_b64_tr_b16 v[142:143], v203 offset:41472
  v_mul_f32 v186, 0xbfb8aa3b, v50
  v_mul_f32 v187, 0xbfb8aa3b, v51
  v_exp_f32 v184, v184
  v_exp_f32 v185, v185
  s_waitcnt vmcnt(15)
  s_barrier
  s_waitcnt lgkmcnt(4)
  v_mfma_f32_32x32x16_bf16 v[64:79], v[128:131], v[160:163], v[64:79]
  ds_read_b64_tr_b16 v[144:145], v202 offset:45056
  v_exp_f32 v186, v186
  v_exp_f32 v187, v187
  v_mul_f32 v56, v48, v56
  v_mul_f32 v57, v49, v57
  v_mfma_f32_32x32x16_bf16 v[96:111], v[132:135], v[160:163], v[96:111]
  ds_read_b64_tr_b16 v[146:147], v202 offset:45568
  v_mul_f32 v58, v50, v58
  v_mul_f32 v59, v51, v59
  v_add_f32 v184, 1.0, v184
  v_add_f32 v185, 1.0, v185
  v_add_f32 v186, 1.0, v186
  v_mfma_f32_32x32x16_bf16 v[112:127], v[132:135], v[164:167], v[112:127]
  ds_read_b64_tr_b16 v[148:149], v203 offset:45056
  v_add_f32 v187, 1.0, v187
  v_rcp_f32 v184, v184
  v_rcp_f32 v185, v185
  v_mfma_f32_32x32x16_bf16 v[80:95], v[128:131], v[164:167], v[80:95]
  ds_read_b64_tr_b16 v[150:151], v203 offset:45568
  v_rcp_f32 v186, v186
  v_rcp_f32 v187, v187
  v_mul_f32 v56, v56, v184
  s_waitcnt lgkmcnt(4)
  v_mfma_f32_32x32x16_bf16 v[64:79], v[136:139], v[168:171], v[64:79]
  ds_read_b64_tr_b16 v[128:129], v192 offset:0
  v_mul_f32 v57, v57, v185
  v_mul_f32 v58, v58, v186
  v_mul_f32 v59, v59, v187
  v_cvt_pk_bf16_f32 v188, v56, v57
  v_cvt_pk_bf16_f32 v189, v58, v59
  v_mul_f32 v184, 0xbfb8aa3b, v52
  v_mfma_f32_32x32x16_bf16 v[96:111], v[140:143], v[168:171], v[96:111]
  ds_read_b64_tr_b16 v[130:131], v192 offset:512
  v_mul_f32 v185, 0xbfb8aa3b, v53
  v_mul_f32 v186, 0xbfb8aa3b, v54
  v_mul_f32 v187, 0xbfb8aa3b, v55
  v_exp_f32 v184, v184
  v_mfma_f32_32x32x16_bf16 v[112:127], v[140:143], v[172:175], v[112:127]
  ds_read_b64_tr_b16 v[132:133], v193 offset:0
  v_exp_f32 v185, v185
  v_exp_f32 v186, v186
  v_exp_f32 v187, v187
  v_mfma_f32_32x32x16_bf16 v[80:95], v[136:139], v[172:175], v[80:95]
  ds_read_b64_tr_b16 v[134:135], v193 offset:512
  v_mul_f32 v60, v52, v60
  v_mul_f32 v61, v53, v61
  v_mul_f32 v62, v54, v62
  v_mul_f32 v63, v55, v63
  s_waitcnt lgkmcnt(4)
  v_mfma_f32_32x32x16_bf16 v[64:79], v[144:147], v[176:179], v[64:79]
  ds_read_b64_tr_b16 v[136:137], v192 offset:4096
  v_add_f32 v184, 1.0, v184
  v_add_f32 v185, 1.0, v185
  v_add_f32 v186, 1.0, v186
  v_add_f32 v187, 1.0, v187
  v_rcp_f32 v184, v184
  v_mfma_f32_32x32x16_bf16 v[96:111], v[148:151], v[176:179], v[96:111]
  ds_read_b64_tr_b16 v[138:139], v192 offset:4608
  v_rcp_f32 v185, v185
  v_rcp_f32 v186, v186
  v_rcp_f32 v187, v187
  v_mfma_f32_32x32x16_bf16 v[112:127], v[148:151], v[180:183], v[112:127]
  ds_read_b64_tr_b16 v[140:141], v193 offset:4096
  v_mul_f32 v60, v60, v184
  v_mul_f32 v61, v61, v185
  v_mul_f32 v62, v62, v186
  v_mul_f32 v63, v63, v187
  v_mfma_f32_32x32x16_bf16 v[80:95], v[144:147], v[180:183], v[80:95]
  ds_read_b64_tr_b16 v[142:143], v193 offset:4608
  v_cvt_pk_bf16_f32 v190, v60, v61
  v_cvt_pk_bf16_f32 v191, v62, v63
  s_add_u32 s34, s49, 295424
  buffer_store_dwordx4 v[188:191], v208, s[20:23], s34 offen sc1
  s_waitcnt lgkmcnt(4)
  v_mfma_f32_32x32x16_bf16 v[0:15], v[128:131], a[0:3], 0
  ds_read_b64_tr_b16 v[144:145], v192 offset:8192
  v_mfma_f32_32x32x16_bf16 v[32:47], v[132:135], a[0:3], 0
  ds_read_b64_tr_b16 v[146:147], v192 offset:8704
  v_mfma_f32_32x32x16_bf16 v[48:63], v[132:135], a[4:7], 0
  ds_read_b64_tr_b16 v[148:149], v193 offset:8192
  v_mfma_f32_32x32x16_bf16 v[16:31], v[128:131], a[4:7], 0
  ds_read_b64_tr_b16 v[150:151], v193 offset:8704
  s_barrier
  s_waitcnt lgkmcnt(4)
  v_mfma_f32_32x32x16_bf16 v[0:15], v[136:139], a[8:11], v[0:15]
  ds_read_b64_tr_b16 v[128:129], v192 offset:12288
  s_add_u32 m0, s29, 98304
  s_add_u32 s33, s28, 3539072
  v_mul_f32 v184, 0xbfb8aa3b, v64
  v_mul_f32 v185, 0xbfb8aa3b, v65
  v_mfma_f32_32x32x16_bf16 v[32:47], v[140:143], a[8:11], v[32:47]
  ds_read_b64_tr_b16 v[130:131], v192 offset:12800
  buffer_load_dwordx4 v206, s[8:11], s33 offen lds
  s_add_u32 m0, s29, 102400
  v_mul_f32 v186, 0xbfb8aa3b, v66
  v_mul_f32 v187, 0xbfb8aa3b, v67
  v_mfma_f32_32x32x16_bf16 v[48:63], v[140:143], a[12:15], v[48:63]
  ds_read_b64_tr_b16 v[132:133], v193 offset:12288
  s_add_u32 s33, s28, 3686528
  v_exp_f32 v184, v184
  v_mfma_f32_32x32x16_bf16 v[16:31], v[136:139], a[12:15], v[16:31]
  ds_read_b64_tr_b16 v[134:135], v193 offset:12800
  buffer_load_dwordx4 v206, s[8:11], s33 offen lds
  v_exp_f32 v185, v185
  s_waitcnt lgkmcnt(4)
  v_mfma_f32_32x32x16_bf16 v[0:15], v[144:147], a[16:19], v[0:15]
  ds_read_b64_tr_b16 v[136:137], v192 offset:16384
  s_add_u32 m0, s29, 106496
  v_exp_f32 v186, v186
  v_mfma_f32_32x32x16_bf16 v[32:47], v[148:151], a[16:19], v[32:47]
  ds_read_b64_tr_b16 v[138:139], v192 offset:16896
  s_add_u32 s33, s28, 3833984
  v_exp_f32 v187, v187
  v_mfma_f32_32x32x16_bf16 v[48:63], v[148:151], a[20:23], v[48:63]
  ds_read_b64_tr_b16 v[140:141], v193 offset:16384
  buffer_load_dwordx4 v206, s[8:11], s33 offen lds
  v_mul_f32 v72, v64, v72
  v_mul_f32 v73, v65, v73
  v_mfma_f32_32x32x16_bf16 v[16:31], v[144:147], a[20:23], v[16:31]
  ds_read_b64_tr_b16 v[142:143], v193 offset:16896
  v_mul_f32 v74, v66, v74
  v_mul_f32 v75, v67, v75
  s_waitcnt lgkmcnt(4)
  v_mfma_f32_32x32x16_bf16 v[0:15], v[128:131], a[24:27], v[0:15]
  ds_read_b64_tr_b16 v[144:145], v192 offset:20480
  s_add_u32 m0, s29, 110592
  s_add_u32 s33, s28, 3981440
  v_add_f32 v184, 1.0, v184
  v_add_f32 v185, 1.0, v185
  v_mfma_f32_32x32x16_bf16 v[32:47], v[132:135], a[24:27], v[32:47]
  ds_read_b64_tr_b16 v[146:147], v192 offset:20992
  buffer_load_dwordx4 v206, s[8:11], s33 offen lds
  s_add_u32 m0, s29, 114688
  v_add_f32 v186, 1.0, v186
  v_add_f32 v187, 1.0, v187
  v_mfma_f32_32x32x16_bf16 v[48:63], v[132:135], a[28:31], v[48:63]
  ds_read_b64_tr_b16 v[148:149], v193 offset:20480
  s_add_u32 s33, s28, 4128896
  v_rcp_f32 v184, v184
  v_mfma_f32_32x32x16_bf16 v[16:31], v[128:131], a[28:31], v[16:31]
  ds_read_b64_tr_b16 v[150:151], v193 offset:20992
  buffer_load_dwordx4 v206, s[8:11], s33 offen lds
  v_rcp_f32 v185, v185
  s_waitcnt lgkmcnt(4)
  v_mfma_f32_32x32x16_bf16 v[0:15], v[136:139], a[32:35], v[0:15]
  ds_read_b64_tr_b16 v[128:129], v192 offset:24576
  s_add_u32 m0, s29, 118784
  v_rcp_f32 v186, v186
  v_mfma_f32_32x32x16_bf16 v[32:47], v[140:143], a[32:35], v[32:47]
  ds_read_b64_tr_b16 v[130:131], v192 offset:25088
  s_add_u32 s33, s28, 4276352
  v_rcp_f32 v187, v187
  v_mfma_f32_32x32x16_bf16 v[48:63], v[140:143], a[36:39], v[48:63]
  ds_read_b64_tr_b16 v[132:133], v193 offset:24576
  buffer_load_dwordx4 v206, s[8:11], s33 offen lds
  v_mul_f32 v72, v72, v184
  v_mul_f32 v73, v73, v185
  v_mfma_f32_32x32x16_bf16 v[16:31], v[136:139], a[36:39], v[16:31]
  ds_read_b64_tr_b16 v[134:135], v193 offset:25088
  v_mul_f32 v74, v74, v186
  v_mul_f32 v75, v75, v187
  s_waitcnt lgkmcnt(4)
  v_mfma_f32_32x32x16_bf16 v[0:15], v[144:147], a[40:43], v[0:15]
  ds_read_b64_tr_b16 v[136:137], v192 offset:28672
  s_add_u32 m0, s29, 122880
  s_add_u32 s33, s28, 4423808
  v_cvt_pk_bf16_f32 v188, v72, v73
  v_cvt_pk_bf16_f32 v189, v74, v75
  v_mfma_f32_32x32x16_bf16 v[32:47], v[148:151], a[40:43], v[32:47]
  ds_read_b64_tr_b16 v[138:139], v192 offset:29184
  buffer_load_dwordx4 v206, s[8:11], s33 offen lds
  s_add_u32 m0, s29, 126976
  v_mul_f32 v184, 0xbfb8aa3b, v68
  v_mul_f32 v185, 0xbfb8aa3b, v69
  v_mfma_f32_32x32x16_bf16 v[48:63], v[148:151], a[44:47], v[48:63]
  ds_read_b64_tr_b16 v[140:141], v193 offset:28672
  s_add_u32 s33, s28, 4571264
  v_mul_f32 v186, 0xbfb8aa3b, v70
  v_mul_f32 v187, 0xbfb8aa3b, v71
  v_mfma_f32_32x32x16_bf16 v[16:31], v[144:147], a[44:47], v[16:31]
  ds_read_b64_tr_b16 v[142:143], v193 offset:29184
  buffer_load_dwordx4 v206, s[8:11], s33 offen lds
  v_exp_f32 v184, v184
  s_waitcnt lgkmcnt(4)
  v_mfma_f32_32x32x16_bf16 v[0:15], v[128:131], a[48:51], v[0:15]
  ds_read_b64_tr_b16 v[144:145], v192 offset:32768
  s_add_u32 m0, s29, 131072
  v_exp_f32 v185, v185
  v_mfma_f32_32x32x16_bf16 v[32:47], v[132:135], a[48:51], v[32:47]
  ds_read_b64_tr_b16 v[146:147], v192 offset:33280
  s_add_u32 s33, s28, 4718720
  v_exp_f32 v186, v186
  v_mfma_f32_32x32x16_bf16 v[48:63], v[132:135], a[52:55], v[48:63]
  ds_read_b64_tr_b16 v[148:149], v193 offset:32768
  buffer_load_dwordx4 v206, s[8:11], s33 offen lds
  v_exp_f32 v187, v187
  v_mfma_f32_32x32x16_bf16 v[16:31], v[128:131], a[52:55], v[16:31]
  ds_read_b64_tr_b16 v[150:151], v193 offset:33280
  v_mul_f32 v76, v68, v76
  v_mul_f32 v77, v69, v77
  s_waitcnt lgkmcnt(4)
  v_mfma_f32_32x32x16_bf16 v[0:15], v[136:139], a[56:59], v[0:15]
  ds_read_b64_tr_b16 v[128:129], v192 offset:36864
  s_add_u32 m0, s29, 135168
  s_add_u32 s33, s28, 4866176
  v_mul_f32 v78, v70, v78
  v_mul_f32 v79, v71, v79
  v_mfma_f32_32x32x16_bf16 v[32:47], v[140:143], a[56:59], v[32:47]
  ds_read_b64_tr_b16 v[130:131], v192 offset:37376
  buffer_load_dwordx4 v206, s[8:11], s33 offen lds
  s_add_u32 m0, s29, 139264
  v_add_f32 v184, 1.0, v184
  v_add_f32 v185, 1.0, v185
  v_mfma_f32_32x32x16_bf16 v[48:63], v[140:143], a[60:63], v[48:63]
  ds_read_b64_tr_b16 v[132:133], v193 offset:36864
  s_add_u32 s33, s28, 5013632
  v_add_f32 v186, 1.0, v186
  v_add_f32 v187, 1.0, v187
  v_mfma_f32_32x32x16_bf16 v[16:31], v[136:139], a[60:63], v[16:31]
  ds_read_b64_tr_b16 v[134:135], v193 offset:37376
  buffer_load_dwordx4 v206, s[8:11], s33 offen lds
  v_rcp_f32 v184, v184
  s_waitcnt lgkmcnt(4)
  v_mfma_f32_32x32x16_bf16 v[0:15], v[144:147], a[64:67], v[0:15]
  ds_read_b64_tr_b16 v[136:137], v192 offset:40960
  s_add_u32 m0, s29, 143360
  v_rcp_f32 v185, v185
  v_mfma_f32_32x32x16_bf16 v[32:47], v[148:151], a[64:67], v[32:47]
  ds_read_b64_tr_b16 v[138:139], v192 offset:41472
  s_add_u32 s33, s28, 5161088
  v_rcp_f32 v186, v186
  v_mfma_f32_32x32x16_bf16 v[48:63], v[148:151], a[68:71], v[48:63]
  ds_read_b64_tr_b16 v[140:141], v193 offset:40960
  buffer_load_dwordx4 v206, s[8:11], s33 offen lds
  v_rcp_f32 v187, v187
  v_mfma_f32_32x32x16_bf16 v[16:31], v[144:147], a[68:71], v[16:31]
  ds_read_b64_tr_b16 v[142:143], v193 offset:41472
  v_mul_f32 v76, v76, v184
  v_mul_f32 v77, v77, v185
  s_waitcnt vmcnt(14)
  s_barrier
  s_waitcnt lgkmcnt(4)
  v_mfma_f32_32x32x16_bf16 v[0:15], v[128:131], a[72:75], v[0:15]
  ds_read_b64_tr_b16 v[144:145], v192 offset:45056
  v_mul_f32 v78, v78, v186
  v_mul_f32 v79, v79, v187
  v_mfma_f32_32x32x16_bf16 v[32:47], v[132:135], a[72:75], v[32:47]
  ds_read_b64_tr_b16 v[146:147], v192 offset:45568
  v_cvt_pk_bf16_f32 v190, v76, v77
  v_cvt_pk_bf16_f32 v191, v78, v79
  v_mfma_f32_32x32x16_bf16 v[48:63], v[132:135], a[76:79], v[48:63]
  ds_read_b64_tr_b16 v[148:149], v193 offset:45056
  s_add_u32 s34, s49, 1024
  buffer_store_dwordx4 v[188:191], v208, s[20:23], s34 offen sc1
  v_mfma_f32_32x32x16_bf16 v[16:31], v[128:131], a[76:79], v[16:31]
  ds_read_b64_tr_b16 v[150:151], v193 offset:45568
  v_mul_f32 v184, 0xbfb8aa3b, v80
  v_mul_f32 v185, 0xbfb8aa3b, v81
  s_waitcnt lgkmcnt(4)
  v_mfma_f32_32x32x16_bf16 v[0:15], v[136:139], a[80:83], v[0:15]
  ds_read_b64_tr_b16 v[128:129], v196 offset:0
  v_mul_f32 v186, 0xbfb8aa3b, v82
  v_mul_f32 v187, 0xbfb8aa3b, v83
  v_mfma_f32_32x32x16_bf16 v[32:47], v[140:143], a[80:83], v[32:47]
  ds_read_b64_tr_b16 v[130:131], v196 offset:512
  v_exp_f32 v184, v184
  v_mfma_f32_32x32x16_bf16 v[48:63], v[140:143], a[84:87], v[48:63]
  ds_read_b64_tr_b16 v[132:133], v197 offset:0
  v_exp_f32 v185, v185
  v_mfma_f32_32x32x16_bf16 v[16:31], v[136:139], a[84:87], v[16:31]
  ds_read_b64_tr_b16 v[134:135], v197 offset:512
  v_exp_f32 v186, v186
  s_waitcnt lgkmcnt(4)
  v_mfma_f32_32x32x16_bf16 v[0:15], v[144:147], a[88:91], v[0:15]
  ds_read_b64_tr_b16 v[136:137], v196 offset:4096
  v_exp_f32 v187, v187
  v_mfma_f32_32x32x16_bf16 v[32:47], v[148:151], a[88:91], v[32:47]
  ds_read_b64_tr_b16 v[138:139], v196 offset:4608
  v_mul_f32 v88, v80, v88
  v_mul_f32 v89, v81, v89
  v_mfma_f32_32x32x16_bf16 v[48:63], v[148:151], a[92:95], v[48:63]
  ds_read_b64_tr_b16 v[140:141], v197 offset:4096
  v_mul_f32 v90, v82, v90
  v_mul_f32 v91, v83, v91
  v_mfma_f32_32x32x16_bf16 v[16:31], v[144:147], a[92:95], v[16:31]
  ds_read_b64_tr_b16 v[142:143], v197 offset:4608
  v_add_f32 v184, 1.0, v184
  v_add_f32 v185, 1.0, v185
  s_waitcnt lgkmcnt(4)
  v_mfma_f32_32x32x16_bf16 v[0:15], v[128:131], a[96:99], v[0:15]
  ds_read_b64_tr_b16 v[144:145], v196 offset:8192
  v_add_f32 v186, 1.0, v186
  v_add_f32 v187, 1.0, v187
  v_mfma_f32_32x32x16_bf16 v[32:47], v[132:135], a[96:99], v[32:47]
  ds_read_b64_tr_b16 v[146:147], v196 offset:8704
  v_rcp_f32 v184, v184
  v_mfma_f32_32x32x16_bf16 v[48:63], v[132:135], a[100:103], v[48:63]
  ds_read_b64_tr_b16 v[148:149], v197 offset:8192
  v_rcp_f32 v185, v185
  v_mfma_f32_32x32x16_bf16 v[16:31], v[128:131], a[100:103], v[16:31]
  ds_read_b64_tr_b16 v[150:151], v197 offset:8704
  v_rcp_f32 v186, v186
  s_waitcnt lgkmcnt(4)
  v_mfma_f32_32x32x16_bf16 v[0:15], v[136:139], a[104:107], v[0:15]
  ds_read_b64_tr_b16 v[128:129], v196 offset:12288
  v_rcp_f32 v187, v187
  v_mfma_f32_32x32x16_bf16 v[32:47], v[140:143], a[104:107], v[32:47]
  ds_read_b64_tr_b16 v[130:131], v196 offset:12800
  v_mul_f32 v88, v88, v184
  v_mul_f32 v89, v89, v185
  v_mfma_f32_32x32x16_bf16 v[48:63], v[140:143], a[108:111], v[48:63]
  ds_read_b64_tr_b16 v[132:133], v197 offset:12288
  v_mul_f32 v90, v90, v186
  v_mul_f32 v91, v91, v187
  v_mfma_f32_32x32x16_bf16 v[16:31], v[136:139], a[108:111], v[16:31]
  ds_read_b64_tr_b16 v[134:135], v197 offset:12800
  v_cvt_pk_bf16_f32 v188, v88, v89
  v_cvt_pk_bf16_f32 v189, v90, v91
  s_waitcnt lgkmcnt(4)
  v_mfma_f32_32x32x16_bf16 v[0:15], v[144:147], a[112:115], v[0:15]
  ds_read_b64_tr_b16 v[136:137], v196 offset:16384
  v_mul_f32 v184, 0xbfb8aa3b, v84
  v_mul_f32 v185, 0xbfb8aa3b, v85
  v_mfma_f32_32x32x16_bf16 v[32:47], v[148:151], a[112:115], v[32:47]
  ds_read_b64_tr_b16 v[138:139], v196 offset:16896
  v_mul_f32 v186, 0xbfb8aa3b, v86
  v_mul_f32 v187, 0xbfb8aa3b, v87
  v_mfma_f32_32x32x16_bf16 v[48:63], v[148:151], a[116:119], v[48:63]
  ds_read_b64_tr_b16 v[140:141], v197 offset:16384
  v_exp_f32 v184, v184
  v_mfma_f32_32x32x16_bf16 v[16:31], v[144:147], a[116:119], v[16:31]
  ds_read_b64_tr_b16 v[142:143], v197 offset:16896
  v_exp_f32 v185, v185
  s_waitcnt lgkmcnt(4)
  v_mfma_f32_32x32x16_bf16 v[0:15], v[128:131], a[120:123], v[0:15]
  ds_read_b64_tr_b16 v[144:145], v196 offset:20480
  v_exp_f32 v186, v186
  v_mfma_f32_32x32x16_bf16 v[32:47], v[132:135], a[120:123], v[32:47]
  ds_read_b64_tr_b16 v[146:147], v196 offset:20992
  v_exp_f32 v187, v187
  v_mfma_f32_32x32x16_bf16 v[48:63], v[132:135], a[124:127], v[48:63]
  ds_read_b64_tr_b16 v[148:149], v197 offset:20480
  v_mul_f32 v92, v84, v92
  v_mul_f32 v93, v85, v93
  v_mfma_f32_32x32x16_bf16 v[16:31], v[128:131], a[124:127], v[16:31]
  ds_read_b64_tr_b16 v[150:151], v197 offset:20992
  v_mul_f32 v94, v86, v94
  v_mul_f32 v95, v87, v95
  s_waitcnt lgkmcnt(4)
  v_mfma_f32_32x32x16_bf16 v[0:15], v[136:139], a[128:131], v[0:15]
  ds_read_b64_tr_b16 v[128:129], v196 offset:24576
  v_add_f32 v184, 1.0, v184
  v_add_f32 v185, 1.0, v185
  v_mfma_f32_32x32x16_bf16 v[32:47], v[140:143], a[128:131], v[32:47]
  ds_read_b64_tr_b16 v[130:131], v196 offset:25088
  v_add_f32 v186, 1.0, v186
  v_add_f32 v187, 1.0, v187
  v_mfma_f32_32x32x16_bf16 v[48:63], v[140:143], a[132:135], v[48:63]
  ds_read_b64_tr_b16 v[132:133], v197 offset:24576
  v_rcp_f32 v184, v184
  v_mfma_f32_32x32x16_bf16 v[16:31], v[136:139], a[132:135], v[16:31]
  ds_read_b64_tr_b16 v[134:135], v197 offset:25088
  v_rcp_f32 v185, v185
  s_waitcnt lgkmcnt(4)
  v_mfma_f32_32x32x16_bf16 v[0:15], v[144:147], a[136:139], v[0:15]
  ds_read_b64_tr_b16 v[136:137], v196 offset:28672
  v_rcp_f32 v186, v186
  v_mfma_f32_32x32x16_bf16 v[32:47], v[148:151], a[136:139], v[32:47]
  ds_read_b64_tr_b16 v[138:139], v196 offset:29184
  v_rcp_f32 v187, v187
  v_mfma_f32_32x32x16_bf16 v[48:63], v[148:151], a[140:143], v[48:63]
  ds_read_b64_tr_b16 v[140:141], v197 offset:28672
  v_mul_f32 v92, v92, v184
  v_mul_f32 v93, v93, v185
  v_mfma_f32_32x32x16_bf16 v[16:31], v[144:147], a[140:143], v[16:31]
  ds_read_b64_tr_b16 v[142:143], v197 offset:29184
  v_mul_f32 v94, v94, v186
  v_mul_f32 v95, v95, v187
  s_waitcnt lgkmcnt(4)
  v_mfma_f32_32x32x16_bf16 v[0:15], v[128:131], a[144:147], v[0:15]
  ds_read_b64_tr_b16 v[144:145], v196 offset:32768
  v_cvt_pk_bf16_f32 v190, v92, v93
  v_cvt_pk_bf16_f32 v191, v94, v95
  v_mfma_f32_32x32x16_bf16 v[32:47], v[132:135], a[144:147], v[32:47]
  ds_read_b64_tr_b16 v[146:147], v196 offset:33280
  s_add_u32 s34, s49, 295936
  buffer_store_dwordx4 v[188:191], v208, s[20:23], s34 offen sc1
  v_mfma_f32_32x32x16_bf16 v[48:63], v[132:135], a[148:151], v[48:63]
  ds_read_b64_tr_b16 v[148:149], v197 offset:32768
  v_mul_f32 v184, 0xbfb8aa3b, v96
  v_mul_f32 v185, 0xbfb8aa3b, v97
  v_mfma_f32_32x32x16_bf16 v[16:31], v[128:131], a[148:151], v[16:31]
  ds_read_b64_tr_b16 v[150:151], v197 offset:33280
  v_mul_f32 v186, 0xbfb8aa3b, v98
  v_mul_f32 v187, 0xbfb8aa3b, v99
  s_waitcnt lgkmcnt(4)
  v_mfma_f32_32x32x16_bf16 v[0:15], v[136:139], a[152:155], v[0:15]
  ds_read_b64_tr_b16 v[128:129], v196 offset:36864
  v_exp_f32 v184, v184
  v_mfma_f32_32x32x16_bf16 v[32:47], v[140:143], a[152:155], v[32:47]
  ds_read_b64_tr_b16 v[130:131], v196 offset:37376
  v_exp_f32 v185, v185
  v_mfma_f32_32x32x16_bf16 v[48:63], v[140:143], a[156:159], v[48:63]
  ds_read_b64_tr_b16 v[132:133], v197 offset:36864
  v_exp_f32 v186, v186
  v_mfma_f32_32x32x16_bf16 v[16:31], v[136:139], a[156:159], v[16:31]
  ds_read_b64_tr_b16 v[134:135], v197 offset:37376
  v_exp_f32 v187, v187
  s_waitcnt lgkmcnt(4)
  v_mfma_f32_32x32x16_bf16 v[0:15], v[144:147], a[160:163], v[0:15]
  ds_read_b64_tr_b16 v[136:137], v196 offset:40960
  v_mul_f32 v104, v96, v104
  v_mul_f32 v105, v97, v105
  v_mfma_f32_32x32x16_bf16 v[32:47], v[148:151], a[160:163], v[32:47]
  ds_read_b64_tr_b16 v[138:139], v196 offset:41472
  v_mul_f32 v106, v98, v106
  v_mul_f32 v107, v99, v107
  v_mfma_f32_32x32x16_bf16 v[48:63], v[148:151], a[164:167], v[48:63]
  ds_read_b64_tr_b16 v[140:141], v197 offset:40960
  v_add_f32 v184, 1.0, v184
  v_add_f32 v185, 1.0, v185
  v_mfma_f32_32x32x16_bf16 v[16:31], v[144:147], a[164:167], v[16:31]
  ds_read_b64_tr_b16 v[142:143], v197 offset:41472
  v_add_f32 v186, 1.0, v186
  v_add_f32 v187, 1.0, v187
  s_waitcnt vmcnt(2)
  s_barrier
  s_waitcnt lgkmcnt(4)
  v_mfma_f32_32x32x16_bf16 v[0:15], v[128:131], a[168:171], v[0:15]
  ds_read_b64_tr_b16 v[144:145], v196 offset:45056
  v_rcp_f32 v184, v184
  v_mfma_f32_32x32x16_bf16 v[32:47], v[132:135], a[168:171], v[32:47]
  ds_read_b64_tr_b16 v[146:147], v196 offset:45568
  v_rcp_f32 v185, v185
  v_mfma_f32_32x32x16_bf16 v[48:63], v[132:135], a[172:175], v[48:63]
  ds_read_b64_tr_b16 v[148:149], v197 offset:45056
  v_rcp_f32 v186, v186
  v_mfma_f32_32x32x16_bf16 v[16:31], v[128:131], a[172:175], v[16:31]
  ds_read_b64_tr_b16 v[150:151], v197 offset:45568
  v_rcp_f32 v187, v187
  s_waitcnt lgkmcnt(4)
  v_mfma_f32_32x32x16_bf16 v[0:15], v[136:139], a[176:179], v[0:15]
  ds_read_b64_tr_b16 v[128:129], v200 offset:0
  s_add_u32 m0, s31, 147456
  v_mul_f32 v104, v104, v184
  v_mul_f32 v105, v105, v185
  v_mfma_f32_32x32x16_bf16 v[32:47], v[140:143], a[176:179], v[32:47]
  ds_read_b64_tr_b16 v[130:131], v200 offset:512
  s_add_u32 s33, s30, 0
  v_mul_f32 v106, v106, v186
  v_mul_f32 v107, v107, v187
  v_mfma_f32_32x32x16_bf16 v[48:63], v[140:143], a[180:183], v[48:63]
  ds_read_b64_tr_b16 v[132:133], v201 offset:0
  buffer_load_dwordx4 v207, s[8:11], s33 offen lds
  v_cvt_pk_bf16_f32 v188, v104, v105
  v_cvt_pk_bf16_f32 v189, v106, v107
  v_mfma_f32_32x32x16_bf16 v[16:31], v[136:139], a[180:183], v[16:31]
  ds_read_b64_tr_b16 v[134:135], v201 offset:512
  v_mul_f32 v184, 0xbfb8aa3b, v100
  v_mul_f32 v185, 0xbfb8aa3b, v101
  s_waitcnt lgkmcnt(4)
  v_mfma_f32_32x32x16_bf16 v[0:15], v[144:147], a[184:187], v[0:15]
  ds_read_b64_tr_b16 v[136:137], v200 offset:4096
  v_mul_f32 v186, 0xbfb8aa3b, v102
  v_mul_f32 v187, 0xbfb8aa3b, v103
  v_mfma_f32_32x32x16_bf16 v[32:47], v[148:151], a[184:187], v[32:47]
  ds_read_b64_tr_b16 v[138:139], v200 offset:4608
  v_exp_f32 v184, v184
  v_mfma_f32_32x32x16_bf16 v[48:63], v[148:151], a[188:191], v[48:63]
  ds_read_b64_tr_b16 v[140:141], v201 offset:4096
  v_exp_f32 v185, v185
  v_mfma_f32_32x32x16_bf16 v[16:31], v[144:147], a[188:191], v[16:31]
  ds_read_b64_tr_b16 v[142:143], v201 offset:4608
  v_exp_f32 v186, v186
  s_waitcnt lgkmcnt(4)
  v_mfma_f32_32x32x16_bf16 v[0:15], v[128:131], a[192:195], v[0:15]
  ds_read_b64_tr_b16 v[144:145], v200 offset:8192
  v_exp_f32 v187, v187
  v_mfma_f32_32x32x16_bf16 v[32:47], v[132:135], a[192:195], v[32:47]
  ds_read_b64_tr_b16 v[146:147], v200 offset:8704
  v_mul_f32 v108, v100, v108
  v_mul_f32 v109, v101, v109
  v_mfma_f32_32x32x16_bf16 v[48:63], v[132:135], a[196:199], v[48:63]
  ds_read_b64_tr_b16 v[148:149], v201 offset:8192
  v_mul_f32 v110, v102, v110
  v_mul_f32 v111, v103, v111
  v_mfma_f32_32x32x16_bf16 v[16:31], v[128:131], a[196:199], v[16:31]
  ds_read_b64_tr_b16 v[150:151], v201 offset:8704
  v_add_f32 v184, 1.0, v184
  v_add_f32 v185, 1.0, v185
  s_waitcnt lgkmcnt(4)
  v_mfma_f32_32x32x16_bf16 v[0:15], v[136:139], a[200:203], v[0:15]
  ds_read_b64_tr_b16 v[128:129], v200 offset:12288
  v_add_f32 v186, 1.0, v186
  v_add_f32 v187, 1.0, v187
  v_mfma_f32_32x32x16_bf16 v[32:47], v[140:143], a[200:203], v[32:47]
  ds_read_b64_tr_b16 v[130:131], v200 offset:12800
  v_rcp_f32 v184, v184
  v_mfma_f32_32x32x16_bf16 v[48:63], v[140:143], a[204:207], v[48:63]
  ds_read_b64_tr_b16 v[132:133], v201 offset:12288
  v_rcp_f32 v185, v185
  v_mfma_f32_32x32x16_bf16 v[16:31], v[136:139], a[204:207], v[16:31]
  ds_read_b64_tr_b16 v[134:135], v201 offset:12800
  v_rcp_f32 v186, v186
  s_waitcnt lgkmcnt(4)
  v_mfma_f32_32x32x16_bf16 v[0:15], v[144:147], a[208:211], v[0:15]
  ds_read_b64_tr_b16 v[136:137], v200 offset:16384
  s_add_u32 m0, s31, 151552
  v_rcp_f32 v187, v187
  v_mfma_f32_32x32x16_bf16 v[32:47], v[148:151], a[208:211], v[32:47]
  ds_read_b64_tr_b16 v[138:139], v200 offset:16896
  s_add_u32 s33, s30, 589824
  v_mul_f32 v108, v108, v184
  v_mul_f32 v109, v109, v185
  v_mfma_f32_32x32x16_bf16 v[48:63], v[148:151], a[212:215], v[48:63]
  ds_read_b64_tr_b16 v[140:141], v201 offset:16384
  buffer_load_dwordx4 v207, s[8:11], s33 offen lds
  v_mul_f32 v110, v110, v186
  v_mul_f32 v111, v111, v187
  v_mfma_f32_32x32x16_bf16 v[16:31], v[144:147], a[212:215], v[16:31]
  ds_read_b64_tr_b16 v[142:143], v201 offset:16896
  v_cvt_pk_bf16_f32 v190, v108, v109
  v_cvt_pk_bf16_f32 v191, v110, v111
  s_waitcnt lgkmcnt(4)
  v_mfma_f32_32x32x16_bf16 v[0:15], v[128:131], a[216:219], v[0:15]
  ds_read_b64_tr_b16 v[144:145], v200 offset:20480
  s_add_u32 s34, s49, 1536
  buffer_store_dwordx4 v[188:191], v208, s[20:23], s34 offen sc1
  v_mfma_f32_32x32x16_bf16 v[32:47], v[132:135], a[216:219], v[32:47]
  ds_read_b64_tr_b16 v[146:147], v200 offset:20992
  v_mul_f32 v184, 0xbfb8aa3b, v112
  v_mul_f32 v185, 0xbfb8aa3b, v113
  v_mfma_f32_32x32x16_bf16 v[48:63], v[132:135], a[220:223], v[48:63]
  ds_read_b64_tr_b16 v[148:149], v201 offset:20480
  v_mul_f32 v186, 0xbfb8aa3b, v114
  v_mul_f32 v187, 0xbfb8aa3b, v115
  v_mfma_f32_32x32x16_bf16 v[16:31], v[128:131], a[220:223], v[16:31]
  ds_read_b64_tr_b16 v[150:151], v201 offset:20992
  v_exp_f32 v184, v184
  s_waitcnt lgkmcnt(4)
  v_mfma_f32_32x32x16_bf16 v[0:15], v[136:139], a[224:227], v[0:15]
  ds_read_b64_tr_b16 v[128:129], v200 offset:24576
  v_exp_f32 v185, v185
  v_mfma_f32_32x32x16_bf16 v[32:47], v[140:143], a[224:227], v[32:47]
  ds_read_b64_tr_b16 v[130:131], v200 offset:25088
  v_exp_f32 v186, v186
  v_mfma_f32_32x32x16_bf16 v[48:63], v[140:143], a[228:231], v[48:63]
  ds_read_b64_tr_b16 v[132:133], v201 offset:24576
  v_exp_f32 v187, v187
  v_mfma_f32_32x32x16_bf16 v[16:31], v[136:139], a[228:231], v[16:31]
  ds_read_b64_tr_b16 v[134:135], v201 offset:25088
  v_mul_f32 v120, v112, v120
  v_mul_f32 v121, v113, v121
  s_waitcnt lgkmcnt(4)
  v_mfma_f32_32x32x16_bf16 v[0:15], v[144:147], a[232:235], v[0:15]
  ds_read_b64_tr_b16 v[136:137], v200 offset:28672
  v_mul_f32 v122, v114, v122
  v_mul_f32 v123, v115, v123
  v_mfma_f32_32x32x16_bf16 v[32:47], v[148:151], a[232:235], v[32:47]
  ds_read_b64_tr_b16 v[138:139], v200 offset:29184
  v_add_f32 v184, 1.0, v184
  v_add_f32 v185, 1.0, v185
  v_mfma_f32_32x32x16_bf16 v[48:63], v[148:151], a[236:239], v[48:63]
  ds_read_b64_tr_b16 v[140:141], v201 offset:28672
  v_add_f32 v186, 1.0, v186
  v_add_f32 v187, 1.0, v187
  v_mfma_f32_32x32x16_bf16 v[16:31], v[144:147], a[236:239], v[16:31]
  ds_read_b64_tr_b16 v[142:143], v201 offset:29184
  v_rcp_f32 v184, v184
  s_waitcnt lgkmcnt(4)
  v_mfma_f32_32x32x16_bf16 v[0:15], v[128:131], a[240:243], v[0:15]
  ds_read_b64_tr_b16 v[144:145], v200 offset:32768
  s_add_u32 m0, s31, 155648
  v_rcp_f32 v185, v185
  v_mfma_f32_32x32x16_bf16 v[32:47], v[132:135], a[240:243], v[32:47]
  ds_read_b64_tr_b16 v[146:147], v200 offset:33280
  s_add_u32 s33, s30, 1179648
  v_rcp_f32 v186, v186
  v_mfma_f32_32x32x16_bf16 v[48:63], v[132:135], a[244:247], v[48:63]
  ds_read_b64_tr_b16 v[148:149], v201 offset:32768
  buffer_load_dwordx4 v207, s[8:11], s33 offen lds
  v_rcp_f32 v187, v187
  v_mfma_f32_32x32x16_bf16 v[16:31], v[128:131], a[244:247], v[16:31]
  ds_read_b64_tr_b16 v[150:151], v201 offset:33280
  v_mul_f32 v120, v120, v184
  v_mul_f32 v121, v121, v185
  s_waitcnt lgkmcnt(4)
  v_mfma_f32_32x32x16_bf16 v[0:15], v[136:139], a[248:251], v[0:15]
  ds_read_b64_tr_b16 v[128:129], v200 offset:36864
  v_mul_f32 v122, v122, v186
  v_mul_f32 v123, v123, v187
  v_mfma_f32_32x32x16_bf16 v[32:47], v[140:143], a[248:251], v[32:47]
  ds_read_b64_tr_b16 v[130:131], v200 offset:37376
  v_cvt_pk_bf16_f32 v188, v120, v121
  v_cvt_pk_bf16_f32 v189, v122, v123
  v_mfma_f32_32x32x16_bf16 v[48:63], v[140:143], a[252:255], v[48:63]
  ds_read_b64_tr_b16 v[132:133], v201 offset:36864
  v_mul_f32 v184, 0xbfb8aa3b, v116
  v_mul_f32 v185, 0xbfb8aa3b, v117
  v_mfma_f32_32x32x16_bf16 v[16:31], v[136:139], a[252:255], v[16:31]
  ds_read_b64_tr_b16 v[134:135], v201 offset:37376
  v_mul_f32 v186, 0xbfb8aa3b, v118
  v_mul_f32 v187, 0xbfb8aa3b, v119
  s_waitcnt lgkmcnt(4)
  v_mfma_f32_32x32x16_bf16 v[0:15], v[144:147], v[152:155], v[0:15]
  ds_read_b64_tr_b16 v[136:137], v200 offset:40960
  v_exp_f32 v184, v184
  v_mfma_f32_32x32x16_bf16 v[32:47], v[148:151], v[152:155], v[32:47]
  ds_read_b64_tr_b16 v[138:139], v200 offset:41472
  v_exp_f32 v185, v185
  v_mfma_f32_32x32x16_bf16 v[48:63], v[148:151], v[156:159], v[48:63]
  ds_read_b64_tr_b16 v[140:141], v201 offset:40960
  v_exp_f32 v186, v186
  v_mfma_f32_32x32x16_bf16 v[16:31], v[144:147], v[156:159], v[16:31]
  ds_read_b64_tr_b16 v[142:143], v201 offset:41472
  v_exp_f32 v187, v187
  s_waitcnt lgkmcnt(4)
  v_mfma_f32_32x32x16_bf16 v[0:15], v[128:131], v[160:163], v[0:15]
  ds_read_b64_tr_b16 v[144:145], v200 offset:45056
  v_mul_f32 v124, v116, v124
  v_mul_f32 v125, v117, v125
  v_mfma_f32_32x32x16_bf16 v[32:47], v[132:135], v[160:163], v[32:47]
  ds_read_b64_tr_b16 v[146:147], v200 offset:45568
  v_mul_f32 v126, v118, v126
  v_mul_f32 v127, v119, v127
  v_mfma_f32_32x32x16_bf16 v[48:63], v[132:135], v[164:167], v[48:63]
  ds_read_b64_tr_b16 v[148:149], v201 offset:45056
  v_add_f32 v184, 1.0, v184
  v_add_f32 v185, 1.0, v185
  v_mfma_f32_32x32x16_bf16 v[16:31], v[128:131], v[164:167], v[16:31]
  ds_read_b64_tr_b16 v[150:151], v201 offset:45568
  v_add_f32 v186, 1.0, v186
  v_add_f32 v187, 1.0, v187
  s_waitcnt lgkmcnt(4)
  v_mfma_f32_32x32x16_bf16 v[0:15], v[136:139], v[168:171], v[0:15]
  ds_read_b64_tr_b16 v[128:129], v194 offset:0
  s_add_u32 m0, s31, 159744
  v_rcp_f32 v184, v184
  v_mfma_f32_32x32x16_bf16 v[32:47], v[140:143], v[168:171], v[32:47]
  ds_read_b64_tr_b16 v[130:131], v194 offset:512
  s_add_u32 s33, s30, 1769472
  v_rcp_f32 v185, v185
  v_mfma_f32_32x32x16_bf16 v[48:63], v[140:143], v[172:175], v[48:63]
  ds_read_b64_tr_b16 v[132:133], v195 offset:0
  buffer_load_dwordx4 v207, s[8:11], s33 offen lds
  v_rcp_f32 v186, v186
  v_mfma_f32_32x32x16_bf16 v[16:31], v[136:139], v[172:175], v[16:31]
  ds_read_b64_tr_b16 v[134:135], v195 offset:512
  v_rcp_f32 v187, v187
  s_waitcnt lgkmcnt(4)
  v_mfma_f32_32x32x16_bf16 v[0:15], v[144:147], v[176:179], v[0:15]
  ds_read_b64_tr_b16 v[136:137], v194 offset:4096
  v_mul_f32 v124, v124, v184
  v_mul_f32 v125, v125, v185
  v_mfma_f32_32x32x16_bf16 v[32:47], v[148:151], v[176:179], v[32:47]
  ds_read_b64_tr_b16 v[138:139], v194 offset:4608
  v_mul_f32 v126, v126, v186
  v_mul_f32 v127, v127, v187
  v_mfma_f32_32x32x16_bf16 v[48:63], v[148:151], v[180:183], v[48:63]
  ds_read_b64_tr_b16 v[140:141], v195 offset:4096
  v_cvt_pk_bf16_f32 v190, v124, v125
  v_cvt_pk_bf16_f32 v191, v126, v127
  v_mfma_f32_32x32x16_bf16 v[16:31], v[144:147], v[180:183], v[16:31]
  ds_read_b64_tr_b16 v[142:143], v195 offset:4608
  s_add_u32 s34, s49, 296448
  buffer_store_dwordx4 v[188:191], v208, s[20:23], s34 offen sc1
  s_waitcnt lgkmcnt(4)
  v_mfma_f32_32x32x16_bf16 v[64:79], v[128:131], a[0:3], 0
  ds_read_b64_tr_b16 v[144:145], v194 offset:8192
  v_mfma_f32_32x32x16_bf16 v[96:111], v[132:135], a[0:3], 0
  ds_read_b64_tr_b16 v[146:147], v194 offset:8704
  v_mfma_f32_32x32x16_bf16 v[112:127], v[132:135], a[4:7], 0
  ds_read_b64_tr_b16 v[148:149], v195 offset:8192
  v_mfma_f32_32x32x16_bf16 v[80:95], v[128:131], a[4:7], 0
  ds_read_b64_tr_b16 v[150:151], v195 offset:8704
  s_waitcnt lgkmcnt(4)
  v_mfma_f32_32x32x16_bf16 v[64:79], v[136:139], a[8:11], v[64:79]
  ds_read_b64_tr_b16 v[128:129], v194 offset:12288
  v_mul_f32 v184, 0xbfb8aa3b, v0
  v_mul_f32 v185, 0xbfb8aa3b, v1
  v_mfma_f32_32x32x16_bf16 v[96:111], v[140:143], a[8:11], v[96:111]
  ds_read_b64_tr_b16 v[130:131], v194 offset:12800
  v_mul_f32 v186, 0xbfb8aa3b, v2
  v_mul_f32 v187, 0xbfb8aa3b, v3
  v_mfma_f32_32x32x16_bf16 v[112:127], v[140:143], a[12:15], v[112:127]
  ds_read_b64_tr_b16 v[132:133], v195 offset:12288
  v_exp_f32 v184, v184
  v_mfma_f32_32x32x16_bf16 v[80:95], v[136:139], a[12:15], v[80:95]
  ds_read_b64_tr_b16 v[134:135], v195 offset:12800
  v_exp_f32 v185, v185
  s_waitcnt lgkmcnt(4)
  v_mfma_f32_32x32x16_bf16 v[64:79], v[144:147], a[16:19], v[64:79]
  ds_read_b64_tr_b16 v[136:137], v194 offset:16384
  v_exp_f32 v186, v186
  v_mfma_f32_32x32x16_bf16 v[96:111], v[148:151], a[16:19], v[96:111]
  ds_read_b64_tr_b16 v[138:139], v194 offset:16896
  v_exp_f32 v187, v187
  v_mfma_f32_32x32x16_bf16 v[112:127], v[148:151], a[20:23], v[112:127]
  ds_read_b64_tr_b16 v[140:141], v195 offset:16384
  v_mul_f32 v8, v0, v8
  v_mul_f32 v9, v1, v9
  v_mfma_f32_32x32x16_bf16 v[80:95], v[144:147], a[20:23], v[80:95]
  ds_read_b64_tr_b16 v[142:143], v195 offset:16896
  v_mul_f32 v10, v2, v10
  v_mul_f32 v11, v3, v11
  s_waitcnt lgkmcnt(4)
  v_mfma_f32_32x32x16_bf16 v[64:79], v[128:131], a[24:27], v[64:79]
  ds_read_b64_tr_b16 v[144:145], v194 offset:20480
  buffer_load_dword v211, v210, s[24:27], s35 offen
  v_add_f32 v184, 1.0, v184
  v_add_f32 v185, 1.0, v185
  v_mfma_f32_32x32x16_bf16 v[96:111], v[132:135], a[24:27], v[96:111]
  ds_read_b64_tr_b16 v[146:147], v194 offset:20992
  v_add_f32 v186, 1.0, v186
  v_add_f32 v187, 1.0, v187
  v_mfma_f32_32x32x16_bf16 v[112:127], v[132:135], a[28:31], v[112:127]
  ds_read_b64_tr_b16 v[148:149], v195 offset:20480
  v_rcp_f32 v184, v184
  v_mfma_f32_32x32x16_bf16 v[80:95], v[128:131], a[28:31], v[80:95]
  ds_read_b64_tr_b16 v[150:151], v195 offset:20992
  v_rcp_f32 v185, v185
  s_waitcnt lgkmcnt(4)
  v_mfma_f32_32x32x16_bf16 v[64:79], v[136:139], a[32:35], v[64:79]
  ds_read_b64_tr_b16 v[128:129], v194 offset:24576
  buffer_load_dword v211, v210, s[24:27], s51 offen
  v_rcp_f32 v186, v186
  v_mfma_f32_32x32x16_bf16 v[96:111], v[140:143], a[32:35], v[96:111]
  ds_read_b64_tr_b16 v[130:131], v194 offset:25088
  v_rcp_f32 v187, v187
  v_mfma_f32_32x32x16_bf16 v[112:127], v[140:143], a[36:39], v[112:127]
  ds_read_b64_tr_b16 v[132:133], v195 offset:24576
  v_mul_f32 v8, v8, v184
  v_mul_f32 v9, v9, v185
  v_mfma_f32_32x32x16_bf16 v[80:95], v[136:139], a[36:39], v[80:95]
  ds_read_b64_tr_b16 v[134:135], v195 offset:25088
  v_mul_f32 v10, v10, v186
  v_mul_f32 v11, v11, v187
  s_waitcnt lgkmcnt(4)
  v_mfma_f32_32x32x16_bf16 v[64:79], v[144:147], a[40:43], v[64:79]
  ds_read_b64_tr_b16 v[136:137], v194 offset:28672
  v_cvt_pk_bf16_f32 v188, v8, v9
  v_cvt_pk_bf16_f32 v189, v10, v11
  v_mfma_f32_32x32x16_bf16 v[96:111], v[148:151], a[40:43], v[96:111]
  ds_read_b64_tr_b16 v[138:139], v194 offset:29184
  v_mul_f32 v184, 0xbfb8aa3b, v4
  v_mul_f32 v185, 0xbfb8aa3b, v5
  v_mfma_f32_32x32x16_bf16 v[112:127], v[148:151], a[44:47], v[112:127]
  ds_read_b64_tr_b16 v[140:141], v195 offset:28672
  v_mul_f32 v186, 0xbfb8aa3b, v6
  v_mul_f32 v187, 0xbfb8aa3b, v7
  v_mfma_f32_32x32x16_bf16 v[80:95], v[144:147], a[44:47], v[80:95]
  ds_read_b64_tr_b16 v[142:143], v195 offset:29184
  v_exp_f32 v184, v184
  s_waitcnt lgkmcnt(4)
  v_mfma_f32_32x32x16_bf16 v[64:79], v[128:131], a[48:51], v[64:79]
  ds_read_b64_tr_b16 v[144:145], v194 offset:32768
  v_exp_f32 v185, v185
  v_mfma_f32_32x32x16_bf16 v[96:111], v[132:135], a[48:51], v[96:111]
  ds_read_b64_tr_b16 v[146:147], v194 offset:33280
  v_exp_f32 v186, v186
  v_mfma_f32_32x32x16_bf16 v[112:127], v[132:135], a[52:55], v[112:127]
  ds_read_b64_tr_b16 v[148:149], v195 offset:32768
  v_exp_f32 v187, v187
  v_mfma_f32_32x32x16_bf16 v[80:95], v[128:131], a[52:55], v[80:95]
  ds_read_b64_tr_b16 v[150:151], v195 offset:33280
  v_mul_f32 v12, v4, v12
  v_mul_f32 v13, v5, v13
  s_waitcnt lgkmcnt(4)
  v_mfma_f32_32x32x16_bf16 v[64:79], v[136:139], a[56:59], v[64:79]
  ds_read_b64_tr_b16 v[128:129], v194 offset:36864
  v_mul_f32 v14, v6, v14
  v_mul_f32 v15, v7, v15
  v_mfma_f32_32x32x16_bf16 v[96:111], v[140:143], a[56:59], v[96:111]
  ds_read_b64_tr_b16 v[130:131], v194 offset:37376
  v_add_f32 v184, 1.0, v184
  v_add_f32 v185, 1.0, v185
  v_mfma_f32_32x32x16_bf16 v[112:127], v[140:143], a[60:63], v[112:127]
  ds_read_b64_tr_b16 v[132:133], v195 offset:36864
  v_add_f32 v186, 1.0, v186
  v_add_f32 v187, 1.0, v187
  v_mfma_f32_32x32x16_bf16 v[80:95], v[136:139], a[60:63], v[80:95]
  ds_read_b64_tr_b16 v[134:135], v195 offset:37376
  v_rcp_f32 v184, v184
  s_waitcnt lgkmcnt(4)
  v_mfma_f32_32x32x16_bf16 v[64:79], v[144:147], a[64:67], v[64:79]
  ds_read_b64_tr_b16 v[136:137], v194 offset:40960
  v_rcp_f32 v185, v185
  v_mfma_f32_32x32x16_bf16 v[96:111], v[148:151], a[64:67], v[96:111]
  ds_read_b64_tr_b16 v[138:139], v194 offset:41472
  v_rcp_f32 v186, v186
  v_mfma_f32_32x32x16_bf16 v[112:127], v[148:151], a[68:71], v[112:127]
  ds_read_b64_tr_b16 v[140:141], v195 offset:40960
  v_rcp_f32 v187, v187
  v_mfma_f32_32x32x16_bf16 v[80:95], v[144:147], a[68:71], v[80:95]
  ds_read_b64_tr_b16 v[142:143], v195 offset:41472
  v_mul_f32 v12, v12, v184
  v_mul_f32 v13, v13, v185
  s_waitcnt lgkmcnt(4)
  v_mfma_f32_32x32x16_bf16 v[64:79], v[128:131], a[72:75], v[64:79]
  ds_read_b64_tr_b16 v[144:145], v194 offset:45056
  v_mul_f32 v14, v14, v186
  v_mul_f32 v15, v15, v187
  v_mfma_f32_32x32x16_bf16 v[96:111], v[132:135], a[72:75], v[96:111]
  ds_read_b64_tr_b16 v[146:147], v194 offset:45568
  v_cvt_pk_bf16_f32 v190, v12, v13
  v_cvt_pk_bf16_f32 v191, v14, v15
  v_mfma_f32_32x32x16_bf16 v[112:127], v[132:135], a[76:79], v[112:127]
  ds_read_b64_tr_b16 v[148:149], v195 offset:45056
  s_add_u32 s34, s49, 2048
  buffer_store_dwordx4 v[188:191], v208, s[20:23], s34 offen sc1
  v_mfma_f32_32x32x16_bf16 v[80:95], v[128:131], a[76:79], v[80:95]
  ds_read_b64_tr_b16 v[150:151], v195 offset:45568
  v_mul_f32 v184, 0xbfb8aa3b, v16
  v_mul_f32 v185, 0xbfb8aa3b, v17
  s_waitcnt lgkmcnt(4)
  v_mfma_f32_32x32x16_bf16 v[64:79], v[136:139], a[80:83], v[64:79]
  ds_read_b64_tr_b16 v[128:129], v198 offset:0
  v_mul_f32 v186, 0xbfb8aa3b, v18
  v_mul_f32 v187, 0xbfb8aa3b, v19
  v_mfma_f32_32x32x16_bf16 v[96:111], v[140:143], a[80:83], v[96:111]
  ds_read_b64_tr_b16 v[130:131], v198 offset:512
  v_exp_f32 v184, v184
  v_mfma_f32_32x32x16_bf16 v[112:127], v[140:143], a[84:87], v[112:127]
  ds_read_b64_tr_b16 v[132:133], v199 offset:0
  v_exp_f32 v185, v185
  v_mfma_f32_32x32x16_bf16 v[80:95], v[136:139], a[84:87], v[80:95]
  ds_read_b64_tr_b16 v[134:135], v199 offset:512
  v_exp_f32 v186, v186
  s_waitcnt lgkmcnt(4)
  v_mfma_f32_32x32x16_bf16 v[64:79], v[144:147], a[88:91], v[64:79]
  ds_read_b64_tr_b16 v[136:137], v198 offset:4096
  v_exp_f32 v187, v187
  v_mfma_f32_32x32x16_bf16 v[96:111], v[148:151], a[88:91], v[96:111]
  ds_read_b64_tr_b16 v[138:139], v198 offset:4608
  v_mul_f32 v24, v16, v24
  v_mul_f32 v25, v17, v25
  v_mfma_f32_32x32x16_bf16 v[112:127], v[148:151], a[92:95], v[112:127]
  ds_read_b64_tr_b16 v[140:141], v199 offset:4096
  v_mul_f32 v26, v18, v26
  v_mul_f32 v27, v19, v27
  v_mfma_f32_32x32x16_bf16 v[80:95], v[144:147], a[92:95], v[80:95]
  ds_read_b64_tr_b16 v[142:143], v199 offset:4608
  v_add_f32 v184, 1.0, v184
  v_add_f32 v185, 1.0, v185
  s_waitcnt lgkmcnt(4)
  v_mfma_f32_32x32x16_bf16 v[64:79], v[128:131], a[96:99], v[64:79]
  ds_read_b64_tr_b16 v[144:145], v198 offset:8192
  v_add_f32 v186, 1.0, v186
  v_add_f32 v187, 1.0, v187
  v_mfma_f32_32x32x16_bf16 v[96:111], v[132:135], a[96:99], v[96:111]
  ds_read_b64_tr_b16 v[146:147], v198 offset:8704
  v_rcp_f32 v184, v184
  v_mfma_f32_32x32x16_bf16 v[112:127], v[132:135], a[100:103], v[112:127]
  ds_read_b64_tr_b16 v[148:149], v199 offset:8192
  v_rcp_f32 v185, v185
  v_mfma_f32_32x32x16_bf16 v[80:95], v[128:131], a[100:103], v[80:95]
  ds_read_b64_tr_b16 v[150:151], v199 offset:8704
  v_rcp_f32 v186, v186
  s_waitcnt vmcnt(4)
  s_barrier
  s_waitcnt lgkmcnt(4)
  v_mfma_f32_32x32x16_bf16 v[64:79], v[136:139], a[104:107], v[64:79]
  ds_read_b64_tr_b16 v[128:129], v198 offset:12288
  s_add_u32 m0, s31, 0
  v_rcp_f32 v187, v187
  v_mfma_f32_32x32x16_bf16 v[96:111], v[140:143], a[104:107], v[96:111]
  ds_read_b64_tr_b16 v[130:131], v198 offset:12800
  s_add_u32 s33, s30, 2359296
  v_mul_f32 v24, v24, v184
  v_mul_f32 v25, v25, v185
  v_mfma_f32_32x32x16_bf16 v[112:127], v[140:143], a[108:111], v[112:127]
  ds_read_b64_tr_b16 v[132:133], v199 offset:12288
  buffer_load_dwordx4 v207, s[8:11], s33 offen lds
  v_mul_f32 v26, v26, v186
  v_mul_f32 v27, v27, v187
  v_mfma_f32_32x32x16_bf16 v[80:95], v[136:139], a[108:111], v[80:95]
  ds_read_b64_tr_b16 v[134:135], v199 offset:12800
  v_cvt_pk_bf16_f32 v188, v24, v25
  v_cvt_pk_bf16_f32 v189, v26, v27
  s_waitcnt lgkmcnt(4)
  v_mfma_f32_32x32x16_bf16 v[64:79], v[144:147], a[112:115], v[64:79]
  ds_read_b64_tr_b16 v[136:137], v198 offset:16384
  v_mul_f32 v184, 0xbfb8aa3b, v20
  v_mul_f32 v185, 0xbfb8aa3b, v21
  v_mfma_f32_32x32x16_bf16 v[96:111], v[148:151], a[112:115], v[96:111]
  ds_read_b64_tr_b16 v[138:139], v198 offset:16896
  v_mul_f32 v186, 0xbfb8aa3b, v22
  v_mul_f32 v187, 0xbfb8aa3b, v23
  v_mfma_f32_32x32x16_bf16 v[112:127], v[148:151], a[116:119], v[112:127]
  ds_read_b64_tr_b16 v[140:141], v199 offset:16384
  v_exp_f32 v184, v184
  v_mfma_f32_32x32x16_bf16 v[80:95], v[144:147], a[116:119], v[80:95]
  ds_read_b64_tr_b16 v[142:143], v199 offset:16896
  v_exp_f32 v185, v185
  s_waitcnt lgkmcnt(4)
  v_mfma_f32_32x32x16_bf16 v[64:79], v[128:131], a[120:123], v[64:79]
  ds_read_b64_tr_b16 v[144:145], v198 offset:20480
  v_exp_f32 v186, v186
  v_mfma_f32_32x32x16_bf16 v[96:111], v[132:135], a[120:123], v[96:111]
  ds_read_b64_tr_b16 v[146:147], v198 offset:20992
  v_exp_f32 v187, v187
  v_mfma_f32_32x32x16_bf16 v[112:127], v[132:135], a[124:127], v[112:127]
  ds_read_b64_tr_b16 v[148:149], v199 offset:20480
  v_mul_f32 v28, v20, v28
  v_mul_f32 v29, v21, v29
  v_mfma_f32_32x32x16_bf16 v[80:95], v[128:131], a[124:127], v[80:95]
  ds_read_b64_tr_b16 v[150:151], v199 offset:20992
  v_mul_f32 v30, v22, v30
  v_mul_f32 v31, v23, v31
  s_waitcnt lgkmcnt(4)
  v_mfma_f32_32x32x16_bf16 v[64:79], v[136:139], a[128:131], v[64:79]
  ds_read_b64_tr_b16 v[128:129], v198 offset:24576
  v_add_f32 v184, 1.0, v184
  v_add_f32 v185, 1.0, v185
  v_mfma_f32_32x32x16_bf16 v[96:111], v[140:143], a[128:131], v[96:111]
  ds_read_b64_tr_b16 v[130:131], v198 offset:25088
  v_add_f32 v186, 1.0, v186
  v_add_f32 v187, 1.0, v187
  v_mfma_f32_32x32x16_bf16 v[112:127], v[140:143], a[132:135], v[112:127]
  ds_read_b64_tr_b16 v[132:133], v199 offset:24576
  v_rcp_f32 v184, v184
  v_mfma_f32_32x32x16_bf16 v[80:95], v[136:139], a[132:135], v[80:95]
  ds_read_b64_tr_b16 v[134:135], v199 offset:25088
  v_rcp_f32 v185, v185
  s_waitcnt lgkmcnt(4)
  v_mfma_f32_32x32x16_bf16 v[64:79], v[144:147], a[136:139], v[64:79]
  ds_read_b64_tr_b16 v[136:137], v198 offset:28672
  s_add_u32 m0, s31, 4096
  v_rcp_f32 v186, v186
  v_mfma_f32_32x32x16_bf16 v[96:111], v[148:151], a[136:139], v[96:111]
  ds_read_b64_tr_b16 v[138:139], v198 offset:29184
  s_add_u32 s33, s30, 2949120
  v_rcp_f32 v187, v187
  v_mfma_f32_32x32x16_bf16 v[112:127], v[148:151], a[140:143], v[112:127]
  ds_read_b64_tr_b16 v[140:141], v199 offset:28672
  buffer_load_dwordx4 v207, s[8:11], s33 offen lds
  v_mul_f32 v28, v28, v184
  v_mul_f32 v29, v29, v185
  v_mfma_f32_32x32x16_bf16 v[80:95], v[144:147], a[140:143], v[80:95]
  ds_read_b64_tr_b16 v[142:143], v199 offset:29184
  v_mul_f32 v30, v30, v186
  v_mul_f32 v31, v31, v187
  s_waitcnt lgkmcnt(4)
  v_mfma_f32_32x32x16_bf16 v[64:79], v[128:131], a[144:147], v[64:79]
  ds_read_b64_tr_b16 v[144:145], v198 offset:32768
  v_cvt_pk_bf16_f32 v190, v28, v29
  v_cvt_pk_bf16_f32 v191, v30, v31
  v_mfma_f32_32x32x16_bf16 v[96:111], v[132:135], a[144:147], v[96:111]
  ds_read_b64_tr_b16 v[146:147], v198 offset:33280
  s_add_u32 s34, s49, 296960
  buffer_store_dwordx4 v[188:191], v208, s[20:23], s34 offen sc1
  v_mfma_f32_32x32x16_bf16 v[112:127], v[132:135], a[148:151], v[112:127]
  ds_read_b64_tr_b16 v[148:149], v199 offset:32768
  v_mul_f32 v184, 0xbfb8aa3b, v32
  v_mul_f32 v185, 0xbfb8aa3b, v33
  v_mfma_f32_32x32x16_bf16 v[80:95], v[128:131], a[148:151], v[80:95]
  ds_read_b64_tr_b16 v[150:151], v199 offset:33280
  v_mul_f32 v186, 0xbfb8aa3b, v34
  v_mul_f32 v187, 0xbfb8aa3b, v35
  s_waitcnt lgkmcnt(4)
  v_mfma_f32_32x32x16_bf16 v[64:79], v[136:139], a[152:155], v[64:79]
  ds_read_b64_tr_b16 v[128:129], v198 offset:36864
  v_exp_f32 v184, v184
  v_mfma_f32_32x32x16_bf16 v[96:111], v[140:143], a[152:155], v[96:111]
  ds_read_b64_tr_b16 v[130:131], v198 offset:37376
  v_exp_f32 v185, v185
  v_mfma_f32_32x32x16_bf16 v[112:127], v[140:143], a[156:159], v[112:127]
  ds_read_b64_tr_b16 v[132:133], v199 offset:36864
  v_exp_f32 v186, v186
  v_mfma_f32_32x32x16_bf16 v[80:95], v[136:139], a[156:159], v[80:95]
  ds_read_b64_tr_b16 v[134:135], v199 offset:37376
  v_exp_f32 v187, v187
  s_waitcnt lgkmcnt(4)
  v_mfma_f32_32x32x16_bf16 v[64:79], v[144:147], a[160:163], v[64:79]
  ds_read_b64_tr_b16 v[136:137], v198 offset:40960
  v_mul_f32 v40, v32, v40
  v_mul_f32 v41, v33, v41
  v_mfma_f32_32x32x16_bf16 v[96:111], v[148:151], a[160:163], v[96:111]
  ds_read_b64_tr_b16 v[138:139], v198 offset:41472
  v_mul_f32 v42, v34, v42
  v_mul_f32 v43, v35, v43
  v_mfma_f32_32x32x16_bf16 v[112:127], v[148:151], a[164:167], v[112:127]
  ds_read_b64_tr_b16 v[140:141], v199 offset:40960
  v_add_f32 v184, 1.0, v184
  v_add_f32 v185, 1.0, v185
  v_mfma_f32_32x32x16_bf16 v[80:95], v[144:147], a[164:167], v[80:95]
  ds_read_b64_tr_b16 v[142:143], v199 offset:41472
  v_add_f32 v186, 1.0, v186
  v_add_f32 v187, 1.0, v187
  s_waitcnt lgkmcnt(4)
  v_mfma_f32_32x32x16_bf16 v[64:79], v[128:131], a[168:171], v[64:79]
  ds_read_b64_tr_b16 v[144:145], v198 offset:45056
  s_add_u32 m0, s31, 8192
  v_rcp_f32 v184, v184
  v_mfma_f32_32x32x16_bf16 v[96:111], v[132:135], a[168:171], v[96:111]
  ds_read_b64_tr_b16 v[146:147], v198 offset:45568
  s_add_u32 s33, s30, 3538944
  v_rcp_f32 v185, v185
  v_mfma_f32_32x32x16_bf16 v[112:127], v[132:135], a[172:175], v[112:127]
  ds_read_b64_tr_b16 v[148:149], v199 offset:45056
  buffer_load_dwordx4 v207, s[8:11], s33 offen lds
  v_rcp_f32 v186, v186
  v_mfma_f32_32x32x16_bf16 v[80:95], v[128:131], a[172:175], v[80:95]
  ds_read_b64_tr_b16 v[150:151], v199 offset:45568
  v_rcp_f32 v187, v187
  s_waitcnt lgkmcnt(4)
  v_mfma_f32_32x32x16_bf16 v[64:79], v[136:139], a[176:179], v[64:79]
  ds_read_b64_tr_b16 v[128:129], v202 offset:0
  v_mul_f32 v40, v40, v184
  v_mul_f32 v41, v41, v185
  v_mfma_f32_32x32x16_bf16 v[96:111], v[140:143], a[176:179], v[96:111]
  ds_read_b64_tr_b16 v[130:131], v202 offset:512
  v_mul_f32 v42, v42, v186
  v_mul_f32 v43, v43, v187
  v_mfma_f32_32x32x16_bf16 v[112:127], v[140:143], a[180:183], v[112:127]
  ds_read_b64_tr_b16 v[132:133], v203 offset:0
  v_cvt_pk_bf16_f32 v188, v40, v41
  v_cvt_pk_bf16_f32 v189, v42, v43
  v_mfma_f32_32x32x16_bf16 v[80:95], v[136:139], a[180:183], v[80:95]
  ds_read_b64_tr_b16 v[134:135], v203 offset:512
  v_mul_f32 v184, 0xbfb8aa3b, v36
  v_mul_f32 v185, 0xbfb8aa3b, v37
  s_waitcnt lgkmcnt(4)
  v_mfma_f32_32x32x16_bf16 v[64:79], v[144:147], a[184:187], v[64:79]
  ds_read_b64_tr_b16 v[136:137], v202 offset:4096
  v_mul_f32 v186, 0xbfb8aa3b, v38
  v_mul_f32 v187, 0xbfb8aa3b, v39
  v_mfma_f32_32x32x16_bf16 v[96:111], v[148:151], a[184:187], v[96:111]
  ds_read_b64_tr_b16 v[138:139], v202 offset:4608
  v_exp_f32 v184, v184
  v_mfma_f32_32x32x16_bf16 v[112:127], v[148:151], a[188:191], v[112:127]
  ds_read_b64_tr_b16 v[140:141], v203 offset:4096
  v_exp_f32 v185, v185
  v_mfma_f32_32x32x16_bf16 v[80:95], v[144:147], a[188:191], v[80:95]
  ds_read_b64_tr_b16 v[142:143], v203 offset:4608
  v_exp_f32 v186, v186
  s_waitcnt lgkmcnt(4)
  v_mfma_f32_32x32x16_bf16 v[64:79], v[128:131], a[192:195], v[64:79]
  ds_read_b64_tr_b16 v[144:145], v202 offset:8192
  v_exp_f32 v187, v187
  v_mfma_f32_32x32x16_bf16 v[96:111], v[132:135], a[192:195], v[96:111]
  ds_read_b64_tr_b16 v[146:147], v202 offset:8704
  v_mul_f32 v44, v36, v44
  v_mul_f32 v45, v37, v45
  v_mfma_f32_32x32x16_bf16 v[112:127], v[132:135], a[196:199], v[112:127]
  ds_read_b64_tr_b16 v[148:149], v203 offset:8192
  v_mul_f32 v46, v38, v46
  v_mul_f32 v47, v39, v47
  v_mfma_f32_32x32x16_bf16 v[80:95], v[128:131], a[196:199], v[80:95]
  ds_read_b64_tr_b16 v[150:151], v203 offset:8704
  v_add_f32 v184, 1.0, v184
  v_add_f32 v185, 1.0, v185
  s_waitcnt lgkmcnt(4)
  v_mfma_f32_32x32x16_bf16 v[64:79], v[136:139], a[200:203], v[64:79]
  ds_read_b64_tr_b16 v[128:129], v202 offset:12288
  s_add_u32 m0, s31, 12288
  v_add_f32 v186, 1.0, v186
  v_add_f32 v187, 1.0, v187
  v_mfma_f32_32x32x16_bf16 v[96:111], v[140:143], a[200:203], v[96:111]
  ds_read_b64_tr_b16 v[130:131], v202 offset:12800
  s_add_u32 s33, s30, 4128768
  v_rcp_f32 v184, v184
  v_mfma_f32_32x32x16_bf16 v[112:127], v[140:143], a[204:207], v[112:127]
  ds_read_b64_tr_b16 v[132:133], v203 offset:12288
  buffer_load_dwordx4 v207, s[8:11], s33 offen lds
  v_rcp_f32 v185, v185
  v_mfma_f32_32x32x16_bf16 v[80:95], v[136:139], a[204:207], v[80:95]
  ds_read_b64_tr_b16 v[134:135], v203 offset:12800
  v_rcp_f32 v186, v186
  s_waitcnt lgkmcnt(4)
  v_mfma_f32_32x32x16_bf16 v[64:79], v[144:147], a[208:211], v[64:79]
  ds_read_b64_tr_b16 v[136:137], v202 offset:16384
  v_rcp_f32 v187, v187
  v_mfma_f32_32x32x16_bf16 v[96:111], v[148:151], a[208:211], v[96:111]
  ds_read_b64_tr_b16 v[138:139], v202 offset:16896
  v_mul_f32 v44, v44, v184
  v_mul_f32 v45, v45, v185
  v_mfma_f32_32x32x16_bf16 v[112:127], v[148:151], a[212:215], v[112:127]
  ds_read_b64_tr_b16 v[140:141], v203 offset:16384
  v_mul_f32 v46, v46, v186
  v_mul_f32 v47, v47, v187
  v_mfma_f32_32x32x16_bf16 v[80:95], v[144:147], a[212:215], v[80:95]
  ds_read_b64_tr_b16 v[142:143], v203 offset:16896
  v_cvt_pk_bf16_f32 v190, v44, v45
  v_cvt_pk_bf16_f32 v191, v46, v47
  s_waitcnt lgkmcnt(4)
  v_mfma_f32_32x32x16_bf16 v[64:79], v[128:131], a[216:219], v[64:79]
  ds_read_b64_tr_b16 v[144:145], v202 offset:20480
  s_add_u32 s34, s49, 2560
  buffer_store_dwordx4 v[188:191], v208, s[20:23], s34 offen sc1
  v_mfma_f32_32x32x16_bf16 v[96:111], v[132:135], a[216:219], v[96:111]
  ds_read_b64_tr_b16 v[146:147], v202 offset:20992
  v_mul_f32 v184, 0xbfb8aa3b, v48
  v_mul_f32 v185, 0xbfb8aa3b, v49
  v_mfma_f32_32x32x16_bf16 v[112:127], v[132:135], a[220:223], v[112:127]
  ds_read_b64_tr_b16 v[148:149], v203 offset:20480
  v_mul_f32 v186, 0xbfb8aa3b, v50
  v_mul_f32 v187, 0xbfb8aa3b, v51
  v_mfma_f32_32x32x16_bf16 v[80:95], v[128:131], a[220:223], v[80:95]
  ds_read_b64_tr_b16 v[150:151], v203 offset:20992
  v_exp_f32 v184, v184
  s_waitcnt lgkmcnt(4)
  v_mfma_f32_32x32x16_bf16 v[64:79], v[136:139], a[224:227], v[64:79]
  ds_read_b64_tr_b16 v[128:129], v202 offset:24576
  v_exp_f32 v185, v185
  v_mfma_f32_32x32x16_bf16 v[96:111], v[140:143], a[224:227], v[96:111]
  ds_read_b64_tr_b16 v[130:131], v202 offset:25088
  v_exp_f32 v186, v186
  v_mfma_f32_32x32x16_bf16 v[112:127], v[140:143], a[228:231], v[112:127]
  ds_read_b64_tr_b16 v[132:133], v203 offset:24576
  v_exp_f32 v187, v187
  v_mfma_f32_32x32x16_bf16 v[80:95], v[136:139], a[228:231], v[80:95]
  ds_read_b64_tr_b16 v[134:135], v203 offset:25088
  v_mul_f32 v56, v48, v56
  v_mul_f32 v57, v49, v57
  s_waitcnt lgkmcnt(4)
  v_mfma_f32_32x32x16_bf16 v[64:79], v[144:147], a[232:235], v[64:79]
  ds_read_b64_tr_b16 v[136:137], v202 offset:28672
  s_add_u32 m0, s31, 16384
  v_mul_f32 v58, v50, v58
  v_mul_f32 v59, v51, v59
  v_mfma_f32_32x32x16_bf16 v[96:111], v[148:151], a[232:235], v[96:111]
  ds_read_b64_tr_b16 v[138:139], v202 offset:29184
  s_add_u32 s33, s30, 4718592
  v_add_f32 v184, 1.0, v184
  v_add_f32 v185, 1.0, v185
  v_mfma_f32_32x32x16_bf16 v[112:127], v[148:151], a[236:239], v[112:127]
  ds_read_b64_tr_b16 v[140:141], v203 offset:28672
  buffer_load_dwordx4 v207, s[8:11], s33 offen lds
  v_add_f32 v186, 1.0, v186
  v_add_f32 v187, 1.0, v187
  v_mfma_f32_32x32x16_bf16 v[80:95], v[144:147], a[236:239], v[80:95]
  ds_read_b64_tr_b16 v[142:143], v203 offset:29184
  v_rcp_f32 v184, v184
  s_waitcnt lgkmcnt(4)
  v_mfma_f32_32x32x16_bf16 v[64:79], v[128:131], a[240:243], v[64:79]
  ds_read_b64_tr_b16 v[144:145], v202 offset:32768
  s_bfe_u32 s68, s2, 0x20001
  s_mul_i32 s68, s68, 1327104
  s_lshl_b32 s69, s41, 8
  s_add_u32 s68, s68, s69
  s_mul_i32 s69, s38, 36864
  v_rcp_f32 v185, v185
  v_mfma_f32_32x32x16_bf16 v[96:111], v[132:135], a[240:243], v[96:111]
  ds_read_b64_tr_b16 v[146:147], v202 offset:33280
  s_add_u32 s60, s68, s69
  s_add_u32 s68, s38, 6
  s_and_b32 s68, s68, 15
  s_mul_i32 s61, s68, 9216
  s_add_u32 s68, s38, 10
  v_rcp_f32 v186, v186
  v_mfma_f32_32x32x16_bf16 v[112:127], v[132:135], a[244:247], v[112:127]
  ds_read_b64_tr_b16 v[148:149], v203 offset:32768
  s_and_b32 s68, s68, 15
  s_mul_i32 s62, s68, 9216
  s_add_u32 s68, s38, 14
  s_and_b32 s68, s68, 15
  v_rcp_f32 v187, v187
  v_mfma_f32_32x32x16_bf16 v[80:95], v[128:131], a[244:247], v[80:95]
  ds_read_b64_tr_b16 v[150:151], v203 offset:33280
  s_mul_i32 s63, s68, 9216
  s_add_u32 s68, s38, 18
  s_and_b32 s68, s68, 15
  s_mul_i32 s64, s68, 9216
  v_mul_f32 v56, v56, v184
  v_mul_f32 v57, v57, v185
  s_waitcnt lgkmcnt(4)
  v_mfma_f32_32x32x16_bf16 v[64:79], v[136:139], a[248:251], v[64:79]
  ds_read_b64_tr_b16 v[128:129], v202 offset:36864
  v_mul_f32 v58, v58, v186
  v_mul_f32 v59, v59, v187
  v_mfma_f32_32x32x16_bf16 v[96:111], v[140:143], a[248:251], v[96:111]
  ds_read_b64_tr_b16 v[130:131], v202 offset:37376
  v_cvt_pk_bf16_f32 v188, v56, v57
  v_cvt_pk_bf16_f32 v189, v58, v59
  v_mfma_f32_32x32x16_bf16 v[112:127], v[140:143], a[252:255], v[112:127]
  ds_read_b64_tr_b16 v[132:133], v203 offset:36864
  v_mul_f32 v184, 0xbfb8aa3b, v52
  v_mul_f32 v185, 0xbfb8aa3b, v53
  v_mfma_f32_32x32x16_bf16 v[80:95], v[136:139], a[252:255], v[80:95]
  ds_read_b64_tr_b16 v[134:135], v203 offset:37376
  v_mul_f32 v186, 0xbfb8aa3b, v54
  v_mul_f32 v187, 0xbfb8aa3b, v55
  s_waitcnt lgkmcnt(4)
  v_mfma_f32_32x32x16_bf16 v[64:79], v[144:147], v[152:155], v[64:79]
  ds_read_b64_tr_b16 v[136:137], v202 offset:40960
  v_exp_f32 v184, v184
  v_mfma_f32_32x32x16_bf16 v[96:111], v[148:151], v[152:155], v[96:111]
  ds_read_b64_tr_b16 v[138:139], v202 offset:41472
  v_exp_f32 v185, v185
  v_mfma_f32_32x32x16_bf16 v[112:127], v[148:151], v[156:159], v[112:127]
  ds_read_b64_tr_b16 v[140:141], v203 offset:40960
  v_exp_f32 v186, v186
  v_mfma_f32_32x32x16_bf16 v[80:95], v[144:147], v[156:159], v[80:95]
  ds_read_b64_tr_b16 v[142:143], v203 offset:41472
  v_exp_f32 v187, v187
  s_waitcnt lgkmcnt(4)
  v_mfma_f32_32x32x16_bf16 v[64:79], v[128:131], v[160:163], v[64:79]
  ds_read_b64_tr_b16 v[144:145], v202 offset:45056
  v_mul_f32 v60, v52, v60
  v_mul_f32 v61, v53, v61
  v_mfma_f32_32x32x16_bf16 v[96:111], v[132:135], v[160:163], v[96:111]
  ds_read_b64_tr_b16 v[146:147], v202 offset:45568
  v_mul_f32 v62, v54, v62
  v_mul_f32 v63, v55, v63
  v_mfma_f32_32x32x16_bf16 v[112:127], v[132:135], v[164:167], v[112:127]
  ds_read_b64_tr_b16 v[148:149], v203 offset:45056
  v_add_f32 v184, 1.0, v184
  v_add_f32 v185, 1.0, v185
  v_mfma_f32_32x32x16_bf16 v[80:95], v[128:131], v[164:167], v[80:95]
  ds_read_b64_tr_b16 v[150:151], v203 offset:45568
  v_add_f32 v186, 1.0, v186
  v_add_f32 v187, 1.0, v187
  s_waitcnt lgkmcnt(4)
  v_mfma_f32_32x32x16_bf16 v[64:79], v[136:139], v[168:171], v[64:79]
  ds_read_b64_tr_b16 v[128:129], v212 offset:0
  v_rcp_f32 v184, v184
  v_mfma_f32_32x32x16_bf16 v[96:111], v[140:143], v[168:171], v[96:111]
  ds_read_b64_tr_b16 v[130:131], v213 offset:0
  v_rcp_f32 v185, v185
  v_mfma_f32_32x32x16_bf16 v[112:127], v[140:143], v[172:175], v[112:127]
  v_rcp_f32 v186, v186
  v_mfma_f32_32x32x16_bf16 v[80:95], v[136:139], v[172:175], v[80:95]
  v_rcp_f32 v187, v187
  s_waitcnt lgkmcnt(2)
  v_mfma_f32_32x32x16_bf16 v[64:79], v[144:147], v[176:179], v[64:79]
  ds_read_b64_tr_b16 v[136:137], v212 offset:512
  v_mul_f32 v60, v60, v184
  v_mul_f32 v61, v61, v185
  v_mfma_f32_32x32x16_bf16 v[96:111], v[148:151], v[176:179], v[96:111]
  ds_read_b64_tr_b16 v[138:139], v213 offset:512
  v_mul_f32 v62, v62, v186
  v_mul_f32 v63, v63, v187
  v_mfma_f32_32x32x16_bf16 v[112:127], v[148:151], v[180:183], v[112:127]
  v_cvt_pk_bf16_f32 v190, v60, v61
  v_cvt_pk_bf16_f32 v191, v62, v63
  v_mfma_f32_32x32x16_bf16 v[80:95], v[144:147], v[180:183], v[80:95]
  s_add_u32 s34, s49, 297472
  buffer_store_dwordx4 v[188:191], v208, s[20:23], s34 offen sc1
  s_barrier
  s_waitcnt lgkmcnt(2)
  v_mfma_f32_32x32x16_bf16 v[0:15], v[128:131], a[0:3], 0
  ds_read_b64_tr_b16 v[144:145], v212 offset:2048
  v_mfma_f32_32x32x16_bf16 v[16:31], v[128:131], a[4:7], 0
  ds_read_b64_tr_b16 v[146:147], v213 offset:2048
  s_waitcnt lgkmcnt(2)
  v_mfma_f32_32x32x16_bf16 v[0:15], v[136:139], a[8:11], v[0:15]
  ds_read_b64_tr_b16 v[128:129], v212 offset:2560
  s_add_u32 s65, s60, 0
  s_add_u32 m0, s61, 0
  v_mul_f32 v184, 0xbfb8aa3b, v64
  v_mul_f32 v185, 0xbfb8aa3b, v65
  v_mul_f32 v186, 0xbfb8aa3b, v66
  v_mul_f32 v187, 0xbfb8aa3b, v67
  v_mfma_f32_32x32x16_bf16 v[16:31], v[136:139], a[12:15], v[16:31]
  ds_read_b64_tr_b16 v[130:131], v213 offset:2560
  buffer_load_dwordx4 v226, s[24:27], s65 offen lds
  v_exp_f32 v184, v184
  v_exp_f32 v185, v185
  s_waitcnt lgkmcnt(2)
  v_mfma_f32_32x32x16_bf16 v[0:15], v[144:147], a[16:19], v[0:15]
  ds_read_b64_tr_b16 v[136:137], v212 offset:4096
  s_add_u32 m0, s61, 1024
  v_exp_f32 v186, v186
  v_exp_f32 v187, v187
  v_mfma_f32_32x32x16_bf16 v[16:31], v[144:147], a[20:23], v[16:31]
  ds_read_b64_tr_b16 v[138:139], v213 offset:4096
  buffer_load_dwordx4 v227, s[24:27], s65 offen lds
  v_mul_f32 v72, v64, v72
  v_mul_f32 v73, v65, v73
  v_mul_f32 v74, v66, v74
  v_mul_f32 v75, v67, v75
  s_waitcnt lgkmcnt(2)
  v_mfma_f32_32x32x16_bf16 v[0:15], v[128:131], a[24:27], v[0:15]
  ds_read_b64_tr_b16 v[144:145], v212 offset:4608
  v_add_f32 v184, 1.0, v184
  v_add_f32 v185, 1.0, v185
  v_add_f32 v186, 1.0, v186
  v_add_f32 v187, 1.0, v187
  v_mfma_f32_32x32x16_bf16 v[16:31], v[128:131], a[28:31], v[16:31]
  ds_read_b64_tr_b16 v[146:147], v213 offset:4608
  v_rcp_f32 v184, v184
  v_rcp_f32 v185, v185
  s_waitcnt lgkmcnt(2)
  v_mfma_f32_32x32x16_bf16 v[0:15], v[136:139], a[32:35], v[0:15]
  ds_read_b64_tr_b16 v[128:129], v212 offset:6144
  s_add_u32 m0, s61, 2048
  v_rcp_f32 v186, v186
  v_rcp_f32 v187, v187
  v_mfma_f32_32x32x16_bf16 v[16:31], v[136:139], a[36:39], v[16:31]
  ds_read_b64_tr_b16 v[130:131], v213 offset:6144
  buffer_load_dwordx4 v228, s[24:27], s65 offen lds
  v_mul_f32 v72, v72, v184
  v_mul_f32 v73, v73, v185
  v_mul_f32 v74, v74, v186
  v_mul_f32 v75, v75, v187
  s_waitcnt lgkmcnt(2)
  v_mfma_f32_32x32x16_bf16 v[0:15], v[144:147], a[40:43], v[0:15]
  ds_read_b64_tr_b16 v[136:137], v212 offset:6656
  s_add_u32 m0, s61, 3072
  v_cvt_pk_bf16_f32 v188, v72, v73
  v_cvt_pk_bf16_f32 v189, v74, v75
  v_mul_f32 v184, 0xbfb8aa3b, v68
  v_mul_f32 v185, 0xbfb8aa3b, v69
  v_mfma_f32_32x32x16_bf16 v[16:31], v[144:147], a[44:47], v[16:31]
  ds_read_b64_tr_b16 v[138:139], v213 offset:6656
  buffer_load_dwordx4 v229, s[24:27], s65 offen lds
  v_mul_f32 v186, 0xbfb8aa3b, v70
  v_mul_f32 v187, 0xbfb8aa3b, v71
  v_exp_f32 v184, v184
  s_waitcnt lgkmcnt(2)
  v_mfma_f32_32x32x16_bf16 v[0:15], v[128:131], a[48:51], v[0:15]
  ds_read_b64_tr_b16 v[144:145], v212 offset:8192
  v_exp_f32 v185, v185
  v_exp_f32 v186, v186
  v_mfma_f32_32x32x16_bf16 v[16:31], v[128:131], a[52:55], v[16:31]
  ds_read_b64_tr_b16 v[146:147], v213 offset:8192
  v_exp_f32 v187, v187
  v_mul_f32 v76, v68, v76
  v_mul_f32 v77, v69, v77
  s_waitcnt lgkmcnt(2)
  v_mfma_f32_32x32x16_bf16 v[0:15], v[136:139], a[56:59], v[0:15]
  ds_read_b64_tr_b16 v[128:129], v212 offset:8704
  s_add_u32 m0, s61, 4096
  v_mul_f32 v78, v70, v78
  v_mul_f32 v79, v71, v79
  v_add_f32 v184, 1.0, v184
  v_add_f32 v185, 1.0, v185
  v_mfma_f32_32x32x16_bf16 v[16:31], v[136:139], a[60:63], v[16:31]
  ds_read_b64_tr_b16 v[130:131], v213 offset:8704
  buffer_load_dwordx4 v230, s[24:27], s65 offen lds
  v_add_f32 v186, 1.0, v186
  v_add_f32 v187, 1.0, v187
  v_rcp_f32 v184, v184
  s_waitcnt lgkmcnt(2)
  v_mfma_f32_32x32x16_bf16 v[0:15], v[144:147], a[64:67], v[0:15]
  ds_read_b64_tr_b16 v[136:137], v212 offset:10240
  s_add_u32 m0, s61, 5120
  v_rcp_f32 v185, v185
  v_rcp_f32 v186, v186
  v_mfma_f32_32x32x16_bf16 v[16:31], v[144:147], a[68:71], v[16:31]
  ds_read_b64_tr_b16 v[138:139], v213 offset:10240
  buffer_load_dwordx4 v231, s[24:27], s65 offen lds
  v_rcp_f32 v187, v187
  v_mul_f32 v76, v76, v184
  v_mul_f32 v77, v77, v185
  s_waitcnt lgkmcnt(2)
  v_mfma_f32_32x32x16_bf16 v[0:15], v[128:131], a[72:75], v[0:15]
  ds_read_b64_tr_b16 v[144:145], v212 offset:10752
  v_mul_f32 v78, v78, v186
  v_mul_f32 v79, v79, v187
  v_cvt_pk_bf16_f32 v190, v76, v77
  v_cvt_pk_bf16_f32 v191, v78, v79
  v_mfma_f32_32x32x16_bf16 v[16:31], v[128:131], a[76:79], v[16:31]
  ds_read_b64_tr_b16 v[146:147], v213 offset:10752
  s_add_u32 s34, s49, 3072
  buffer_store_dwordx4 v[188:191], v208, s[20:23], s34 offen sc1
  v_mul_f32 v184, 0xbfb8aa3b, v80
  v_mul_f32 v185, 0xbfb8aa3b, v81
  s_waitcnt lgkmcnt(2)
  v_mfma_f32_32x32x16_bf16 v[0:15], v[136:139], a[80:83], v[0:15]
  ds_read_b64_tr_b16 v[128:129], v212 offset:12288
  s_add_u32 m0, s61, 6144
  v_mul_f32 v186, 0xbfb8aa3b, v82
  v_mul_f32 v187, 0xbfb8aa3b, v83
  v_exp_f32 v184, v184
  v_mfma_f32_32x32x16_bf16 v[16:31], v[136:139], a[84:87], v[16:31]
  ds_read_b64_tr_b16 v[130:131], v213 offset:12288
  buffer_load_dwordx4 v232, s[24:27], s65 offen lds
  v_exp_f32 v185, v185
  v_exp_f32 v186, v186
  s_waitcnt lgkmcnt(2)
  v_mfma_f32_32x32x16_bf16 v[0:15], v[144:147], a[88:91], v[0:15]
  ds_read_b64_tr_b16 v[136:137], v212 offset:12800
  s_add_u32 m0, s61, 7168
  v_exp_f32 v187, v187
  v_mul_f32 v88, v80, v88
  v_mul_f32 v89, v81, v89
  v_mfma_f32_32x32x16_bf16 v[16:31], v[144:147], a[92:95], v[16:31]
  ds_read_b64_tr_b16 v[138:139], v213 offset:12800
  buffer_load_dwordx4 v233, s[24:27], s65 offen lds
  v_mul_f32 v90, v82, v90
  v_mul_f32 v91, v83, v91
  v_add_f32 v184, 1.0, v184
  v_add_f32 v185, 1.0, v185
  s_waitcnt vmcnt(10)
  s_barrier
  s_waitcnt lgkmcnt(2)
  v_mfma_f32_32x32x16_bf16 v[0:15], v[128:131], a[96:99], v[0:15]
  ds_read_b64_tr_b16 v[144:145], v212 offset:14336
  v_add_f32 v186, 1.0, v186
  v_add_f32 v187, 1.0, v187
  v_rcp_f32 v184, v184
  v_mfma_f32_32x32x16_bf16 v[16:31], v[128:131], a[100:103], v[16:31]
  ds_read_b64_tr_b16 v[146:147], v213 offset:14336
  v_rcp_f32 v185, v185
  v_rcp_f32 v186, v186
  s_waitcnt lgkmcnt(2)
  v_mfma_f32_32x32x16_bf16 v[0:15], v[136:139], a[104:107], v[0:15]
  ds_read_b64_tr_b16 v[128:129], v212 offset:14848
  s_add_u32 m0, s61, 8192
  v_rcp_f32 v187, v187
  v_mul_f32 v88, v88, v184
  v_mul_f32 v89, v89, v185
  v_mfma_f32_32x32x16_bf16 v[16:31], v[136:139], a[108:111], v[16:31]
  ds_read_b64_tr_b16 v[130:131], v213 offset:14848
  buffer_load_dwordx4 v234, s[24:27], s65 offen lds
  v_mul_f32 v90, v90, v186
  v_mul_f32 v91, v91, v187
  v_cvt_pk_bf16_f32 v188, v88, v89
  v_cvt_pk_bf16_f32 v189, v90, v91
  s_waitcnt lgkmcnt(2)
  v_mfma_f32_32x32x16_bf16 v[0:15], v[144:147], a[112:115], v[0:15]
  ds_read_b64_tr_b16 v[136:137], v204 offset:0
  v_mul_f32 v184, 0xbfb8aa3b, v84
  v_mul_f32 v185, 0xbfb8aa3b, v85
  v_mul_f32 v186, 0xbfb8aa3b, v86
  v_mul_f32 v187, 0xbfb8aa3b, v87
  v_mfma_f32_32x32x16_bf16 v[16:31], v[144:147], a[116:119], v[16:31]
  ds_read_b64_tr_b16 v[138:139], v205 offset:0
  v_exp_f32 v184, v184
  v_exp_f32 v185, v185
  s_waitcnt lgkmcnt(2)
  v_mfma_f32_32x32x16_bf16 v[0:15], v[128:131], a[120:123], v[0:15]
  ds_read_b64_tr_b16 v[144:145], v204 offset:512
  s_add_u32 s65, s60, 147456
  s_add_u32 m0, s62, 0
  v_exp_f32 v186, v186
  v_exp_f32 v187, v187
  v_mfma_f32_32x32x16_bf16 v[16:31], v[128:131], a[124:127], v[16:31]
  ds_read_b64_tr_b16 v[146:147], v205 offset:512
  buffer_load_dwordx4 v226, s[24:27], s65 offen lds
  v_mul_f32 v92, v84, v92
  v_mul_f32 v93, v85, v93
  v_mul_f32 v94, v86, v94
  v_mul_f32 v95, v87, v95
  s_waitcnt lgkmcnt(2)
  v_mfma_f32_32x32x16_bf16 v[0:15], v[136:139], a[128:131], v[0:15]
  ds_read_b64_tr_b16 v[128:129], v204 offset:2048
  s_add_u32 m0, s62, 1024
  v_add_f32 v184, 1.0, v184
  v_add_f32 v185, 1.0, v185
  v_add_f32 v186, 1.0, v186
  v_add_f32 v187, 1.0, v187
  v_mfma_f32_32x32x16_bf16 v[16:31], v[136:139], a[132:135], v[16:31]
  ds_read_b64_tr_b16 v[130:131], v205 offset:2048
  buffer_load_dwordx4 v227, s[24:27], s65 offen lds
  v_rcp_f32 v184, v184
  v_rcp_f32 v185, v185
  s_waitcnt lgkmcnt(2)
  v_mfma_f32_32x32x16_bf16 v[0:15], v[144:147], a[136:139], v[0:15]
  ds_read_b64_tr_b16 v[136:137], v204 offset:2560
  v_rcp_f32 v186, v186
  v_rcp_f32 v187, v187
  v_mfma_f32_32x32x16_bf16 v[16:31], v[144:147], a[140:143], v[16:31]
  ds_read_b64_tr_b16 v[138:139], v205 offset:2560
  v_mul_f32 v92, v92, v184
  v_mul_f32 v93, v93, v185
  v_mul_f32 v94, v94, v186
  v_mul_f32 v95, v95, v187
  s_waitcnt lgkmcnt(2)
  v_mfma_f32_32x32x16_bf16 v[0:15], v[128:131], a[144:147], v[0:15]
  ds_read_b64_tr_b16 v[144:145], v204 offset:4096
  s_add_u32 m0, s62, 2048
  v_cvt_pk_bf16_f32 v190, v92, v93
  v_cvt_pk_bf16_f32 v191, v94, v95
  s_add_u32 s34, s49, 297984
  buffer_store_dwordx4 v[188:191], v208, s[20:23], s34 offen sc1
  v_mfma_f32_32x32x16_bf16 v[16:31], v[128:131], a[148:151], v[16:31]
  ds_read_b64_tr_b16 v[146:147], v205 offset:4096
  buffer_load_dwordx4 v228, s[24:27], s65 offen lds
  v_mul_f32 v184, 0xbfb8aa3b, v96
  v_mul_f32 v185, 0xbfb8aa3b, v97
  v_mul_f32 v186, 0xbfb8aa3b, v98
  v_mul_f32 v187, 0xbfb8aa3b, v99
  s_waitcnt lgkmcnt(2)
  v_mfma_f32_32x32x16_bf16 v[0:15], v[136:139], a[152:155], v[0:15]
  ds_read_b64_tr_b16 v[128:129], v204 offset:4608
  s_add_u32 m0, s62, 3072
  v_exp_f32 v184, v184
  v_exp_f32 v185, v185
  v_mfma_f32_32x32x16_bf16 v[16:31], v[136:139], a[156:159], v[16:31]
  ds_read_b64_tr_b16 v[130:131], v205 offset:4608
  buffer_load_dwordx4 v229, s[24:27], s65 offen lds
  v_exp_f32 v186, v186
  v_exp_f32 v187, v187
  s_waitcnt lgkmcnt(2)
  v_mfma_f32_32x32x16_bf16 v[0:15], v[144:147], a[160:163], v[0:15]
  ds_read_b64_tr_b16 v[136:137], v204 offset:6144
  v_mul_f32 v104, v96, v104
  v_mul_f32 v105, v97, v105
  v_mul_f32 v106, v98, v106
  v_mul_f32 v107, v99, v107
  v_mfma_f32_32x32x16_bf16 v[16:31], v[144:147], a[164:167], v[16:31]
  ds_read_b64_tr_b16 v[138:139], v205 offset:6144
  v_add_f32 v184, 1.0, v184
  v_add_f32 v185, 1.0, v185
  v_add_f32 v186, 1.0, v186
  v_add_f32 v187, 1.0, v187
  s_waitcnt lgkmcnt(2)
  v_mfma_f32_32x32x16_bf16 v[0:15], v[128:131], a[168:171], v[0:15]
  ds_read_b64_tr_b16 v[144:145], v204 offset:6656
  s_add_u32 m0, s62, 4096
  v_rcp_f32 v184, v184
  v_rcp_f32 v185, v185
  v_mfma_f32_32x32x16_bf16 v[16:31], v[128:131], a[172:175], v[16:31]
  ds_read_b64_tr_b16 v[146:147], v205 offset:6656
  buffer_load_dwordx4 v230, s[24:27], s65 offen lds
  v_rcp_f32 v186, v186
  v_rcp_f32 v187, v187
  s_waitcnt lgkmcnt(2)
  v_mfma_f32_32x32x16_bf16 v[0:15], v[136:139], a[176:179], v[0:15]
  ds_read_b64_tr_b16 v[128:129], v204 offset:8192
  s_add_u32 m0, s62, 5120
  v_mul_f32 v104, v104, v184
  v_mul_f32 v105, v105, v185
  v_mul_f32 v106, v106, v186
  v_mul_f32 v107, v107, v187
  v_mfma_f32_32x32x16_bf16 v[16:31], v[136:139], a[180:183], v[16:31]
  ds_read_b64_tr_b16 v[130:131], v205 offset:8192
  buffer_load_dwordx4 v231, s[24:27], s65 offen lds
  v_cvt_pk_bf16_f32 v188, v104, v105
  v_cvt_pk_bf16_f32 v189, v106, v107
  v_mul_f32 v184, 0xbfb8aa3b, v100
  v_mul_f32 v185, 0xbfb8aa3b, v101
  s_waitcnt lgkmcnt(2)
  v_mfma_f32_32x32x16_bf16 v[0:15], v[144:147], a[184:187], v[0:15]
  ds_read_b64_tr_b16 v[136:137], v204 offset:8704
  v_mul_f32 v186, 0xbfb8aa3b, v102
  v_mul_f32 v187, 0xbfb8aa3b, v103
  v_exp_f32 v184, v184
  v_mfma_f32_32x32x16_bf16 v[16:31], v[144:147], a[188:191], v[16:31]
  ds_read_b64_tr_b16 v[138:139], v205 offset:8704
  v_exp_f32 v185, v185
  v_exp_f32 v186, v186
  s_waitcnt lgkmcnt(2)
  v_mfma_f32_32x32x16_bf16 v[0:15], v[128:131], a[192:195], v[0:15]
  ds_read_b64_tr_b16 v[144:145], v204 offset:10240
  s_add_u32 m0, s62, 6144
  v_exp_f32 v187, v187
  v_mul_f32 v108, v100, v108
  v_mul_f32 v109, v101, v109
  v_mfma_f32_32x32x16_bf16 v[16:31], v[128:131], a[196:199], v[16:31]
  ds_read_b64_tr_b16 v[146:147], v205 offset:10240
  buffer_load_dwordx4 v232, s[24:27], s65 offen lds
  v_mul_f32 v110, v102, v110
  v_mul_f32 v111, v103, v111
  v_add_f32 v184, 1.0, v184
  v_add_f32 v185, 1.0, v185
  s_waitcnt lgkmcnt(2)
  v_mfma_f32_32x32x16_bf16 v[0:15], v[136:139], a[200:203], v[0:15]
  ds_read_b64_tr_b16 v[128:129], v204 offset:10752
  s_add_u32 m0, s62, 7168
  v_add_f32 v186, 1.0, v186
  v_add_f32 v187, 1.0, v187
  v_rcp_f32 v184, v184
  v_mfma_f32_32x32x16_bf16 v[16:31], v[136:139], a[204:207], v[16:31]
  ds_read_b64_tr_b16 v[130:131], v205 offset:10752
  buffer_load_dwordx4 v233, s[24:27], s65 offen lds
  v_rcp_f32 v185, v185
  v_rcp_f32 v186, v186
  s_waitcnt lgkmcnt(2)
  v_mfma_f32_32x32x16_bf16 v[0:15], v[144:147], a[208:211], v[0:15]
  ds_read_b64_tr_b16 v[136:137], v204 offset:12288
  v_rcp_f32 v187, v187
  v_mul_f32 v108, v108, v184
  v_mul_f32 v109, v109, v185
  v_mfma_f32_32x32x16_bf16 v[16:31], v[144:147], a[212:215], v[16:31]
  ds_read_b64_tr_b16 v[138:139], v205 offset:12288
  v_mul_f32 v110, v110, v186
  v_mul_f32 v111, v111, v187
  v_cvt_pk_bf16_f32 v190, v108, v109
  v_cvt_pk_bf16_f32 v191, v110, v111
  s_waitcnt lgkmcnt(2)
  v_mfma_f32_32x32x16_bf16 v[0:15], v[128:131], a[216:219], v[0:15]
  ds_read_b64_tr_b16 v[144:145], v204 offset:12800
  s_add_u32 m0, s62, 8192
  s_add_u32 s34, s49, 3584
  buffer_store_dwordx4 v[188:191], v208, s[20:23], s34 offen sc1
  v_mul_f32 v184, 0xbfb8aa3b, v112
  v_mul_f32 v185, 0xbfb8aa3b, v113
  v_mfma_f32_32x32x16_bf16 v[16:31], v[128:131], a[220:223], v[16:31]
  ds_read_b64_tr_b16 v[146:147], v205 offset:12800
  buffer_load_dwordx4 v234, s[24:27], s65 offen lds
  v_mul_f32 v186, 0xbfb8aa3b, v114
  v_mul_f32 v187, 0xbfb8aa3b, v115
  v_exp_f32 v184, v184
  s_waitcnt lgkmcnt(2)
  v_mfma_f32_32x32x16_bf16 v[0:15], v[136:139], a[224:227], v[0:15]
  ds_read_b64_tr_b16 v[128:129], v204 offset:14336
  v_exp_f32 v185, v185
  v_exp_f32 v186, v186
  v_mfma_f32_32x32x16_bf16 v[16:31], v[136:139], a[228:231], v[16:31]
  ds_read_b64_tr_b16 v[130:131], v205 offset:14336
  v_exp_f32 v187, v187
  v_mul_f32 v120, v112, v120
  v_mul_f32 v121, v113, v121
  s_waitcnt lgkmcnt(2)
  v_mfma_f32_32x32x16_bf16 v[0:15], v[144:147], a[232:235], v[0:15]
  ds_read_b64_tr_b16 v[136:137], v204 offset:14848
  v_mul_f32 v122, v114, v122
  v_mul_f32 v123, v115, v123
  v_add_f32 v184, 1.0, v184
  v_add_f32 v185, 1.0, v185
  v_mfma_f32_32x32x16_bf16 v[16:31], v[144:147], a[236:239], v[16:31]
  ds_read_b64_tr_b16 v[138:139], v205 offset:14848
  v_add_f32 v186, 1.0, v186
  v_add_f32 v187, 1.0, v187
  v_rcp_f32 v184, v184
  s_waitcnt lgkmcnt(2)
  v_mfma_f32_32x32x16_bf16 v[0:15], v[128:131], a[240:243], v[0:15]
  ds_read_b64_tr_b16 v[144:145], v204 offset:16384
  v_rcp_f32 v185, v185
  v_rcp_f32 v186, v186
  v_mfma_f32_32x32x16_bf16 v[16:31], v[128:131], a[244:247], v[16:31]
  ds_read_b64_tr_b16 v[146:147], v205 offset:16384
  v_rcp_f32 v187, v187
  v_mul_f32 v120, v120, v184
  v_mul_f32 v121, v121, v185
  s_waitcnt lgkmcnt(2)
  v_mfma_f32_32x32x16_bf16 v[0:15], v[136:139], a[248:251], v[0:15]
  ds_read_b64_tr_b16 v[128:129], v204 offset:16896
  v_mul_f32 v122, v122, v186
  v_mul_f32 v123, v123, v187
  v_cvt_pk_bf16_f32 v188, v120, v121
  v_cvt_pk_bf16_f32 v189, v122, v123
  v_mfma_f32_32x32x16_bf16 v[16:31], v[136:139], a[252:255], v[16:31]
  ds_read_b64_tr_b16 v[130:131], v205 offset:16896
  v_mul_f32 v184, 0xbfb8aa3b, v116
  v_mul_f32 v185, 0xbfb8aa3b, v117
  v_mul_f32 v186, 0xbfb8aa3b, v118
  v_mul_f32 v187, 0xbfb8aa3b, v119
  s_waitcnt lgkmcnt(2)
  v_mfma_f32_32x32x16_bf16 v[0:15], v[144:147], v[152:155], v[0:15]
  ds_read_b64_tr_b16 v[136:137], v204 offset:18432
  v_exp_f32 v184, v184
  v_exp_f32 v185, v185
  v_mfma_f32_32x32x16_bf16 v[16:31], v[144:147], v[156:159], v[16:31]
  ds_read_b64_tr_b16 v[138:139], v205 offset:18432
  v_exp_f32 v186, v186
  v_exp_f32 v187, v187
  s_waitcnt lgkmcnt(2)
  v_mfma_f32_32x32x16_bf16 v[0:15], v[128:131], v[160:163], v[0:15]
  ds_read_b64_tr_b16 v[144:145], v204 offset:18944
  v_mul_f32 v124, v116, v124
  v_mul_f32 v125, v117, v125
  v_mul_f32 v126, v118, v126
  v_mul_f32 v127, v119, v127
  v_mfma_f32_32x32x16_bf16 v[16:31], v[128:131], v[164:167], v[16:31]
  ds_read_b64_tr_b16 v[146:147], v205 offset:18944
  v_add_f32 v184, 1.0, v184
  v_add_f32 v185, 1.0, v185
  v_add_f32 v186, 1.0, v186
  v_add_f32 v187, 1.0, v187
  s_waitcnt lgkmcnt(2)
  v_mfma_f32_32x32x16_bf16 v[0:15], v[136:139], v[168:171], v[0:15]
  v_rcp_f32 v184, v184
  v_rcp_f32 v185, v185
  v_mfma_f32_32x32x16_bf16 v[16:31], v[136:139], v[172:175], v[16:31]
  v_rcp_f32 v186, v186
  v_rcp_f32 v187, v187
  s_waitcnt lgkmcnt(0)
  v_mfma_f32_32x32x16_bf16 v[0:15], v[144:147], v[176:179], v[0:15]
  v_mul_f32 v124, v124, v184
  v_mul_f32 v125, v125, v185
  v_mul_f32 v126, v126, v186
  v_mul_f32 v127, v127, v187
  v_mfma_f32_32x32x16_bf16 v[16:31], v[144:147], v[180:183], v[16:31]
  v_cvt_pk_bf16_f32 v190, v124, v125
  v_cvt_pk_bf16_f32 v191, v126, v127
  s_add_u32 s34, s49, 298496
  buffer_store_dwordx4 v[188:191], v208, s[20:23], s34 offen sc1
  s_nop 2
  v_mul_f32 v184, 0xbfb8aa3b, v0
  v_mul_f32 v185, 0xbfb8aa3b, v1
  v_mul_f32 v186, 0xbfb8aa3b, v2
  v_mul_f32 v187, 0xbfb8aa3b, v3
  v_exp_f32 v184, v184
  v_exp_f32 v185, v185
  v_exp_f32 v186, v186
  v_exp_f32 v187, v187
  v_mul_f32 v8, v0, v8
  v_mul_f32 v9, v1, v9
  v_mul_f32 v10, v2, v10
  v_mul_f32 v11, v3, v11
  v_add_f32 v184, 1.0, v184
  v_add_f32 v185, 1.0, v185
  v_add_f32 v186, 1.0, v186
  v_add_f32 v187, 1.0, v187
  v_rcp_f32 v184, v184
  v_rcp_f32 v185, v185
  v_rcp_f32 v186, v186
  v_rcp_f32 v187, v187
  v_mul_f32 v8, v8, v184
  v_mul_f32 v9, v9, v185
  v_mul_f32 v10, v10, v186
  v_mul_f32 v11, v11, v187
  v_cvt_pk_bf16_f32 v188, v8, v9
  v_cvt_pk_bf16_f32 v189, v10, v11
  v_mul_f32 v184, 0xbfb8aa3b, v4
  v_mul_f32 v185, 0xbfb8aa3b, v5
  v_mul_f32 v186, 0xbfb8aa3b, v6
  v_mul_f32 v187, 0xbfb8aa3b, v7
  v_exp_f32 v184, v184
  v_exp_f32 v185, v185
  v_exp_f32 v186, v186
  v_exp_f32 v187, v187
  v_mul_f32 v12, v4, v12
  v_mul_f32 v13, v5, v13
  v_mul_f32 v14, v6, v14
  v_mul_f32 v15, v7, v15
  v_add_f32 v184, 1.0, v184
  v_add_f32 v185, 1.0, v185
  v_add_f32 v186, 1.0, v186
  v_add_f32 v187, 1.0, v187
  v_rcp_f32 v184, v184
  v_rcp_f32 v185, v185
  v_rcp_f32 v186, v186
  v_rcp_f32 v187, v187
  v_mul_f32 v12, v12, v184
  v_mul_f32 v13, v13, v185
  v_mul_f32 v14, v14, v186
  v_mul_f32 v15, v15, v187
  v_cvt_pk_bf16_f32 v190, v12, v13
  v_cvt_pk_bf16_f32 v191, v14, v15
  s_add_u32 s34, s50, 0
  buffer_store_dwordx4 v[188:191], v208, s[20:23], s34 offen sc1
  v_mul_f32 v184, 0xbfb8aa3b, v16
  v_mul_f32 v185, 0xbfb8aa3b, v17
  v_mul_f32 v186, 0xbfb8aa3b, v18
  v_mul_f32 v187, 0xbfb8aa3b, v19
  v_exp_f32 v184, v184
  v_exp_f32 v185, v185
  v_exp_f32 v186, v186
  v_exp_f32 v187, v187
  v_mul_f32 v24, v16, v24
  v_mul_f32 v25, v17, v25
  v_mul_f32 v26, v18, v26
  v_mul_f32 v27, v19, v27
  v_add_f32 v184, 1.0, v184
  v_add_f32 v185, 1.0, v185
  v_add_f32 v186, 1.0, v186
  v_add_f32 v187, 1.0, v187
  v_rcp_f32 v184, v184
  v_rcp_f32 v185, v185
  v_rcp_f32 v186, v186
  v_rcp_f32 v187, v187
  v_mul_f32 v24, v24, v184
  v_mul_f32 v25, v25, v185
  v_mul_f32 v26, v26, v186
  v_mul_f32 v27, v27, v187
  v_cvt_pk_bf16_f32 v188, v24, v25
  v_cvt_pk_bf16_f32 v189, v26, v27
  v_mul_f32 v184, 0xbfb8aa3b, v20
  v_mul_f32 v185, 0xbfb8aa3b, v21
  v_mul_f32 v186, 0xbfb8aa3b, v22
  v_mul_f32 v187, 0xbfb8aa3b, v23
  v_exp_f32 v184, v184
  v_exp_f32 v185, v185
  v_exp_f32 v186, v186
  v_exp_f32 v187, v187
  v_mul_f32 v28, v20, v28
  v_mul_f32 v29, v21, v29
  v_mul_f32 v30, v22, v30
  v_mul_f32 v31, v23, v31
  v_add_f32 v184, 1.0, v184
  v_add_f32 v185, 1.0, v185
  v_add_f32 v186, 1.0, v186
  v_add_f32 v187, 1.0, v187
  v_rcp_f32 v184, v184
  v_rcp_f32 v185, v185
  v_rcp_f32 v186, v186
  v_rcp_f32 v187, v187
  v_mul_f32 v28, v28, v184
  v_mul_f32 v29, v29, v185
  v_mul_f32 v30, v30, v186
  v_mul_f32 v31, v31, v187
  v_cvt_pk_bf16_f32 v190, v28, v29
  v_cvt_pk_bf16_f32 v191, v30, v31
  s_add_u32 s34, s50, 294912
  buffer_store_dwordx4 v[188:191], v208, s[20:23], s34 offen sc1
  s_bfe_u32 s39, s2, 0x20001
  s_lshr_b32 s42, s2, 3
  s_lshr_b32 s42, s42, 2
  s_and_b32 s43, s2, 1
  s_lshl_b32 s43, s43, 3
  s_add_u32 s42, s42, s43
  s_lshl_b32 s45, s42, 3
  s_lshl_b32 s46, s38, 1
  s_add_u32 s45, s45, s46
  s_mul_i32 s46, s45, 147456
  s_mul_i32 s47, s39, 36864
  s_add_u32 s46, s46, s47
  v_lshlrev_b32 v141, 4, v216
  v_add_u32 v140, s46, v141
  v_add_u32 v151, 147456, v140
  s_mul_i32 s46, s39, 2359296
  s_lshl_b32 s47, s42, 2
  s_add_u32 s47, s47, s41
  s_lshl_b32 s47, s47, 2
  s_add_u32 s47, s47, s38
  s_mul_i32 s47, s47, 9216
  s_add_u32 s66, s46, s47
  s_add_u32 s4, s36, 0x1b10000
  s_addc_u32 s5, s37, 0
  s_mov_b32 s6, 0x900000
  s_mov_b32 s7, 0x20000
  s_load_dwordx2 s[54:55], s[0:1], 96
  s_add_u32 s8, s36, 0x480000
  s_addc_u32 s9, s37, 0
  s_mov_b32 s10, 0x240000
  s_mov_b32 s11, 0x20000
  s_add_u32 s16, s36, 0x900000
  s_addc_u32 s17, s37, 0
  s_mov_b32 s18, 0x3600
  s_mov_b32 s19, 0x20000
  s_waitcnt lgkmcnt(0)
  s_mov_b32 s12, s54
  s_mov_b32 s13, s55
  s_mov_b32 s14, 0x240000
  s_mov_b32 s15, 0x20000
  v_lshrrev_b32 v154, 5, v216
  v_bfe_u32 v156, v216, 2, 3
  v_lshl_add_u32 v156, v154, 4, v156
  v_mul_u32_u24 v156, 288, v156
  v_and_b32 v155, 3, v216
  v_lshl_add_u32 v137, v155, 3, v156
  v_add_u32 v138, 55296, v137
  v_add_u32 v139, 110592, v137
  s_mul_i32 s48, s38, 9728
  s_add_u32 s48, s48, 92160
  v_and_b32 v154, 15, v216
  v_mul_u32_u24 v154, 304, v154
  v_lshrrev_b32 v155, 4, v216
  v_lshl_add_u32 v154, v155, 3, v154
  v_add_u32 v154, s48, v154
  s_lshl_b32 s68, s38, 6
  v_add_u32 v174, s68, v216
  s_mul_i32 s68, s41, 224
  s_sub_u32 s68, 768, s68
  s_lshl_b32 s69, s41, 8
  s_lshl_b32 s43, s42, 2
  s_add_u32 s43, s43, s39
  s_mul_i32 s43, s43, 36864
  s_mul_i32 s44, s39, 9728
  s_add_u32 s44, s44, 92160
  s_mov_b32 s45, 0xe38e38f
  v_add_u32 v175, 0, v174
  v_mul_hi_u32 v176, v175, s45
  v_mul_u32_u24 v177, 18, v176
  v_sub_u32 v177, v175, v177
  v_mul_u32_u24 v164, 304, v176
  v_lshl_add_u32 v164, v177, 4, v164
  v_add_u32 v164, s44, v164
  v_lshlrev_b32 v178, 4, v177
  v_add_u32 v178, s69, v178
  v_add_u32 v179, s68, v178
  v_cmp_lt_u32 vcc, 15, v177
  s_nop 1
  v_cndmask_b32 v178, v178, v179, vcc
  v_lshlrev_b32 v170, 1, v178
  v_add_u32 v170, 11520, v170
  v_mul_u32_u24 v176, 1152, v176
  v_add3_u32 v167, v176, v178, s43
  v_add_u32 v175, 256, v174
  v_mul_hi_u32 v176, v175, s45
  v_mul_u32_u24 v177, 18, v176
  v_sub_u32 v177, v175, v177
  v_mul_u32_u24 v165, 304, v176
  v_lshl_add_u32 v165, v177, 4, v165
  v_add_u32 v165, s44, v165
  v_lshlrev_b32 v178, 4, v177
  v_add_u32 v178, s69, v178
  v_add_u32 v179, s68, v178
  v_cmp_lt_u32 vcc, 15, v177
  s_nop 1
  v_cndmask_b32 v178, v178, v179, vcc
  v_lshlrev_b32 v171, 1, v178
  v_add_u32 v171, 11520, v171
  v_mul_u32_u24 v176, 1152, v176
  v_add3_u32 v168, v176, v178, s43
  v_add_u32 v175, 512, v174
  v_mul_hi_u32 v176, v175, s45
  v_mul_u32_u24 v177, 18, v176
  v_sub_u32 v177, v175, v177
  v_mul_u32_u24 v166, 304, v176
  v_lshl_add_u32 v166, v177, 4, v166
  v_add_u32 v166, s44, v166
  v_lshlrev_b32 v178, 4, v177
  v_add_u32 v178, s69, v178
  v_add_u32 v179, s68, v178
  v_cmp_lt_u32 vcc, 15, v177
  s_nop 1
  v_cndmask_b32 v178, v178, v179, vcc
  v_lshlrev_b32 v172, 1, v178
  v_add_u32 v172, 11520, v172
  v_mul_u32_u24 v176, 1152, v176
  v_add3_u32 v169, v176, v178, s43
  v_cmp_gt_u32 vcc, 64, v174
  v_mov_b32 v175, 0x7ff00000
  s_nop 0
  v_cndmask_b32 v169, v175, v169, vcc
  v_lshlrev_b32 v180, 4, v174
  v_add_u32 v181, 0x2000, v180
  v_cndmask_b32 v181, v175, v181, vcc
  s_mov_b32 s69, 0xe38e38f
  v_add_u32 v156, 0, v216
  v_mul_hi_u32 v157, v156, s69
  v_mul_u32_u24 v158, 18, v157
  v_sub_u32 v158, v156, v158
  v_mul_u32_u24 v157, 304, v157
  v_lshl_add_u32 v142, v158, 4, v157
  v_add_u32 v142, s48, v142
  v_add_u32 v156, 64, v216
  v_mul_hi_u32 v157, v156, s69
  v_mul_u32_u24 v158, 18, v157
  v_sub_u32 v158, v156, v158
  v_mul_u32_u24 v157, 304, v157
  v_lshl_add_u32 v143, v158, 4, v157
  v_add_u32 v143, s48, v143
  v_add_u32 v156, 128, v216
  v_mul_hi_u32 v157, v156, s69
  v_mul_u32_u24 v158, 18, v157
  v_sub_u32 v158, v156, v158
  v_mul_u32_u24 v157, 304, v157
  v_lshl_add_u32 v144, v158, 4, v157
  v_add_u32 v144, s48, v144
  v_add_u32 v156, 192, v216
  v_mul_hi_u32 v157, v156, s69
  v_mul_u32_u24 v158, 18, v157
  v_sub_u32 v158, v156, v158
  v_mul_u32_u24 v157, 304, v157
  v_lshl_add_u32 v145, v158, 4, v157
  v_add_u32 v145, s48, v145
  v_add_u32 v156, 256, v216
  v_mul_hi_u32 v157, v156, s69
  v_mul_u32_u24 v158, 18, v157
  v_sub_u32 v158, v156, v158
  v_mul_u32_u24 v157, 304, v157
  v_lshl_add_u32 v146, v158, 4, v157
  v_add_u32 v146, s48, v146
  v_add_u32 v156, 320, v216
  v_mul_hi_u32 v157, v156, s69
  v_mul_u32_u24 v158, 18, v157
  v_sub_u32 v158, v156, v158
  v_mul_u32_u24 v157, 304, v157
  v_lshl_add_u32 v147, v158, 4, v157
  v_add_u32 v147, s48, v147
  v_add_u32 v156, 384, v216
  v_mul_hi_u32 v157, v156, s69
  v_mul_u32_u24 v158, 18, v157
  v_sub_u32 v158, v156, v158
  v_mul_u32_u24 v157, 304, v157
  v_lshl_add_u32 v148, v158, 4, v157
  v_add_u32 v148, s48, v148
  v_add_u32 v156, 448, v216
  v_mul_hi_u32 v157, v156, s69
  v_mul_u32_u24 v158, 18, v157
  v_sub_u32 v158, v156, v158
  v_mul_u32_u24 v157, 304, v157
  v_lshl_add_u32 v149, v158, 4, v157
  v_add_u32 v149, s48, v149
  v_add_u32 v156, 512, v216
  v_mul_hi_u32 v157, v156, s69
  v_mul_u32_u24 v158, 18, v157
  v_sub_u32 v158, v156, v158
  v_mul_u32_u24 v157, 304, v157
  v_lshl_add_u32 v150, v158, 4, v157
  v_add_u32 v150, s48, v150
  s_waitcnt vmcnt(0)
  s_barrier
  s_lshl_b32 s68, s40, 2
  s_bfe_u32 s69, s2, 0x20001
  s_add_u32 s68, s68, s69
  s_lshl_b32 s68, s68, 8
  s_add_u32 s68, s68, 32768
  s_cmp_lg_u32 s38, 0
  s_cbranch_scc1 sig2_m_kernel
  s_mov_b64 exec, 1
  v_mov_b32 v1, s68
  v_mov_b32 v2, 1
  global_atomic_add v1, v2, s[52:53]
  s_mov_b64 exec, -1
sig2_m_kernel:
  s_add_u32 s65, s60, 294912
  s_add_u32 m0, s63, 0
  s_nop 0
  buffer_load_dwordx4 v226, s[24:27], s65 offen lds
  s_add_u32 m0, s63, 1024
  s_nop 0
  buffer_load_dwordx4 v227, s[24:27], s65 offen lds
  s_add_u32 m0, s63, 2048
  s_nop 0
  buffer_load_dwordx4 v228, s[24:27], s65 offen lds
  s_add_u32 m0, s63, 3072
  s_nop 0
  buffer_load_dwordx4 v229, s[24:27], s65 offen lds
  s_add_u32 m0, s63, 4096
  s_nop 0
  buffer_load_dwordx4 v230, s[24:27], s65 offen lds
  s_add_u32 m0, s63, 5120
  s_nop 0
  buffer_load_dwordx4 v231, s[24:27], s65 offen lds
  s_add_u32 m0, s63, 6144
  s_nop 0
  buffer_load_dwordx4 v232, s[24:27], s65 offen lds
  s_add_u32 m0, s63, 7168
  s_nop 0
  buffer_load_dwordx4 v233, s[24:27], s65 offen lds
  s_add_u32 m0, s63, 8192
  s_nop 0
  buffer_load_dwordx4 v234, s[24:27], s65 offen lds
  s_cmp_lg_u32 s38, 0
  s_cbranch_scc1 handoff2_m_kernel
  s_mov_b64 exec, 1
  s_mov_b32 s69, 0
poll2_m_kernel:
  global_load_dword v2, v1, s[52:53] sc1
  s_waitcnt vmcnt(0)
  v_readfirstlane_b32 s68, v2
  s_add_u32 s69, s69, 1
  s_nop 0
  s_cmp_ge_u32 s68, 8
  s_cbranch_scc1 polled2_m_kernel
  s_sleep 1
  s_cmp_lt_u32 s69, 40000
  s_cbranch_scc1 poll2_m_kernel
polled2_m_kernel:
  s_mov_b64 exec, -1
handoff2_m_kernel:
  s_barrier
  buffer_load_dwordx4 a[0:3], v140, s[20:23], 0 offen offset:0 sc1
  buffer_load_dwordx4 a[4:7], v151, s[20:23], 0 offen offset:0 sc1
  buffer_load_dwordx4 a[8:11], v140, s[20:23], 0 offen offset:1024 sc1
  buffer_load_dwordx4 a[12:15], v151, s[20:23], 0 offen offset:1024 sc1
  buffer_load_dwordx4 a[16:19], v140, s[20:23], 0 offen offset:2048 sc1
  buffer_load_dwordx4 a[20:23], v151, s[20:23], 0 offen offset:2048 sc1
  ds_read_b64_tr_b16 v[72:73], v138 offset:0
  ds_read_b64_tr_b16 v[74:75], v138 offset:2304
  ds_read_b64_tr_b16 v[76:77], v138 offset:32
  ds_read_b64_tr_b16 v[78:79], v138 offset:2336
  ds_read_b64_tr_b16 v[80:81], v138 offset:64
  ds_read_b64_tr_b16 v[82:83], v138 offset:2368
  ds_read_b64_tr_b16 v[84:85], v138 offset:96
  ds_read_b64_tr_b16 v[86:87], v138 offset:2400
  s_waitcnt vmcnt(4) lgkmcnt(4)
  v_mfma_f32_16x16x32_bf16 v[0:3], v[72:75], a[0:3], 0
  ds_read_b64_tr_b16 v[88:89], v138 offset:128
  v_mfma_f32_16x16x32_bf16 v[4:7], v[72:75], a[4:7], 0
  ds_read_b64_tr_b16 v[90:91], v138 offset:2432
  v_mfma_f32_16x16x32_bf16 v[8:11], v[76:79], a[0:3], 0
  ds_read_b64_tr_b16 v[92:93], v138 offset:160
  buffer_load_dwordx4 a[24:27], v140, s[20:23], 0 offen offset:3072 sc1
  v_mfma_f32_16x16x32_bf16 v[12:15], v[76:79], a[4:7], 0
  ds_read_b64_tr_b16 v[94:95], v138 offset:2464
  buffer_load_dwordx4 a[28:31], v151, s[20:23], 0 offen offset:3072 sc1
  s_waitcnt lgkmcnt(4)
  v_mfma_f32_16x16x32_bf16 v[16:19], v[80:83], a[0:3], 0
  ds_read_b64_tr_b16 v[72:73], v138 offset:192
  v_mfma_f32_16x16x32_bf16 v[20:23], v[80:83], a[4:7], 0
  ds_read_b64_tr_b16 v[74:75], v138 offset:2496
  v_mfma_f32_16x16x32_bf16 v[24:27], v[84:87], a[0:3], 0
  ds_read_b64_tr_b16 v[76:77], v138 offset:224
  v_mfma_f32_16x16x32_bf16 v[28:31], v[84:87], a[4:7], 0
  ds_read_b64_tr_b16 v[78:79], v138 offset:2528
  s_waitcnt lgkmcnt(4)
  v_mfma_f32_16x16x32_bf16 v[32:35], v[88:91], a[0:3], 0
  ds_read_b64_tr_b16 v[80:81], v138 offset:256
  s_mov_b32 s67, 4096
  buffer_load_dwordx4 a[32:35], v140, s[20:23], s67 offen offset:0 sc1
  v_mfma_f32_16x16x32_bf16 v[36:39], v[88:91], a[4:7], 0
  ds_read_b64_tr_b16 v[82:83], v138 offset:2560
  buffer_load_dwordx4 a[36:39], v151, s[20:23], s67 offen offset:0 sc1
  v_mfma_f32_16x16x32_bf16 v[40:43], v[92:95], a[0:3], 0
  ds_read_b64_tr_b16 v[84:85], v138 offset:9216
  v_mfma_f32_16x16x32_bf16 v[44:47], v[92:95], a[4:7], 0
  ds_read_b64_tr_b16 v[86:87], v138 offset:11520
  s_waitcnt lgkmcnt(4)
  v_mfma_f32_16x16x32_bf16 v[48:51], v[72:75], a[0:3], 0
  ds_read_b64_tr_b16 v[88:89], v138 offset:9248
  v_mfma_f32_16x16x32_bf16 v[52:55], v[72:75], a[4:7], 0
  ds_read_b64_tr_b16 v[90:91], v138 offset:11552
  v_mfma_f32_16x16x32_bf16 v[56:59], v[76:79], a[0:3], 0
  ds_read_b64_tr_b16 v[92:93], v138 offset:9280
  v_mfma_f32_16x16x32_bf16 v[60:63], v[76:79], a[4:7], 0
  ds_read_b64_tr_b16 v[94:95], v138 offset:11584
  s_waitcnt lgkmcnt(4)
  v_mfma_f32_16x16x32_bf16 v[64:67], v[80:83], a[0:3], 0
  ds_read_b64_tr_b16 v[72:73], v138 offset:9312
  v_mfma_f32_16x16x32_bf16 v[68:71], v[80:83], a[4:7], 0
  ds_read_b64_tr_b16 v[74:75], v138 offset:11616
  s_waitcnt vmcnt(6)
  v_mfma_f32_16x16x32_bf16 v[0:3], v[84:87], a[8:11], v[0:3]
  ds_read_b64_tr_b16 v[76:77], v138 offset:9344
  v_mfma_f32_16x16x32_bf16 v[4:7], v[84:87], a[12:15], v[4:7]
  ds_read_b64_tr_b16 v[78:79], v138 offset:11648
  s_waitcnt lgkmcnt(4)
  v_mfma_f32_16x16x32_bf16 v[8:11], v[88:91], a[8:11], v[8:11]
  ds_read_b64_tr_b16 v[80:81], v138 offset:9376
  s_add_u32 s65, s60, 442368
  s_add_u32 m0, s64, 0
  v_mfma_f32_16x16x32_bf16 v[12:15], v[88:91], a[12:15], v[12:15]
  ds_read_b64_tr_b16 v[82:83], v138 offset:11680
  buffer_load_dwordx4 v226, s[24:27], s65 offen lds
  v_mfma_f32_16x16x32_bf16 v[16:19], v[92:95], a[8:11], v[16:19]
  ds_read_b64_tr_b16 v[84:85], v138 offset:9408
  s_add_u32 m0, s64, 1024
  s_nop 0
  buffer_load_dwordx4 v227, s[24:27], s65 offen lds
  v_mfma_f32_16x16x32_bf16 v[20:23], v[92:95], a[12:15], v[20:23]
  ds_read_b64_tr_b16 v[86:87], v138 offset:11712
  s_add_u32 m0, s64, 2048
  s_nop 0
  buffer_load_dwordx4 v228, s[24:27], s65 offen lds
  s_waitcnt lgkmcnt(4)
  v_mfma_f32_16x16x32_bf16 v[24:27], v[72:75], a[8:11], v[24:27]
  ds_read_b64_tr_b16 v[88:89], v138 offset:9440
  s_add_u32 m0, s64, 3072
  s_nop 0
  buffer_load_dwordx4 v229, s[24:27], s65 offen lds
  v_mfma_f32_16x16x32_bf16 v[28:31], v[72:75], a[12:15], v[28:31]
  ds_read_b64_tr_b16 v[90:91], v138 offset:11744
  s_add_u32 m0, s64, 4096
  s_nop 0
  buffer_load_dwordx4 v230, s[24:27], s65 offen lds
  v_mfma_f32_16x16x32_bf16 v[32:35], v[76:79], a[8:11], v[32:35]
  ds_read_b64_tr_b16 v[92:93], v138 offset:9472
  s_add_u32 m0, s64, 5120
  s_nop 0
  buffer_load_dwordx4 v231, s[24:27], s65 offen lds
  v_mfma_f32_16x16x32_bf16 v[36:39], v[76:79], a[12:15], v[36:39]
  ds_read_b64_tr_b16 v[94:95], v138 offset:11776
  s_add_u32 m0, s64, 6144
  s_nop 0
  buffer_load_dwordx4 v232, s[24:27], s65 offen lds
  s_waitcnt lgkmcnt(4)
  v_mfma_f32_16x16x32_bf16 v[40:43], v[80:83], a[8:11], v[40:43]
  ds_read_b64_tr_b16 v[72:73], v138 offset:18432
  s_add_u32 m0, s64, 7168
  s_nop 0
  buffer_load_dwordx4 v233, s[24:27], s65 offen lds
  v_mfma_f32_16x16x32_bf16 v[44:47], v[80:83], a[12:15], v[44:47]
  ds_read_b64_tr_b16 v[74:75], v138 offset:20736
  s_add_u32 m0, s64, 8192
  s_nop 0
  buffer_load_dwordx4 v234, s[24:27], s65 offen lds
  v_mfma_f32_16x16x32_bf16 v[48:51], v[84:87], a[8:11], v[48:51]
  ds_read_b64_tr_b16 v[76:77], v138 offset:18464
  buffer_load_dwordx4 a[40:43], v140, s[20:23], s67 offen offset:1024 sc1
  v_mfma_f32_16x16x32_bf16 v[52:55], v[84:87], a[12:15], v[52:55]
  ds_read_b64_tr_b16 v[78:79], v138 offset:20768
  buffer_load_dwordx4 a[44:47], v151, s[20:23], s67 offen offset:1024 sc1
  s_waitcnt lgkmcnt(4)
  v_mfma_f32_16x16x32_bf16 v[56:59], v[88:91], a[8:11], v[56:59]
  ds_read_b64_tr_b16 v[80:81], v138 offset:18496
  v_mfma_f32_16x16x32_bf16 v[60:63], v[88:91], a[12:15], v[60:63]
  ds_read_b64_tr_b16 v[82:83], v138 offset:20800
  v_mfma_f32_16x16x32_bf16 v[64:67], v[92:95], a[8:11], v[64:67]
  ds_read_b64_tr_b16 v[84:85], v138 offset:18528
  v_mfma_f32_16x16x32_bf16 v[68:71], v[92:95], a[12:15], v[68:71]
  ds_read_b64_tr_b16 v[86:87], v138 offset:20832
  s_waitcnt vmcnt(15) lgkmcnt(4)
  v_mfma_f32_16x16x32_bf16 v[0:3], v[72:75], a[16:19], v[0:3]
  ds_read_b64_tr_b16 v[88:89], v138 offset:18560
  v_mfma_f32_16x16x32_bf16 v[4:7], v[72:75], a[20:23], v[4:7]
  ds_read_b64_tr_b16 v[90:91], v138 offset:20864
  v_mfma_f32_16x16x32_bf16 v[8:11], v[76:79], a[16:19], v[8:11]
  ds_read_b64_tr_b16 v[92:93], v138 offset:18592
  v_mfma_f32_16x16x32_bf16 v[12:15], v[76:79], a[20:23], v[12:15]
  ds_read_b64_tr_b16 v[94:95], v138 offset:20896
  s_waitcnt lgkmcnt(4)
  v_mfma_f32_16x16x32_bf16 v[16:19], v[80:83], a[16:19], v[16:19]
  ds_read_b64_tr_b16 v[72:73], v138 offset:18624
  v_mfma_f32_16x16x32_bf16 v[20:23], v[80:83], a[20:23], v[20:23]
  ds_read_b64_tr_b16 v[74:75], v138 offset:20928
  v_mfma_f32_16x16x32_bf16 v[24:27], v[84:87], a[16:19], v[24:27]
  ds_read_b64_tr_b16 v[76:77], v138 offset:18656
  v_mfma_f32_16x16x32_bf16 v[28:31], v[84:87], a[20:23], v[28:31]
  ds_read_b64_tr_b16 v[78:79], v138 offset:20960
  s_waitcnt lgkmcnt(4)
  v_mfma_f32_16x16x32_bf16 v[32:35], v[88:91], a[16:19], v[32:35]
  ds_read_b64_tr_b16 v[80:81], v138 offset:18688
  buffer_load_dwordx4 a[48:51], v140, s[20:23], s67 offen offset:2048 sc1
  v_mfma_f32_16x16x32_bf16 v[36:39], v[88:91], a[20:23], v[36:39]
  ds_read_b64_tr_b16 v[82:83], v138 offset:20992
  buffer_load_dwordx4 a[52:55], v151, s[20:23], s67 offen offset:2048 sc1
  v_mfma_f32_16x16x32_bf16 v[40:43], v[92:95], a[16:19], v[40:43]
  ds_read_b64_tr_b16 v[84:85], v138 offset:27648
  v_mfma_f32_16x16x32_bf16 v[44:47], v[92:95], a[20:23], v[44:47]
  ds_read_b64_tr_b16 v[86:87], v138 offset:29952
  s_waitcnt lgkmcnt(4)
  v_mfma_f32_16x16x32_bf16 v[48:51], v[72:75], a[16:19], v[48:51]
  ds_read_b64_tr_b16 v[88:89], v138 offset:27680
  v_mfma_f32_16x16x32_bf16 v[52:55], v[72:75], a[20:23], v[52:55]
  ds_read_b64_tr_b16 v[90:91], v138 offset:29984
  v_mfma_f32_16x16x32_bf16 v[56:59], v[76:79], a[16:19], v[56:59]
  ds_read_b64_tr_b16 v[92:93], v138 offset:27712
  v_mfma_f32_16x16x32_bf16 v[60:63], v[76:79], a[20:23], v[60:63]
  ds_read_b64_tr_b16 v[94:95], v138 offset:30016
  s_waitcnt lgkmcnt(4)
  v_mfma_f32_16x16x32_bf16 v[64:67], v[80:83], a[16:19], v[64:67]
  ds_read_b64_tr_b16 v[72:73], v138 offset:27744
  v_mfma_f32_16x16x32_bf16 v[68:71], v[80:83], a[20:23], v[68:71]
  ds_read_b64_tr_b16 v[74:75], v138 offset:30048
  s_waitcnt vmcnt(15)
  v_mfma_f32_16x16x32_bf16 v[0:3], v[84:87], a[24:27], v[0:3]
  ds_read_b64_tr_b16 v[76:77], v138 offset:27776
  v_mfma_f32_16x16x32_bf16 v[4:7], v[84:87], a[28:31], v[4:7]
  ds_read_b64_tr_b16 v[78:79], v138 offset:30080
  s_waitcnt lgkmcnt(4)
  v_mfma_f32_16x16x32_bf16 v[8:11], v[88:91], a[24:27], v[8:11]
  ds_read_b64_tr_b16 v[80:81], v138 offset:27808
  v_mfma_f32_16x16x32_bf16 v[12:15], v[88:91], a[28:31], v[12:15]
  ds_read_b64_tr_b16 v[82:83], v138 offset:30112
  v_mfma_f32_16x16x32_bf16 v[16:19], v[92:95], a[24:27], v[16:19]
  ds_read_b64_tr_b16 v[84:85], v138 offset:27840
  v_mfma_f32_16x16x32_bf16 v[20:23], v[92:95], a[28:31], v[20:23]
  ds_read_b64_tr_b16 v[86:87], v138 offset:30144
  s_waitcnt lgkmcnt(4)
  v_mfma_f32_16x16x32_bf16 v[24:27], v[72:75], a[24:27], v[24:27]
  ds_read_b64_tr_b16 v[88:89], v138 offset:27872
  v_mfma_f32_16x16x32_bf16 v[28:31], v[72:75], a[28:31], v[28:31]
  ds_read_b64_tr_b16 v[90:91], v138 offset:30176
  v_mfma_f32_16x16x32_bf16 v[32:35], v[76:79], a[24:27], v[32:35]
  ds_read_b64_tr_b16 v[92:93], v138 offset:27904
  buffer_load_dwordx4 a[56:59], v140, s[20:23], s67 offen offset:3072 sc1
  v_mfma_f32_16x16x32_bf16 v[36:39], v[76:79], a[28:31], v[36:39]
  ds_read_b64_tr_b16 v[94:95], v138 offset:30208
  buffer_load_dwordx4 a[60:63], v151, s[20:23], s67 offen offset:3072 sc1
  s_waitcnt lgkmcnt(4)
  v_mfma_f32_16x16x32_bf16 v[40:43], v[80:83], a[24:27], v[40:43]
  ds_read_b64_tr_b16 v[72:73], v138 offset:36864
  v_mfma_f32_16x16x32_bf16 v[44:47], v[80:83], a[28:31], v[44:47]
  ds_read_b64_tr_b16 v[74:75], v138 offset:39168
  v_mfma_f32_16x16x32_bf16 v[48:51], v[84:87], a[24:27], v[48:51]
  ds_read_b64_tr_b16 v[76:77], v138 offset:36896
  v_mfma_f32_16x16x32_bf16 v[52:55], v[84:87], a[28:31], v[52:55]
  ds_read_b64_tr_b16 v[78:79], v138 offset:39200
  s_waitcnt lgkmcnt(4)
  v_mfma_f32_16x16x32_bf16 v[56:59], v[88:91], a[24:27], v[56:59]
  ds_read_b64_tr_b16 v[80:81], v138 offset:36928
  v_mfma_f32_16x16x32_bf16 v[60:63], v[88:91], a[28:31], v[60:63]
  ds_read_b64_tr_b16 v[82:83], v138 offset:39232
  v_mfma_f32_16x16x32_bf16 v[64:67], v[92:95], a[24:27], v[64:67]
  ds_read_b64_tr_b16 v[84:85], v138 offset:36960
  v_mfma_f32_16x16x32_bf16 v[68:71], v[92:95], a[28:31], v[68:71]
  ds_read_b64_tr_b16 v[86:87], v138 offset:39264
  s_waitcnt vmcnt(15) lgkmcnt(4)
  v_mfma_f32_16x16x32_bf16 v[0:3], v[72:75], a[32:35], v[0:3]
  ds_read_b64_tr_b16 v[88:89], v138 offset:36992
  v_mfma_f32_16x16x32_bf16 v[4:7], v[72:75], a[36:39], v[4:7]
  ds_read_b64_tr_b16 v[90:91], v138 offset:39296
  v_mfma_f32_16x16x32_bf16 v[8:11], v[76:79], a[32:35], v[8:11]
  ds_read_b64_tr_b16 v[92:93], v138 offset:37024
  v_mfma_f32_16x16x32_bf16 v[12:15], v[76:79], a[36:39], v[12:15]
  ds_read_b64_tr_b16 v[94:95], v138 offset:39328
  s_waitcnt lgkmcnt(4)
  v_mfma_f32_16x16x32_bf16 v[16:19], v[80:83], a[32:35], v[16:19]
  ds_read_b64_tr_b16 v[72:73], v138 offset:37056
  v_mfma_f32_16x16x32_bf16 v[20:23], v[80:83], a[36:39], v[20:23]
  ds_read_b64_tr_b16 v[74:75], v138 offset:39360
  v_mfma_f32_16x16x32_bf16 v[24:27], v[84:87], a[32:35], v[24:27]
  ds_read_b64_tr_b16 v[76:77], v138 offset:37088
  v_mfma_f32_16x16x32_bf16 v[28:31], v[84:87], a[36:39], v[28:31]
  ds_read_b64_tr_b16 v[78:79], v138 offset:39392
  s_waitcnt lgkmcnt(4)
  v_mfma_f32_16x16x32_bf16 v[32:35], v[88:91], a[32:35], v[32:35]
  ds_read_b64_tr_b16 v[80:81], v138 offset:37120
  s_mov_b32 s67, 8192
  v_mfma_f32_16x16x32_bf16 v[36:39], v[88:91], a[36:39], v[36:39]
  ds_read_b64_tr_b16 v[82:83], v138 offset:39424
  buffer_load_dwordx4 a[64:67], v140, s[20:23], s67 offen offset:0 sc1
  v_mfma_f32_16x16x32_bf16 v[40:43], v[92:95], a[32:35], v[40:43]
  ds_read_b64_tr_b16 v[84:85], v138 offset:46080
  buffer_load_dwordx4 a[68:71], v151, s[20:23], s67 offen offset:0 sc1
  v_mfma_f32_16x16x32_bf16 v[44:47], v[92:95], a[36:39], v[44:47]
  ds_read_b64_tr_b16 v[86:87], v138 offset:48384
  s_waitcnt lgkmcnt(4)
  v_mfma_f32_16x16x32_bf16 v[48:51], v[72:75], a[32:35], v[48:51]
  ds_read_b64_tr_b16 v[88:89], v138 offset:46112
  v_mfma_f32_16x16x32_bf16 v[52:55], v[72:75], a[36:39], v[52:55]
  ds_read_b64_tr_b16 v[90:91], v138 offset:48416
  v_mfma_f32_16x16x32_bf16 v[56:59], v[76:79], a[32:35], v[56:59]
  ds_read_b64_tr_b16 v[92:93], v138 offset:46144
  v_mfma_f32_16x16x32_bf16 v[60:63], v[76:79], a[36:39], v[60:63]
  ds_read_b64_tr_b16 v[94:95], v138 offset:48448
  s_waitcnt lgkmcnt(4)
  v_mfma_f32_16x16x32_bf16 v[64:67], v[80:83], a[32:35], v[64:67]
  ds_read_b64_tr_b16 v[72:73], v138 offset:46176
  v_mfma_f32_16x16x32_bf16 v[68:71], v[80:83], a[36:39], v[68:71]
  ds_read_b64_tr_b16 v[74:75], v138 offset:48480
  s_waitcnt vmcnt(6)
  v_mfma_f32_16x16x32_bf16 v[0:3], v[84:87], a[40:43], v[0:3]
  ds_read_b64_tr_b16 v[76:77], v138 offset:46208
  v_mfma_f32_16x16x32_bf16 v[4:7], v[84:87], a[44:47], v[4:7]
  ds_read_b64_tr_b16 v[78:79], v138 offset:48512
  s_waitcnt lgkmcnt(4)
  v_mfma_f32_16x16x32_bf16 v[8:11], v[88:91], a[40:43], v[8:11]
  ds_read_b64_tr_b16 v[80:81], v138 offset:46240
  v_mfma_f32_16x16x32_bf16 v[12:15], v[88:91], a[44:47], v[12:15]
  ds_read_b64_tr_b16 v[82:83], v138 offset:48544
  v_mfma_f32_16x16x32_bf16 v[16:19], v[92:95], a[40:43], v[16:19]
  ds_read_b64_tr_b16 v[84:85], v138 offset:46272
  v_mfma_f32_16x16x32_bf16 v[20:23], v[92:95], a[44:47], v[20:23]
  ds_read_b64_tr_b16 v[86:87], v138 offset:48576
  s_waitcnt lgkmcnt(4)
  v_mfma_f32_16x16x32_bf16 v[24:27], v[72:75], a[40:43], v[24:27]
  ds_read_b64_tr_b16 v[88:89], v138 offset:46304
  v_mfma_f32_16x16x32_bf16 v[28:31], v[72:75], a[44:47], v[28:31]
  ds_read_b64_tr_b16 v[90:91], v138 offset:48608
  v_mfma_f32_16x16x32_bf16 v[32:35], v[76:79], a[40:43], v[32:35]
  ds_read_b64_tr_b16 v[92:93], v138 offset:46336
  buffer_load_dwordx4 a[72:75], v140, s[20:23], s67 offen offset:1024 sc1
  v_mfma_f32_16x16x32_bf16 v[36:39], v[76:79], a[44:47], v[36:39]
  ds_read_b64_tr_b16 v[94:95], v138 offset:48640
  buffer_load_dwordx4 a[76:79], v151, s[20:23], s67 offen offset:1024 sc1
  s_waitcnt lgkmcnt(4)
  v_mfma_f32_16x16x32_bf16 v[40:43], v[80:83], a[40:43], v[40:43]
  ds_read_b64_tr_b16 v[72:73], v139 offset:0
  v_mfma_f32_16x16x32_bf16 v[44:47], v[80:83], a[44:47], v[44:47]
  ds_read_b64_tr_b16 v[74:75], v139 offset:2304
  v_mfma_f32_16x16x32_bf16 v[48:51], v[84:87], a[40:43], v[48:51]
  ds_read_b64_tr_b16 v[76:77], v139 offset:32
  v_mfma_f32_16x16x32_bf16 v[52:55], v[84:87], a[44:47], v[52:55]
  ds_read_b64_tr_b16 v[78:79], v139 offset:2336
  s_waitcnt lgkmcnt(4)
  v_mfma_f32_16x16x32_bf16 v[56:59], v[88:91], a[40:43], v[56:59]
  ds_read_b64_tr_b16 v[80:81], v139 offset:64
  v_mfma_f32_16x16x32_bf16 v[60:63], v[88:91], a[44:47], v[60:63]
  ds_read_b64_tr_b16 v[82:83], v139 offset:2368
  v_mfma_f32_16x16x32_bf16 v[64:67], v[92:95], a[40:43], v[64:67]
  ds_read_b64_tr_b16 v[84:85], v139 offset:96
  v_mfma_f32_16x16x32_bf16 v[68:71], v[92:95], a[44:47], v[68:71]
  ds_read_b64_tr_b16 v[86:87], v139 offset:2400
  s_waitcnt vmcnt(6) lgkmcnt(4)
  v_mfma_f32_16x16x32_bf16 v[0:3], v[72:75], a[48:51], v[0:3]
  ds_read_b64_tr_b16 v[88:89], v139 offset:128
  v_mfma_f32_16x16x32_bf16 v[4:7], v[72:75], a[52:55], v[4:7]
  ds_read_b64_tr_b16 v[90:91], v139 offset:2432
  v_mfma_f32_16x16x32_bf16 v[8:11], v[76:79], a[48:51], v[8:11]
  ds_read_b64_tr_b16 v[92:93], v139 offset:160
  v_mfma_f32_16x16x32_bf16 v[12:15], v[76:79], a[52:55], v[12:15]
  ds_read_b64_tr_b16 v[94:95], v139 offset:2464
  s_waitcnt lgkmcnt(4)
  v_mfma_f32_16x16x32_bf16 v[16:19], v[80:83], a[48:51], v[16:19]
  ds_read_b64_tr_b16 v[72:73], v139 offset:192
  v_mfma_f32_16x16x32_bf16 v[20:23], v[80:83], a[52:55], v[20:23]
  ds_read_b64_tr_b16 v[74:75], v139 offset:2496
  v_mfma_f32_16x16x32_bf16 v[24:27], v[84:87], a[48:51], v[24:27]
  ds_read_b64_tr_b16 v[76:77], v139 offset:224
  v_mfma_f32_16x16x32_bf16 v[28:31], v[84:87], a[52:55], v[28:31]
  ds_read_b64_tr_b16 v[78:79], v139 offset:2528
  s_waitcnt lgkmcnt(4)
  v_mfma_f32_16x16x32_bf16 v[32:35], v[88:91], a[48:51], v[32:35]
  ds_read_b64_tr_b16 v[80:81], v139 offset:256
  buffer_load_dwordx4 a[80:83], v140, s[20:23], s67 offen offset:2048 sc1
  v_mfma_f32_16x16x32_bf16 v[36:39], v[88:91], a[52:55], v[36:39]
  ds_read_b64_tr_b16 v[82:83], v139 offset:2560
  buffer_load_dwordx4 a[84:87], v151, s[20:23], s67 offen offset:2048 sc1
  v_mfma_f32_16x16x32_bf16 v[40:43], v[92:95], a[48:51], v[40:43]
  ds_read_b64_tr_b16 v[84:85], v139 offset:9216
  v_mfma_f32_16x16x32_bf16 v[44:47], v[92:95], a[52:55], v[44:47]
  ds_read_b64_tr_b16 v[86:87], v139 offset:11520
  s_waitcnt lgkmcnt(4)
  v_mfma_f32_16x16x32_bf16 v[48:51], v[72:75], a[48:51], v[48:51]
  ds_read_b64_tr_b16 v[88:89], v139 offset:9248
  v_mfma_f32_16x16x32_bf16 v[52:55], v[72:75], a[52:55], v[52:55]
  ds_read_b64_tr_b16 v[90:91], v139 offset:11552
  v_mfma_f32_16x16x32_bf16 v[56:59], v[76:79], a[48:51], v[56:59]
  ds_read_b64_tr_b16 v[92:93], v139 offset:9280
  v_mfma_f32_16x16x32_bf16 v[60:63], v[76:79], a[52:55], v[60:63]
  ds_read_b64_tr_b16 v[94:95], v139 offset:11584
  s_waitcnt lgkmcnt(4)
  v_mfma_f32_16x16x32_bf16 v[64:67], v[80:83], a[48:51], v[64:67]
  ds_read_b64_tr_b16 v[72:73], v139 offset:9312
  v_mfma_f32_16x16x32_bf16 v[68:71], v[80:83], a[52:55], v[68:71]
  ds_read_b64_tr_b16 v[74:75], v139 offset:11616
  s_waitcnt vmcnt(6)
  v_mfma_f32_16x16x32_bf16 v[0:3], v[84:87], a[56:59], v[0:3]
  ds_read_b64_tr_b16 v[76:77], v139 offset:9344
  v_mfma_f32_16x16x32_bf16 v[4:7], v[84:87], a[60:63], v[4:7]
  ds_read_b64_tr_b16 v[78:79], v139 offset:11648
  s_waitcnt lgkmcnt(4)
  v_mfma_f32_16x16x32_bf16 v[8:11], v[88:91], a[56:59], v[8:11]
  ds_read_b64_tr_b16 v[80:81], v139 offset:9376
  v_mfma_f32_16x16x32_bf16 v[12:15], v[88:91], a[60:63], v[12:15]
  ds_read_b64_tr_b16 v[82:83], v139 offset:11680
  v_mfma_f32_16x16x32_bf16 v[16:19], v[92:95], a[56:59], v[16:19]
  ds_read_b64_tr_b16 v[84:85], v139 offset:9408
  v_mfma_f32_16x16x32_bf16 v[20:23], v[92:95], a[60:63], v[20:23]
  ds_read_b64_tr_b16 v[86:87], v139 offset:11712
  s_waitcnt lgkmcnt(4)
  v_mfma_f32_16x16x32_bf16 v[24:27], v[72:75], a[56:59], v[24:27]
  ds_read_b64_tr_b16 v[88:89], v139 offset:9440
  v_mfma_f32_16x16x32_bf16 v[28:31], v[72:75], a[60:63], v[28:31]
  ds_read_b64_tr_b16 v[90:91], v139 offset:11744
  s_barrier
  v_mfma_f32_16x16x32_bf16 v[32:35], v[76:79], a[56:59], v[32:35]
  ds_read_b64_tr_b16 v[92:93], v139 offset:9472
  s_add_u32 s65, s60, 589824
  s_add_u32 m0, s61, 0
  v_mfma_f32_16x16x32_bf16 v[36:39], v[76:79], a[60:63], v[36:39]
  ds_read_b64_tr_b16 v[94:95], v139 offset:11776
  buffer_load_dwordx4 v226, s[24:27], s65 offen lds
  s_waitcnt lgkmcnt(4)
  v_mfma_f32_16x16x32_bf16 v[40:43], v[80:83], a[56:59], v[40:43]
  ds_read_b64_tr_b16 v[72:73], v139 offset:18432
  s_add_u32 m0, s61, 1024
  v_mfma_f32_16x16x32_bf16 v[44:47], v[80:83], a[60:63], v[44:47]
  ds_read_b64_tr_b16 v[74:75], v139 offset:20736
  buffer_load_dwordx4 v227, s[24:27], s65 offen lds
  v_mfma_f32_16x16x32_bf16 v[48:51], v[84:87], a[56:59], v[48:51]
  ds_read_b64_tr_b16 v[76:77], v139 offset:18464
  s_add_u32 m0, s61, 2048
  v_mfma_f32_16x16x32_bf16 v[52:55], v[84:87], a[60:63], v[52:55]
  ds_read_b64_tr_b16 v[78:79], v139 offset:20768
  buffer_load_dwordx4 v228, s[24:27], s65 offen lds
  s_waitcnt lgkmcnt(4)
  v_mfma_f32_16x16x32_bf16 v[56:59], v[88:91], a[56:59], v[56:59]
  ds_read_b64_tr_b16 v[80:81], v139 offset:18496
  s_add_u32 m0, s61, 3072
  v_mfma_f32_16x16x32_bf16 v[60:63], v[88:91], a[60:63], v[60:63]
  ds_read_b64_tr_b16 v[82:83], v139 offset:20800
  buffer_load_dwordx4 v229, s[24:27], s65 offen lds
  v_mfma_f32_16x16x32_bf16 v[64:67], v[92:95], a[56:59], v[64:67]
  ds_read_b64_tr_b16 v[84:85], v139 offset:18528
  s_add_u32 m0, s61, 4096
  v_mfma_f32_16x16x32_bf16 v[68:71], v[92:95], a[60:63], v[68:71]
  ds_read_b64_tr_b16 v[86:87], v139 offset:20832
  buffer_load_dwordx4 v230, s[24:27], s65 offen lds
  s_waitcnt vmcnt(9) lgkmcnt(4)
  v_mfma_f32_16x16x32_bf16 v[0:3], v[72:75], a[64:67], v[0:3]
  ds_read_b64_tr_b16 v[88:89], v139 offset:18560
  s_add_u32 m0, s61, 5120
  v_mfma_f32_16x16x32_bf16 v[4:7], v[72:75], a[68:71], v[4:7]
  ds_read_b64_tr_b16 v[90:91], v139 offset:20864
  buffer_load_dwordx4 v231, s[24:27], s65 offen lds
  v_mfma_f32_16x16x32_bf16 v[8:11], v[76:79], a[64:67], v[8:11]
  ds_read_b64_tr_b16 v[92:93], v139 offset:18592
  s_add_u32 m0, s61, 6144
  v_mfma_f32_16x16x32_bf16 v[12:15], v[76:79], a[68:71], v[12:15]
  ds_read_b64_tr_b16 v[94:95], v139 offset:20896
  buffer_load_dwordx4 v232, s[24:27], s65 offen lds
  s_waitcnt lgkmcnt(4)
  v_mfma_f32_16x16x32_bf16 v[16:19], v[80:83], a[64:67], v[16:19]
  ds_read_b64_tr_b16 v[72:73], v139 offset:18624
  s_add_u32 m0, s61, 7168
  v_mfma_f32_16x16x32_bf16 v[20:23], v[80:83], a[68:71], v[20:23]
  ds_read_b64_tr_b16 v[74:75], v139 offset:20928
  buffer_load_dwordx4 v233, s[24:27], s65 offen lds
  v_mfma_f32_16x16x32_bf16 v[24:27], v[84:87], a[64:67], v[24:27]
  ds_read_b64_tr_b16 v[76:77], v139 offset:18656
  s_add_u32 m0, s61, 8192
  v_mfma_f32_16x16x32_bf16 v[28:31], v[84:87], a[68:71], v[28:31]
  ds_read_b64_tr_b16 v[78:79], v139 offset:20960
  buffer_load_dwordx4 v234, s[24:27], s65 offen lds
  s_waitcnt lgkmcnt(4)
  v_mfma_f32_16x16x32_bf16 v[32:35], v[88:91], a[64:67], v[32:35]
  ds_read_b64_tr_b16 v[80:81], v139 offset:18688
  buffer_load_dwordx4 a[88:91], v140, s[20:23], s67 offen offset:3072 sc1
  v_mfma_f32_16x16x32_bf16 v[36:39], v[88:91], a[68:71], v[36:39]
  ds_read_b64_tr_b16 v[82:83], v139 offset:20992
  buffer_load_dwordx4 a[92:95], v151, s[20:23], s67 offen offset:3072 sc1
  v_mfma_f32_16x16x32_bf16 v[40:43], v[92:95], a[64:67], v[40:43]
  ds_read_b64_tr_b16 v[84:85], v139 offset:27648
  s_mov_b32 s67, 12288
  v_mfma_f32_16x16x32_bf16 v[44:47], v[92:95], a[68:71], v[44:47]
  ds_read_b64_tr_b16 v[86:87], v139 offset:29952
  buffer_load_dwordx4 a[96:99], v140, s[20:23], s67 offen offset:0 sc1
  s_waitcnt lgkmcnt(4)
  v_mfma_f32_16x16x32_bf16 v[48:51], v[72:75], a[64:67], v[48:51]
  ds_read_b64_tr_b16 v[88:89], v139 offset:27680
  buffer_load_dwordx4 a[100:103], v151, s[20:23], s67 offen offset:0 sc1
  v_mfma_f32_16x16x32_bf16 v[52:55], v[72:75], a[68:71], v[52:55]
  ds_read_b64_tr_b16 v[90:91], v139 offset:29984
  v_mfma_f32_16x16x32_bf16 v[56:59], v[76:79], a[64:67], v[56:59]
  ds_read_b64_tr_b16 v[92:93], v139 offset:27712
  v_mfma_f32_16x16x32_bf16 v[60:63], v[76:79], a[68:71], v[60:63]
  ds_read_b64_tr_b16 v[94:95], v139 offset:30016
  s_waitcnt lgkmcnt(4)
  v_mfma_f32_16x16x32_bf16 v[64:67], v[80:83], a[64:67], v[64:67]
  ds_read_b64_tr_b16 v[72:73], v139 offset:27744
  v_mfma_f32_16x16x32_bf16 v[68:71], v[80:83], a[68:71], v[68:71]
  ds_read_b64_tr_b16 v[74:75], v139 offset:30048
  s_waitcnt vmcnt(15)
  v_mfma_f32_16x16x32_bf16 v[0:3], v[84:87], a[72:75], v[0:3]
  ds_read_b64_tr_b16 v[76:77], v139 offset:27776
  v_mfma_f32_16x16x32_bf16 v[4:7], v[84:87], a[76:79], v[4:7]
  ds_read_b64_tr_b16 v[78:79], v139 offset:30080
  s_waitcnt lgkmcnt(4)
  v_mfma_f32_16x16x32_bf16 v[8:11], v[88:91], a[72:75], v[8:11]
  ds_read_b64_tr_b16 v[80:81], v139 offset:27808
  v_mfma_f32_16x16x32_bf16 v[12:15], v[88:91], a[76:79], v[12:15]
  ds_read_b64_tr_b16 v[82:83], v139 offset:30112
  v_mfma_f32_16x16x32_bf16 v[16:19], v[92:95], a[72:75], v[16:19]
  ds_read_b64_tr_b16 v[84:85], v139 offset:27840
  v_mfma_f32_16x16x32_bf16 v[20:23], v[92:95], a[76:79], v[20:23]
  ds_read_b64_tr_b16 v[86:87], v139 offset:30144
  s_waitcnt lgkmcnt(4)
  v_mfma_f32_16x16x32_bf16 v[24:27], v[72:75], a[72:75], v[24:27]
  ds_read_b64_tr_b16 v[88:89], v139 offset:27872
  v_mfma_f32_16x16x32_bf16 v[28:31], v[72:75], a[76:79], v[28:31]
  ds_read_b64_tr_b16 v[90:91], v139 offset:30176
  v_mfma_f32_16x16x32_bf16 v[32:35], v[76:79], a[72:75], v[32:35]
  ds_read_b64_tr_b16 v[92:93], v139 offset:27904
  buffer_load_dwordx4 a[104:107], v140, s[20:23], s67 offen offset:1024 sc1
  v_mfma_f32_16x16x32_bf16 v[36:39], v[76:79], a[76:79], v[36:39]
  ds_read_b64_tr_b16 v[94:95], v139 offset:30208
  buffer_load_dwordx4 a[108:111], v151, s[20:23], s67 offen offset:1024 sc1
  s_waitcnt lgkmcnt(4)
  v_mfma_f32_16x16x32_bf16 v[40:43], v[80:83], a[72:75], v[40:43]
  ds_read_b64_tr_b16 v[72:73], v137 offset:0
  v_mfma_f32_16x16x32_bf16 v[44:47], v[80:83], a[76:79], v[44:47]
  ds_read_b64_tr_b16 v[74:75], v137 offset:2304
  v_mfma_f32_16x16x32_bf16 v[48:51], v[84:87], a[72:75], v[48:51]
  ds_read_b64_tr_b16 v[76:77], v137 offset:32
  v_mfma_f32_16x16x32_bf16 v[52:55], v[84:87], a[76:79], v[52:55]
  ds_read_b64_tr_b16 v[78:79], v137 offset:2336
  s_waitcnt lgkmcnt(4)
  v_mfma_f32_16x16x32_bf16 v[56:59], v[88:91], a[72:75], v[56:59]
  ds_read_b64_tr_b16 v[80:81], v137 offset:64
  v_mfma_f32_16x16x32_bf16 v[60:63], v[88:91], a[76:79], v[60:63]
  ds_read_b64_tr_b16 v[82:83], v137 offset:2368
  v_mfma_f32_16x16x32_bf16 v[64:67], v[92:95], a[72:75], v[64:67]
  ds_read_b64_tr_b16 v[84:85], v137 offset:96
  v_mfma_f32_16x16x32_bf16 v[68:71], v[92:95], a[76:79], v[68:71]
  ds_read_b64_tr_b16 v[86:87], v137 offset:2400
  s_waitcnt vmcnt(15) lgkmcnt(4)
  v_mfma_f32_16x16x32_bf16 v[0:3], v[72:75], a[80:83], v[0:3]
  ds_read_b64_tr_b16 v[88:89], v137 offset:128
  v_mfma_f32_16x16x32_bf16 v[4:7], v[72:75], a[84:87], v[4:7]
  ds_read_b64_tr_b16 v[90:91], v137 offset:2432
  v_mfma_f32_16x16x32_bf16 v[8:11], v[76:79], a[80:83], v[8:11]
  ds_read_b64_tr_b16 v[92:93], v137 offset:160
  v_mfma_f32_16x16x32_bf16 v[12:15], v[76:79], a[84:87], v[12:15]
  ds_read_b64_tr_b16 v[94:95], v137 offset:2464
  s_waitcnt lgkmcnt(4)
  v_mfma_f32_16x16x32_bf16 v[16:19], v[80:83], a[80:83], v[16:19]
  ds_read_b64_tr_b16 v[72:73], v137 offset:192
  v_mfma_f32_16x16x32_bf16 v[20:23], v[80:83], a[84:87], v[20:23]
  ds_read_b64_tr_b16 v[74:75], v137 offset:2496
  v_mfma_f32_16x16x32_bf16 v[24:27], v[84:87], a[80:83], v[24:27]
  ds_read_b64_tr_b16 v[76:77], v137 offset:224
  v_mfma_f32_16x16x32_bf16 v[28:31], v[84:87], a[84:87], v[28:31]
  ds_read_b64_tr_b16 v[78:79], v137 offset:2528
  s_waitcnt lgkmcnt(4)
  v_mfma_f32_16x16x32_bf16 v[32:35], v[88:91], a[80:83], v[32:35]
  ds_read_b64_tr_b16 v[80:81], v137 offset:256
  buffer_load_dwordx4 a[112:115], v140, s[20:23], s67 offen offset:2048 sc1
  v_mfma_f32_16x16x32_bf16 v[36:39], v[88:91], a[84:87], v[36:39]
  ds_read_b64_tr_b16 v[82:83], v137 offset:2560
  buffer_load_dwordx4 a[116:119], v151, s[20:23], s67 offen offset:2048 sc1
  v_mfma_f32_16x16x32_bf16 v[40:43], v[92:95], a[80:83], v[40:43]
  ds_read_b64_tr_b16 v[84:85], v137 offset:9216
  v_mfma_f32_16x16x32_bf16 v[44:47], v[92:95], a[84:87], v[44:47]
  ds_read_b64_tr_b16 v[86:87], v137 offset:11520
  s_waitcnt lgkmcnt(4)
  v_mfma_f32_16x16x32_bf16 v[48:51], v[72:75], a[80:83], v[48:51]
  ds_read_b64_tr_b16 v[88:89], v137 offset:9248
  v_mfma_f32_16x16x32_bf16 v[52:55], v[72:75], a[84:87], v[52:55]
  ds_read_b64_tr_b16 v[90:91], v137 offset:11552
  v_mfma_f32_16x16x32_bf16 v[56:59], v[76:79], a[80:83], v[56:59]
  ds_read_b64_tr_b16 v[92:93], v137 offset:9280
  v_mfma_f32_16x16x32_bf16 v[60:63], v[76:79], a[84:87], v[60:63]
  ds_read_b64_tr_b16 v[94:95], v137 offset:11584
  s_waitcnt lgkmcnt(4)
  v_mfma_f32_16x16x32_bf16 v[64:67], v[80:83], a[80:83], v[64:67]
  ds_read_b64_tr_b16 v[72:73], v137 offset:9312
  v_mfma_f32_16x16x32_bf16 v[68:71], v[80:83], a[84:87], v[68:71]
  ds_read_b64_tr_b16 v[74:75], v137 offset:11616
  s_waitcnt vmcnt(6)
  v_mfma_f32_16x16x32_bf16 v[0:3], v[84:87], a[88:91], v[0:3]
  ds_read_b64_tr_b16 v[76:77], v137 offset:9344
  v_mfma_f32_16x16x32_bf16 v[4:7], v[84:87], a[92:95], v[4:7]
  ds_read_b64_tr_b16 v[78:79], v137 offset:11648
  s_waitcnt lgkmcnt(4)
  v_mfma_f32_16x16x32_bf16 v[8:11], v[88:91], a[88:91], v[8:11]
  ds_read_b64_tr_b16 v[80:81], v137 offset:9376
  v_mfma_f32_16x16x32_bf16 v[12:15], v[88:91], a[92:95], v[12:15]
  ds_read_b64_tr_b16 v[82:83], v137 offset:11680
  v_mfma_f32_16x16x32_bf16 v[16:19], v[92:95], a[88:91], v[16:19]
  ds_read_b64_tr_b16 v[84:85], v137 offset:9408
  v_mfma_f32_16x16x32_bf16 v[20:23], v[92:95], a[92:95], v[20:23]
  ds_read_b64_tr_b16 v[86:87], v137 offset:11712
  s_waitcnt lgkmcnt(4)
  v_mfma_f32_16x16x32_bf16 v[24:27], v[72:75], a[88:91], v[24:27]
  ds_read_b64_tr_b16 v[88:89], v137 offset:9440
  v_mfma_f32_16x16x32_bf16 v[28:31], v[72:75], a[92:95], v[28:31]
  ds_read_b64_tr_b16 v[90:91], v137 offset:11744
  s_barrier
  v_mfma_f32_16x16x32_bf16 v[32:35], v[76:79], a[88:91], v[32:35]
  ds_read_b64_tr_b16 v[92:93], v137 offset:9472
  s_add_u32 s65, s60, 737280
  s_add_u32 m0, s62, 0
  v_mfma_f32_16x16x32_bf16 v[36:39], v[76:79], a[92:95], v[36:39]
  ds_read_b64_tr_b16 v[94:95], v137 offset:11776
  buffer_load_dwordx4 v226, s[24:27], s65 offen lds
  s_waitcnt lgkmcnt(4)
  v_mfma_f32_16x16x32_bf16 v[40:43], v[80:83], a[88:91], v[40:43]
  ds_read_b64_tr_b16 v[72:73], v137 offset:18432
  s_add_u32 m0, s62, 1024
  v_mfma_f32_16x16x32_bf16 v[44:47], v[80:83], a[92:95], v[44:47]
  ds_read_b64_tr_b16 v[74:75], v137 offset:20736
  buffer_load_dwordx4 v227, s[24:27], s65 offen lds
  v_mfma_f32_16x16x32_bf16 v[48:51], v[84:87], a[88:91], v[48:51]
  ds_read_b64_tr_b16 v[76:77], v137 offset:18464
  s_add_u32 m0, s62, 2048
  v_mfma_f32_16x16x32_bf16 v[52:55], v[84:87], a[92:95], v[52:55]
  ds_read_b64_tr_b16 v[78:79], v137 offset:20768
  buffer_load_dwordx4 v228, s[24:27], s65 offen lds
  s_waitcnt lgkmcnt(4)
  v_mfma_f32_16x16x32_bf16 v[56:59], v[88:91], a[88:91], v[56:59]
  ds_read_b64_tr_b16 v[80:81], v137 offset:18496
  s_add_u32 m0, s62, 3072
  v_mfma_f32_16x16x32_bf16 v[60:63], v[88:91], a[92:95], v[60:63]
  ds_read_b64_tr_b16 v[82:83], v137 offset:20800
  buffer_load_dwordx4 v229, s[24:27], s65 offen lds
  v_mfma_f32_16x16x32_bf16 v[64:67], v[92:95], a[88:91], v[64:67]
  ds_read_b64_tr_b16 v[84:85], v137 offset:18528
  s_add_u32 m0, s62, 4096
  v_mfma_f32_16x16x32_bf16 v[68:71], v[92:95], a[92:95], v[68:71]
  ds_read_b64_tr_b16 v[86:87], v137 offset:20832
  buffer_load_dwordx4 v230, s[24:27], s65 offen lds
  s_waitcnt vmcnt(9) lgkmcnt(4)
  v_mfma_f32_16x16x32_bf16 v[0:3], v[72:75], a[96:99], v[0:3]
  ds_read_b64_tr_b16 v[88:89], v137 offset:18560
  s_add_u32 m0, s62, 5120
  v_mfma_f32_16x16x32_bf16 v[4:7], v[72:75], a[100:103], v[4:7]
  ds_read_b64_tr_b16 v[90:91], v137 offset:20864
  buffer_load_dwordx4 v231, s[24:27], s65 offen lds
  v_mfma_f32_16x16x32_bf16 v[8:11], v[76:79], a[96:99], v[8:11]
  ds_read_b64_tr_b16 v[92:93], v137 offset:18592
  s_add_u32 m0, s62, 6144
  v_mfma_f32_16x16x32_bf16 v[12:15], v[76:79], a[100:103], v[12:15]
  ds_read_b64_tr_b16 v[94:95], v137 offset:20896
  buffer_load_dwordx4 v232, s[24:27], s65 offen lds
  s_waitcnt lgkmcnt(4)
  v_mfma_f32_16x16x32_bf16 v[16:19], v[80:83], a[96:99], v[16:19]
  ds_read_b64_tr_b16 v[72:73], v137 offset:18624
  s_add_u32 m0, s62, 7168
  v_mfma_f32_16x16x32_bf16 v[20:23], v[80:83], a[100:103], v[20:23]
  ds_read_b64_tr_b16 v[74:75], v137 offset:20928
  buffer_load_dwordx4 v233, s[24:27], s65 offen lds
  v_mfma_f32_16x16x32_bf16 v[24:27], v[84:87], a[96:99], v[24:27]
  ds_read_b64_tr_b16 v[76:77], v137 offset:18656
  s_add_u32 m0, s62, 8192
  v_mfma_f32_16x16x32_bf16 v[28:31], v[84:87], a[100:103], v[28:31]
  ds_read_b64_tr_b16 v[78:79], v137 offset:20960
  buffer_load_dwordx4 v234, s[24:27], s65 offen lds
  s_waitcnt lgkmcnt(4)
  v_mfma_f32_16x16x32_bf16 v[32:35], v[88:91], a[96:99], v[32:35]
  ds_read_b64_tr_b16 v[80:81], v137 offset:18688
  buffer_load_dwordx4 a[120:123], v140, s[20:23], s67 offen offset:3072 sc1
  v_mfma_f32_16x16x32_bf16 v[36:39], v[88:91], a[100:103], v[36:39]
  ds_read_b64_tr_b16 v[82:83], v137 offset:20992
  buffer_load_dwordx4 a[124:127], v151, s[20:23], s67 offen offset:3072 sc1
  v_mfma_f32_16x16x32_bf16 v[40:43], v[92:95], a[96:99], v[40:43]
  ds_read_b64_tr_b16 v[84:85], v137 offset:27648
  s_mov_b32 s67, 16384
  v_mfma_f32_16x16x32_bf16 v[44:47], v[92:95], a[100:103], v[44:47]
  ds_read_b64_tr_b16 v[86:87], v137 offset:29952
  buffer_load_dwordx4 a[128:131], v140, s[20:23], s67 offen offset:0 sc1
  s_waitcnt lgkmcnt(4)
  v_mfma_f32_16x16x32_bf16 v[48:51], v[72:75], a[96:99], v[48:51]
  ds_read_b64_tr_b16 v[88:89], v137 offset:27680
  buffer_load_dwordx4 a[132:135], v151, s[20:23], s67 offen offset:0 sc1
  v_mfma_f32_16x16x32_bf16 v[52:55], v[72:75], a[100:103], v[52:55]
  ds_read_b64_tr_b16 v[90:91], v137 offset:29984
  v_mfma_f32_16x16x32_bf16 v[56:59], v[76:79], a[96:99], v[56:59]
  ds_read_b64_tr_b16 v[92:93], v137 offset:27712
  v_mfma_f32_16x16x32_bf16 v[60:63], v[76:79], a[100:103], v[60:63]
  ds_read_b64_tr_b16 v[94:95], v137 offset:30016
  s_waitcnt lgkmcnt(4)
  v_mfma_f32_16x16x32_bf16 v[64:67], v[80:83], a[96:99], v[64:67]
  ds_read_b64_tr_b16 v[72:73], v137 offset:27744
  v_mfma_f32_16x16x32_bf16 v[68:71], v[80:83], a[100:103], v[68:71]
  ds_read_b64_tr_b16 v[74:75], v137 offset:30048
  s_waitcnt vmcnt(15)
  v_mfma_f32_16x16x32_bf16 v[0:3], v[84:87], a[104:107], v[0:3]
  ds_read_b64_tr_b16 v[76:77], v137 offset:27776
  v_mfma_f32_16x16x32_bf16 v[4:7], v[84:87], a[108:111], v[4:7]
  ds_read_b64_tr_b16 v[78:79], v137 offset:30080
  s_waitcnt lgkmcnt(4)
  v_mfma_f32_16x16x32_bf16 v[8:11], v[88:91], a[104:107], v[8:11]
  ds_read_b64_tr_b16 v[80:81], v137 offset:27808
  v_mfma_f32_16x16x32_bf16 v[12:15], v[88:91], a[108:111], v[12:15]
  ds_read_b64_tr_b16 v[82:83], v137 offset:30112
  v_mfma_f32_16x16x32_bf16 v[16:19], v[92:95], a[104:107], v[16:19]
  ds_read_b64_tr_b16 v[84:85], v137 offset:27840
  v_mfma_f32_16x16x32_bf16 v[20:23], v[92:95], a[108:111], v[20:23]
  ds_read_b64_tr_b16 v[86:87], v137 offset:30144
  s_waitcnt lgkmcnt(4)
  v_mfma_f32_16x16x32_bf16 v[24:27], v[72:75], a[104:107], v[24:27]
  ds_read_b64_tr_b16 v[88:89], v137 offset:27872
  v_mfma_f32_16x16x32_bf16 v[28:31], v[72:75], a[108:111], v[28:31]
  ds_read_b64_tr_b16 v[90:91], v137 offset:30176
  v_mfma_f32_16x16x32_bf16 v[32:35], v[76:79], a[104:107], v[32:35]
  ds_read_b64_tr_b16 v[92:93], v137 offset:27904
  buffer_load_dwordx4 a[136:139], v140, s[20:23], s67 offen offset:1024 sc1
  v_mfma_f32_16x16x32_bf16 v[36:39], v[76:79], a[108:111], v[36:39]
  ds_read_b64_tr_b16 v[94:95], v137 offset:30208
  buffer_load_dwordx4 a[140:143], v151, s[20:23], s67 offen offset:1024 sc1
  s_waitcnt lgkmcnt(4)
  v_mfma_f32_16x16x32_bf16 v[40:43], v[80:83], a[104:107], v[40:43]
  ds_read_b64_tr_b16 v[72:73], v137 offset:36864
  v_mfma_f32_16x16x32_bf16 v[44:47], v[80:83], a[108:111], v[44:47]
  ds_read_b64_tr_b16 v[74:75], v137 offset:39168
  v_mfma_f32_16x16x32_bf16 v[48:51], v[84:87], a[104:107], v[48:51]
  ds_read_b64_tr_b16 v[76:77], v137 offset:36896
  v_mfma_f32_16x16x32_bf16 v[52:55], v[84:87], a[108:111], v[52:55]
  ds_read_b64_tr_b16 v[78:79], v137 offset:39200
  s_waitcnt lgkmcnt(4)
  v_mfma_f32_16x16x32_bf16 v[56:59], v[88:91], a[104:107], v[56:59]
  ds_read_b64_tr_b16 v[80:81], v137 offset:36928
  v_mfma_f32_16x16x32_bf16 v[60:63], v[88:91], a[108:111], v[60:63]
  ds_read_b64_tr_b16 v[82:83], v137 offset:39232
  v_mfma_f32_16x16x32_bf16 v[64:67], v[92:95], a[104:107], v[64:67]
  ds_read_b64_tr_b16 v[84:85], v137 offset:36960
  v_mfma_f32_16x16x32_bf16 v[68:71], v[92:95], a[108:111], v[68:71]
  ds_read_b64_tr_b16 v[86:87], v137 offset:39264
  s_waitcnt vmcnt(15) lgkmcnt(4)
  v_mfma_f32_16x16x32_bf16 v[0:3], v[72:75], a[112:115], v[0:3]
  ds_read_b64_tr_b16 v[88:89], v137 offset:36992
  v_mfma_f32_16x16x32_bf16 v[4:7], v[72:75], a[116:119], v[4:7]
  ds_read_b64_tr_b16 v[90:91], v137 offset:39296
  v_mfma_f32_16x16x32_bf16 v[8:11], v[76:79], a[112:115], v[8:11]
  ds_read_b64_tr_b16 v[92:93], v137 offset:37024
  v_mfma_f32_16x16x32_bf16 v[12:15], v[76:79], a[116:119], v[12:15]
  ds_read_b64_tr_b16 v[94:95], v137 offset:39328
  s_waitcnt lgkmcnt(4)
  v_mfma_f32_16x16x32_bf16 v[16:19], v[80:83], a[112:115], v[16:19]
  ds_read_b64_tr_b16 v[72:73], v137 offset:37056
  v_mfma_f32_16x16x32_bf16 v[20:23], v[80:83], a[116:119], v[20:23]
  ds_read_b64_tr_b16 v[74:75], v137 offset:39360
  v_mfma_f32_16x16x32_bf16 v[24:27], v[84:87], a[112:115], v[24:27]
  ds_read_b64_tr_b16 v[76:77], v137 offset:37088
  v_mfma_f32_16x16x32_bf16 v[28:31], v[84:87], a[116:119], v[28:31]
  ds_read_b64_tr_b16 v[78:79], v137 offset:39392
  s_waitcnt lgkmcnt(4)
  v_mfma_f32_16x16x32_bf16 v[32:35], v[88:91], a[112:115], v[32:35]
  ds_read_b64_tr_b16 v[80:81], v137 offset:37120
  buffer_load_dwordx4 a[144:147], v140, s[20:23], s67 offen offset:2048 sc1
  v_mfma_f32_16x16x32_bf16 v[36:39], v[88:91], a[116:119], v[36:39]
  ds_read_b64_tr_b16 v[82:83], v137 offset:39424
  buffer_load_dwordx4 a[148:151], v151, s[20:23], s67 offen offset:2048 sc1
  v_mfma_f32_16x16x32_bf16 v[40:43], v[92:95], a[112:115], v[40:43]
  ds_read_b64_tr_b16 v[84:85], v137 offset:46080
  v_mfma_f32_16x16x32_bf16 v[44:47], v[92:95], a[116:119], v[44:47]
  ds_read_b64_tr_b16 v[86:87], v137 offset:48384
  s_waitcnt lgkmcnt(4)
  v_mfma_f32_16x16x32_bf16 v[48:51], v[72:75], a[112:115], v[48:51]
  ds_read_b64_tr_b16 v[88:89], v137 offset:46112
  v_mfma_f32_16x16x32_bf16 v[52:55], v[72:75], a[116:119], v[52:55]
  ds_read_b64_tr_b16 v[90:91], v137 offset:48416
  v_mfma_f32_16x16x32_bf16 v[56:59], v[76:79], a[112:115], v[56:59]
  ds_read_b64_tr_b16 v[92:93], v137 offset:46144
  v_mfma_f32_16x16x32_bf16 v[60:63], v[76:79], a[116:119], v[60:63]
  ds_read_b64_tr_b16 v[94:95], v137 offset:48448
  s_waitcnt lgkmcnt(4)
  v_mfma_f32_16x16x32_bf16 v[64:67], v[80:83], a[112:115], v[64:67]
  ds_read_b64_tr_b16 v[72:73], v137 offset:46176
  v_mfma_f32_16x16x32_bf16 v[68:71], v[80:83], a[116:119], v[68:71]
  ds_read_b64_tr_b16 v[74:75], v137 offset:48480
  s_waitcnt vmcnt(6)
  v_mfma_f32_16x16x32_bf16 v[0:3], v[84:87], a[120:123], v[0:3]
  ds_read_b64_tr_b16 v[76:77], v137 offset:46208
  v_mfma_f32_16x16x32_bf16 v[4:7], v[84:87], a[124:127], v[4:7]
  ds_read_b64_tr_b16 v[78:79], v137 offset:48512
  s_waitcnt lgkmcnt(4)
  v_mfma_f32_16x16x32_bf16 v[8:11], v[88:91], a[120:123], v[8:11]
  ds_read_b64_tr_b16 v[80:81], v137 offset:46240
  v_mfma_f32_16x16x32_bf16 v[12:15], v[88:91], a[124:127], v[12:15]
  ds_read_b64_tr_b16 v[82:83], v137 offset:48544
  v_mfma_f32_16x16x32_bf16 v[16:19], v[92:95], a[120:123], v[16:19]
  ds_read_b64_tr_b16 v[84:85], v137 offset:46272
  v_mfma_f32_16x16x32_bf16 v[20:23], v[92:95], a[124:127], v[20:23]
  ds_read_b64_tr_b16 v[86:87], v137 offset:48576
  s_waitcnt lgkmcnt(4)
  v_mfma_f32_16x16x32_bf16 v[24:27], v[72:75], a[120:123], v[24:27]
  ds_read_b64_tr_b16 v[88:89], v137 offset:46304
  v_mfma_f32_16x16x32_bf16 v[28:31], v[72:75], a[124:127], v[28:31]
  ds_read_b64_tr_b16 v[90:91], v137 offset:48608
  s_barrier
  v_mfma_f32_16x16x32_bf16 v[32:35], v[76:79], a[120:123], v[32:35]
  ds_read_b64_tr_b16 v[92:93], v137 offset:46336
  s_add_u32 s65, s60, 884736
  s_add_u32 m0, s63, 0
  v_mfma_f32_16x16x32_bf16 v[36:39], v[76:79], a[124:127], v[36:39]
  ds_read_b64_tr_b16 v[94:95], v137 offset:48640
  buffer_load_dwordx4 v226, s[24:27], s65 offen lds
  s_waitcnt lgkmcnt(4)
  v_mfma_f32_16x16x32_bf16 v[40:43], v[80:83], a[120:123], v[40:43]
  ds_read_b64_tr_b16 v[72:73], v138 offset:0
  s_add_u32 m0, s63, 1024
  v_mfma_f32_16x16x32_bf16 v[44:47], v[80:83], a[124:127], v[44:47]
  ds_read_b64_tr_b16 v[74:75], v138 offset:2304
  buffer_load_dwordx4 v227, s[24:27], s65 offen lds
  v_mfma_f32_16x16x32_bf16 v[48:51], v[84:87], a[120:123], v[48:51]
  ds_read_b64_tr_b16 v[76:77], v138 offset:32
  s_add_u32 m0, s63, 2048
  v_mfma_f32_16x16x32_bf16 v[52:55], v[84:87], a[124:127], v[52:55]
  ds_read_b64_tr_b16 v[78:79], v138 offset:2336
  buffer_load_dwordx4 v228, s[24:27], s65 offen lds
  s_waitcnt lgkmcnt(4)
  v_mfma_f32_16x16x32_bf16 v[56:59], v[88:91], a[120:123], v[56:59]
  ds_read_b64_tr_b16 v[80:81], v138 offset:64
  s_add_u32 m0, s63, 3072
  v_mfma_f32_16x16x32_bf16 v[60:63], v[88:91], a[124:127], v[60:63]
  ds_read_b64_tr_b16 v[82:83], v138 offset:2368
  buffer_load_dwordx4 v229, s[24:27], s65 offen lds
  v_mfma_f32_16x16x32_bf16 v[64:67], v[92:95], a[120:123], v[64:67]
  ds_read_b64_tr_b16 v[84:85], v138 offset:96
  s_add_u32 m0, s63, 4096
  v_mfma_f32_16x16x32_bf16 v[68:71], v[92:95], a[124:127], v[68:71]
  ds_read_b64_tr_b16 v[86:87], v138 offset:2400
  buffer_load_dwordx4 v230, s[24:27], s65 offen lds
  s_waitcnt vmcnt(9) lgkmcnt(4)
  v_mfma_f32_16x16x32_bf16 v[0:3], v[72:75], a[128:131], v[0:3]
  ds_read_b64_tr_b16 v[88:89], v138 offset:128
  s_add_u32 m0, s63, 5120
  v_mfma_f32_16x16x32_bf16 v[4:7], v[72:75], a[132:135], v[4:7]
  ds_read_b64_tr_b16 v[90:91], v138 offset:2432
  buffer_load_dwordx4 v231, s[24:27], s65 offen lds
  v_mfma_f32_16x16x32_bf16 v[8:11], v[76:79], a[128:131], v[8:11]
  ds_read_b64_tr_b16 v[92:93], v138 offset:160
  s_add_u32 m0, s63, 6144
  v_mfma_f32_16x16x32_bf16 v[12:15], v[76:79], a[132:135], v[12:15]
  ds_read_b64_tr_b16 v[94:95], v138 offset:2464
  buffer_load_dwordx4 v232, s[24:27], s65 offen lds
  s_waitcnt lgkmcnt(4)
  v_mfma_f32_16x16x32_bf16 v[16:19], v[80:83], a[128:131], v[16:19]
  ds_read_b64_tr_b16 v[72:73], v138 offset:192
  s_add_u32 m0, s63, 7168
  v_mfma_f32_16x16x32_bf16 v[20:23], v[80:83], a[132:135], v[20:23]
  ds_read_b64_tr_b16 v[74:75], v138 offset:2496
  buffer_load_dwordx4 v233, s[24:27], s65 offen lds
  v_mfma_f32_16x16x32_bf16 v[24:27], v[84:87], a[128:131], v[24:27]
  ds_read_b64_tr_b16 v[76:77], v138 offset:224
  s_add_u32 m0, s63, 8192
  v_mfma_f32_16x16x32_bf16 v[28:31], v[84:87], a[132:135], v[28:31]
  ds_read_b64_tr_b16 v[78:79], v138 offset:2528
  buffer_load_dwordx4 v234, s[24:27], s65 offen lds
  s_waitcnt lgkmcnt(4)
  v_mfma_f32_16x16x32_bf16 v[32:35], v[88:91], a[128:131], v[32:35]
  ds_read_b64_tr_b16 v[80:81], v138 offset:256
  buffer_load_dwordx4 a[152:155], v140, s[20:23], s67 offen offset:3072 sc1
  v_mfma_f32_16x16x32_bf16 v[36:39], v[88:91], a[132:135], v[36:39]
  ds_read_b64_tr_b16 v[82:83], v138 offset:2560
  buffer_load_dwordx4 a[156:159], v151, s[20:23], s67 offen offset:3072 sc1
  v_mfma_f32_16x16x32_bf16 v[40:43], v[92:95], a[128:131], v[40:43]
  ds_read_b64_tr_b16 v[84:85], v138 offset:9216
  s_mov_b32 s67, 20480
  v_mfma_f32_16x16x32_bf16 v[44:47], v[92:95], a[132:135], v[44:47]
  ds_read_b64_tr_b16 v[86:87], v138 offset:11520
  buffer_load_dwordx4 a[160:163], v140, s[20:23], s67 offen offset:0 sc1
  s_waitcnt lgkmcnt(4)
  v_mfma_f32_16x16x32_bf16 v[48:51], v[72:75], a[128:131], v[48:51]
  ds_read_b64_tr_b16 v[88:89], v138 offset:9248
  buffer_load_dwordx4 a[164:167], v151, s[20:23], s67 offen offset:0 sc1
  v_mfma_f32_16x16x32_bf16 v[52:55], v[72:75], a[132:135], v[52:55]
  ds_read_b64_tr_b16 v[90:91], v138 offset:11552
  v_mfma_f32_16x16x32_bf16 v[56:59], v[76:79], a[128:131], v[56:59]
  ds_read_b64_tr_b16 v[92:93], v138 offset:9280
  v_mfma_f32_16x16x32_bf16 v[60:63], v[76:79], a[132:135], v[60:63]
  ds_read_b64_tr_b16 v[94:95], v138 offset:11584
  s_waitcnt lgkmcnt(4)
  v_mfma_f32_16x16x32_bf16 v[64:67], v[80:83], a[128:131], v[64:67]
  ds_read_b64_tr_b16 v[72:73], v138 offset:9312
  v_mfma_f32_16x16x32_bf16 v[68:71], v[80:83], a[132:135], v[68:71]
  ds_read_b64_tr_b16 v[74:75], v138 offset:11616
  s_waitcnt vmcnt(15)
  v_mfma_f32_16x16x32_bf16 v[0:3], v[84:87], a[136:139], v[0:3]
  ds_read_b64_tr_b16 v[76:77], v138 offset:9344
  v_mfma_f32_16x16x32_bf16 v[4:7], v[84:87], a[140:143], v[4:7]
  ds_read_b64_tr_b16 v[78:79], v138 offset:11648
  s_waitcnt lgkmcnt(4)
  v_mfma_f32_16x16x32_bf16 v[8:11], v[88:91], a[136:139], v[8:11]
  ds_read_b64_tr_b16 v[80:81], v138 offset:9376
  v_mfma_f32_16x16x32_bf16 v[12:15], v[88:91], a[140:143], v[12:15]
  ds_read_b64_tr_b16 v[82:83], v138 offset:11680
  v_mfma_f32_16x16x32_bf16 v[16:19], v[92:95], a[136:139], v[16:19]
  ds_read_b64_tr_b16 v[84:85], v138 offset:9408
  v_mfma_f32_16x16x32_bf16 v[20:23], v[92:95], a[140:143], v[20:23]
  ds_read_b64_tr_b16 v[86:87], v138 offset:11712
  s_waitcnt lgkmcnt(4)
  v_mfma_f32_16x16x32_bf16 v[24:27], v[72:75], a[136:139], v[24:27]
  ds_read_b64_tr_b16 v[88:89], v138 offset:9440
  v_mfma_f32_16x16x32_bf16 v[28:31], v[72:75], a[140:143], v[28:31]
  ds_read_b64_tr_b16 v[90:91], v138 offset:11744
  v_mfma_f32_16x16x32_bf16 v[32:35], v[76:79], a[136:139], v[32:35]
  ds_read_b64_tr_b16 v[92:93], v138 offset:9472
  buffer_load_dwordx4 a[168:171], v140, s[20:23], s67 offen offset:1024 sc1
  v_mfma_f32_16x16x32_bf16 v[36:39], v[76:79], a[140:143], v[36:39]
  ds_read_b64_tr_b16 v[94:95], v138 offset:11776
  buffer_load_dwordx4 a[172:175], v151, s[20:23], s67 offen offset:1024 sc1
  s_waitcnt lgkmcnt(4)
  v_mfma_f32_16x16x32_bf16 v[40:43], v[80:83], a[136:139], v[40:43]
  ds_read_b64_tr_b16 v[72:73], v138 offset:18432
  v_mfma_f32_16x16x32_bf16 v[44:47], v[80:83], a[140:143], v[44:47]
  ds_read_b64_tr_b16 v[74:75], v138 offset:20736
  v_mfma_f32_16x16x32_bf16 v[48:51], v[84:87], a[136:139], v[48:51]
  ds_read_b64_tr_b16 v[76:77], v138 offset:18464
  v_mfma_f32_16x16x32_bf16 v[52:55], v[84:87], a[140:143], v[52:55]
  ds_read_b64_tr_b16 v[78:79], v138 offset:20768
  s_waitcnt lgkmcnt(4)
  v_mfma_f32_16x16x32_bf16 v[56:59], v[88:91], a[136:139], v[56:59]
  ds_read_b64_tr_b16 v[80:81], v138 offset:18496
  v_mfma_f32_16x16x32_bf16 v[60:63], v[88:91], a[140:143], v[60:63]
  ds_read_b64_tr_b16 v[82:83], v138 offset:20800
  v_mfma_f32_16x16x32_bf16 v[64:67], v[92:95], a[136:139], v[64:67]
  ds_read_b64_tr_b16 v[84:85], v138 offset:18528
  v_mfma_f32_16x16x32_bf16 v[68:71], v[92:95], a[140:143], v[68:71]
  ds_read_b64_tr_b16 v[86:87], v138 offset:20832
  s_waitcnt vmcnt(15) lgkmcnt(4)
  v_mfma_f32_16x16x32_bf16 v[0:3], v[72:75], a[144:147], v[0:3]
  ds_read_b64_tr_b16 v[88:89], v138 offset:18560
  v_mfma_f32_16x16x32_bf16 v[4:7], v[72:75], a[148:151], v[4:7]
  ds_read_b64_tr_b16 v[90:91], v138 offset:20864
  v_mfma_f32_16x16x32_bf16 v[8:11], v[76:79], a[144:147], v[8:11]
  ds_read_b64_tr_b16 v[92:93], v138 offset:18592
  v_mfma_f32_16x16x32_bf16 v[12:15], v[76:79], a[148:151], v[12:15]
  ds_read_b64_tr_b16 v[94:95], v138 offset:20896
  s_waitcnt lgkmcnt(4)
  v_mfma_f32_16x16x32_bf16 v[16:19], v[80:83], a[144:147], v[16:19]
  ds_read_b64_tr_b16 v[72:73], v138 offset:18624
  v_mfma_f32_16x16x32_bf16 v[20:23], v[80:83], a[148:151], v[20:23]
  ds_read_b64_tr_b16 v[74:75], v138 offset:20928
  v_mfma_f32_16x16x32_bf16 v[24:27], v[84:87], a[144:147], v[24:27]
  ds_read_b64_tr_b16 v[76:77], v138 offset:18656
  v_mfma_f32_16x16x32_bf16 v[28:31], v[84:87], a[148:151], v[28:31]
  ds_read_b64_tr_b16 v[78:79], v138 offset:20960
  s_waitcnt lgkmcnt(4)
  v_mfma_f32_16x16x32_bf16 v[32:35], v[88:91], a[144:147], v[32:35]
  ds_read_b64_tr_b16 v[80:81], v138 offset:18688
  buffer_load_dwordx4 a[176:179], v140, s[20:23], s67 offen offset:2048 sc1
  v_mfma_f32_16x16x32_bf16 v[36:39], v[88:91], a[148:151], v[36:39]
  ds_read_b64_tr_b16 v[82:83], v138 offset:20992
  buffer_load_dwordx4 a[180:183], v151, s[20:23], s67 offen offset:2048 sc1
  v_mfma_f32_16x16x32_bf16 v[40:43], v[92:95], a[144:147], v[40:43]
  ds_read_b64_tr_b16 v[84:85], v138 offset:27648
  v_mfma_f32_16x16x32_bf16 v[44:47], v[92:95], a[148:151], v[44:47]
  ds_read_b64_tr_b16 v[86:87], v138 offset:29952
  s_waitcnt lgkmcnt(4)
  v_mfma_f32_16x16x32_bf16 v[48:51], v[72:75], a[144:147], v[48:51]
  ds_read_b64_tr_b16 v[88:89], v138 offset:27680
  v_mfma_f32_16x16x32_bf16 v[52:55], v[72:75], a[148:151], v[52:55]
  ds_read_b64_tr_b16 v[90:91], v138 offset:29984
  v_mfma_f32_16x16x32_bf16 v[56:59], v[76:79], a[144:147], v[56:59]
  ds_read_b64_tr_b16 v[92:93], v138 offset:27712
  v_mfma_f32_16x16x32_bf16 v[60:63], v[76:79], a[148:151], v[60:63]
  ds_read_b64_tr_b16 v[94:95], v138 offset:30016
  s_waitcnt lgkmcnt(4)
  v_mfma_f32_16x16x32_bf16 v[64:67], v[80:83], a[144:147], v[64:67]
  ds_read_b64_tr_b16 v[72:73], v138 offset:27744
  v_mfma_f32_16x16x32_bf16 v[68:71], v[80:83], a[148:151], v[68:71]
  ds_read_b64_tr_b16 v[74:75], v138 offset:30048
  s_waitcnt vmcnt(6)
  v_mfma_f32_16x16x32_bf16 v[0:3], v[84:87], a[152:155], v[0:3]
  ds_read_b64_tr_b16 v[76:77], v138 offset:27776
  v_mfma_f32_16x16x32_bf16 v[4:7], v[84:87], a[156:159], v[4:7]
  ds_read_b64_tr_b16 v[78:79], v138 offset:30080
  s_waitcnt lgkmcnt(4)
  v_mfma_f32_16x16x32_bf16 v[8:11], v[88:91], a[152:155], v[8:11]
  ds_read_b64_tr_b16 v[80:81], v138 offset:27808
  v_mfma_f32_16x16x32_bf16 v[12:15], v[88:91], a[156:159], v[12:15]
  ds_read_b64_tr_b16 v[82:83], v138 offset:30112
  v_mfma_f32_16x16x32_bf16 v[16:19], v[92:95], a[152:155], v[16:19]
  ds_read_b64_tr_b16 v[84:85], v138 offset:27840
  v_mfma_f32_16x16x32_bf16 v[20:23], v[92:95], a[156:159], v[20:23]
  ds_read_b64_tr_b16 v[86:87], v138 offset:30144
  s_waitcnt lgkmcnt(4)
  v_mfma_f32_16x16x32_bf16 v[24:27], v[72:75], a[152:155], v[24:27]
  ds_read_b64_tr_b16 v[88:89], v138 offset:27872
  v_mfma_f32_16x16x32_bf16 v[28:31], v[72:75], a[156:159], v[28:31]
  ds_read_b64_tr_b16 v[90:91], v138 offset:30176
  s_barrier
  v_mfma_f32_16x16x32_bf16 v[32:35], v[76:79], a[152:155], v[32:35]
  ds_read_b64_tr_b16 v[92:93], v138 offset:27904
  s_add_u32 s65, s60, 1032192
  s_add_u32 m0, s64, 0
  v_mfma_f32_16x16x32_bf16 v[36:39], v[76:79], a[156:159], v[36:39]
  ds_read_b64_tr_b16 v[94:95], v138 offset:30208
  buffer_load_dwordx4 v226, s[24:27], s65 offen lds
  s_waitcnt lgkmcnt(4)
  v_mfma_f32_16x16x32_bf16 v[40:43], v[80:83], a[152:155], v[40:43]
  ds_read_b64_tr_b16 v[72:73], v138 offset:36864
  s_add_u32 m0, s64, 1024
  v_mfma_f32_16x16x32_bf16 v[44:47], v[80:83], a[156:159], v[44:47]
  ds_read_b64_tr_b16 v[74:75], v138 offset:39168
  buffer_load_dwordx4 v227, s[24:27], s65 offen lds
  v_mfma_f32_16x16x32_bf16 v[48:51], v[84:87], a[152:155], v[48:51]
  ds_read_b64_tr_b16 v[76:77], v138 offset:36896
  s_add_u32 m0, s64, 2048
  v_mfma_f32_16x16x32_bf16 v[52:55], v[84:87], a[156:159], v[52:55]
  ds_read_b64_tr_b16 v[78:79], v138 offset:39200
  buffer_load_dwordx4 v228, s[24:27], s65 offen lds
  s_waitcnt lgkmcnt(4)
  v_mfma_f32_16x16x32_bf16 v[56:59], v[88:91], a[152:155], v[56:59]
  ds_read_b64_tr_b16 v[80:81], v138 offset:36928
  s_add_u32 m0, s64, 3072
  v_mfma_f32_16x16x32_bf16 v[60:63], v[88:91], a[156:159], v[60:63]
  ds_read_b64_tr_b16 v[82:83], v138 offset:39232
  buffer_load_dwordx4 v229, s[24:27], s65 offen lds
  v_mfma_f32_16x16x32_bf16 v[64:67], v[92:95], a[152:155], v[64:67]
  ds_read_b64_tr_b16 v[84:85], v138 offset:36960
  s_add_u32 m0, s64, 4096
  v_mfma_f32_16x16x32_bf16 v[68:71], v[92:95], a[156:159], v[68:71]
  ds_read_b64_tr_b16 v[86:87], v138 offset:39264
  buffer_load_dwordx4 v230, s[24:27], s65 offen lds
  s_waitcnt vmcnt(9) lgkmcnt(4)
  v_mfma_f32_16x16x32_bf16 v[0:3], v[72:75], a[160:163], v[0:3]
  ds_read_b64_tr_b16 v[88:89], v138 offset:36992
  s_add_u32 m0, s64, 5120
  v_mfma_f32_16x16x32_bf16 v[4:7], v[72:75], a[164:167], v[4:7]
  ds_read_b64_tr_b16 v[90:91], v138 offset:39296
  buffer_load_dwordx4 v231, s[24:27], s65 offen lds
  v_mfma_f32_16x16x32_bf16 v[8:11], v[76:79], a[160:163], v[8:11]
  ds_read_b64_tr_b16 v[92:93], v138 offset:37024
  s_add_u32 m0, s64, 6144
  v_mfma_f32_16x16x32_bf16 v[12:15], v[76:79], a[164:167], v[12:15]
  ds_read_b64_tr_b16 v[94:95], v138 offset:39328
  buffer_load_dwordx4 v232, s[24:27], s65 offen lds
  s_waitcnt lgkmcnt(4)
  v_mfma_f32_16x16x32_bf16 v[16:19], v[80:83], a[160:163], v[16:19]
  ds_read_b64_tr_b16 v[72:73], v138 offset:37056
  s_add_u32 m0, s64, 7168
  v_mfma_f32_16x16x32_bf16 v[20:23], v[80:83], a[164:167], v[20:23]
  ds_read_b64_tr_b16 v[74:75], v138 offset:39360
  buffer_load_dwordx4 v233, s[24:27], s65 offen lds
  v_mfma_f32_16x16x32_bf16 v[24:27], v[84:87], a[160:163], v[24:27]
  ds_read_b64_tr_b16 v[76:77], v138 offset:37088
  s_add_u32 m0, s64, 8192
  v_mfma_f32_16x16x32_bf16 v[28:31], v[84:87], a[164:167], v[28:31]
  ds_read_b64_tr_b16 v[78:79], v138 offset:39392
  buffer_load_dwordx4 v234, s[24:27], s65 offen lds
  s_waitcnt lgkmcnt(4)
  v_mfma_f32_16x16x32_bf16 v[32:35], v[88:91], a[160:163], v[32:35]
  ds_read_b64_tr_b16 v[80:81], v138 offset:37120
  buffer_load_dwordx4 a[184:187], v140, s[20:23], s67 offen offset:3072 sc1
  v_mfma_f32_16x16x32_bf16 v[36:39], v[88:91], a[164:167], v[36:39]
  ds_read_b64_tr_b16 v[82:83], v138 offset:39424
  buffer_load_dwordx4 a[188:191], v151, s[20:23], s67 offen offset:3072 sc1
  v_mfma_f32_16x16x32_bf16 v[40:43], v[92:95], a[160:163], v[40:43]
  ds_read_b64_tr_b16 v[84:85], v138 offset:46080
  s_mov_b32 s67, 24576
  v_mfma_f32_16x16x32_bf16 v[44:47], v[92:95], a[164:167], v[44:47]
  ds_read_b64_tr_b16 v[86:87], v138 offset:48384
  buffer_load_dwordx4 a[192:195], v140, s[20:23], s67 offen offset:0 sc1
  s_waitcnt lgkmcnt(4)
  v_mfma_f32_16x16x32_bf16 v[48:51], v[72:75], a[160:163], v[48:51]
  ds_read_b64_tr_b16 v[88:89], v138 offset:46112
  buffer_load_dwordx4 a[196:199], v151, s[20:23], s67 offen offset:0 sc1
  v_mfma_f32_16x16x32_bf16 v[52:55], v[72:75], a[164:167], v[52:55]
  ds_read_b64_tr_b16 v[90:91], v138 offset:48416
  v_mfma_f32_16x16x32_bf16 v[56:59], v[76:79], a[160:163], v[56:59]
  ds_read_b64_tr_b16 v[92:93], v138 offset:46144
  v_mfma_f32_16x16x32_bf16 v[60:63], v[76:79], a[164:167], v[60:63]
  ds_read_b64_tr_b16 v[94:95], v138 offset:48448
  s_waitcnt lgkmcnt(4)
  v_mfma_f32_16x16x32_bf16 v[64:67], v[80:83], a[160:163], v[64:67]
  ds_read_b64_tr_b16 v[72:73], v138 offset:46176
  v_mfma_f32_16x16x32_bf16 v[68:71], v[80:83], a[164:167], v[68:71]
  ds_read_b64_tr_b16 v[74:75], v138 offset:48480
  s_waitcnt vmcnt(15)
  v_mfma_f32_16x16x32_bf16 v[0:3], v[84:87], a[168:171], v[0:3]
  ds_read_b64_tr_b16 v[76:77], v138 offset:46208
  v_mfma_f32_16x16x32_bf16 v[4:7], v[84:87], a[172:175], v[4:7]
  ds_read_b64_tr_b16 v[78:79], v138 offset:48512
  s_waitcnt lgkmcnt(4)
  v_mfma_f32_16x16x32_bf16 v[8:11], v[88:91], a[168:171], v[8:11]
  ds_read_b64_tr_b16 v[80:81], v138 offset:46240
  v_mfma_f32_16x16x32_bf16 v[12:15], v[88:91], a[172:175], v[12:15]
  ds_read_b64_tr_b16 v[82:83], v138 offset:48544
  v_mfma_f32_16x16x32_bf16 v[16:19], v[92:95], a[168:171], v[16:19]
  ds_read_b64_tr_b16 v[84:85], v138 offset:46272
  v_mfma_f32_16x16x32_bf16 v[20:23], v[92:95], a[172:175], v[20:23]
  ds_read_b64_tr_b16 v[86:87], v138 offset:48576
  s_waitcnt lgkmcnt(4)
  v_mfma_f32_16x16x32_bf16 v[24:27], v[72:75], a[168:171], v[24:27]
  ds_read_b64_tr_b16 v[88:89], v138 offset:46304
  v_mfma_f32_16x16x32_bf16 v[28:31], v[72:75], a[172:175], v[28:31]
  ds_read_b64_tr_b16 v[90:91], v138 offset:48608
  v_mfma_f32_16x16x32_bf16 v[32:35], v[76:79], a[168:171], v[32:35]
  ds_read_b64_tr_b16 v[92:93], v138 offset:46336
  buffer_load_dwordx4 a[200:203], v140, s[20:23], s67 offen offset:1024 sc1
  v_mfma_f32_16x16x32_bf16 v[36:39], v[76:79], a[172:175], v[36:39]
  ds_read_b64_tr_b16 v[94:95], v138 offset:48640
  buffer_load_dwordx4 a[204:207], v151, s[20:23], s67 offen offset:1024 sc1
  s_waitcnt lgkmcnt(4)
  v_mfma_f32_16x16x32_bf16 v[40:43], v[80:83], a[168:171], v[40:43]
  ds_read_b64_tr_b16 v[72:73], v139 offset:0
  v_mfma_f32_16x16x32_bf16 v[44:47], v[80:83], a[172:175], v[44:47]
  ds_read_b64_tr_b16 v[74:75], v139 offset:2304
  v_mfma_f32_16x16x32_bf16 v[48:51], v[84:87], a[168:171], v[48:51]
  ds_read_b64_tr_b16 v[76:77], v139 offset:32
  v_mfma_f32_16x16x32_bf16 v[52:55], v[84:87], a[172:175], v[52:55]
  ds_read_b64_tr_b16 v[78:79], v139 offset:2336
  s_waitcnt lgkmcnt(4)
  v_mfma_f32_16x16x32_bf16 v[56:59], v[88:91], a[168:171], v[56:59]
  ds_read_b64_tr_b16 v[80:81], v139 offset:64
  v_mfma_f32_16x16x32_bf16 v[60:63], v[88:91], a[172:175], v[60:63]
  ds_read_b64_tr_b16 v[82:83], v139 offset:2368
  v_mfma_f32_16x16x32_bf16 v[64:67], v[92:95], a[168:171], v[64:67]
  ds_read_b64_tr_b16 v[84:85], v139 offset:96
  v_mfma_f32_16x16x32_bf16 v[68:71], v[92:95], a[172:175], v[68:71]
  ds_read_b64_tr_b16 v[86:87], v139 offset:2400
  s_waitcnt vmcnt(15) lgkmcnt(4)
  v_mfma_f32_16x16x32_bf16 v[0:3], v[72:75], a[176:179], v[0:3]
  ds_read_b64_tr_b16 v[88:89], v139 offset:128
  v_mfma_f32_16x16x32_bf16 v[4:7], v[72:75], a[180:183], v[4:7]
  ds_read_b64_tr_b16 v[90:91], v139 offset:2432
  v_mfma_f32_16x16x32_bf16 v[8:11], v[76:79], a[176:179], v[8:11]
  ds_read_b64_tr_b16 v[92:93], v139 offset:160
  v_mfma_f32_16x16x32_bf16 v[12:15], v[76:79], a[180:183], v[12:15]
  ds_read_b64_tr_b16 v[94:95], v139 offset:2464
  s_waitcnt lgkmcnt(4)
  v_mfma_f32_16x16x32_bf16 v[16:19], v[80:83], a[176:179], v[16:19]
  ds_read_b64_tr_b16 v[72:73], v139 offset:192
  v_mfma_f32_16x16x32_bf16 v[20:23], v[80:83], a[180:183], v[20:23]
  ds_read_b64_tr_b16 v[74:75], v139 offset:2496
  v_mfma_f32_16x16x32_bf16 v[24:27], v[84:87], a[176:179], v[24:27]
  ds_read_b64_tr_b16 v[76:77], v139 offset:224
  v_mfma_f32_16x16x32_bf16 v[28:31], v[84:87], a[180:183], v[28:31]
  ds_read_b64_tr_b16 v[78:79], v139 offset:2528
  s_waitcnt lgkmcnt(4)
  v_mfma_f32_16x16x32_bf16 v[32:35], v[88:91], a[176:179], v[32:35]
  ds_read_b64_tr_b16 v[80:81], v139 offset:256
  buffer_load_dwordx4 a[208:211], v140, s[20:23], s67 offen offset:2048 sc1
  v_mfma_f32_16x16x32_bf16 v[36:39], v[88:91], a[180:183], v[36:39]
  ds_read_b64_tr_b16 v[82:83], v139 offset:2560
  buffer_load_dwordx4 a[212:215], v151, s[20:23], s67 offen offset:2048 sc1
  v_mfma_f32_16x16x32_bf16 v[40:43], v[92:95], a[176:179], v[40:43]
  ds_read_b64_tr_b16 v[84:85], v139 offset:9216
  v_mfma_f32_16x16x32_bf16 v[44:47], v[92:95], a[180:183], v[44:47]
  ds_read_b64_tr_b16 v[86:87], v139 offset:11520
  s_waitcnt lgkmcnt(4)
  v_mfma_f32_16x16x32_bf16 v[48:51], v[72:75], a[176:179], v[48:51]
  ds_read_b64_tr_b16 v[88:89], v139 offset:9248
  v_mfma_f32_16x16x32_bf16 v[52:55], v[72:75], a[180:183], v[52:55]
  ds_read_b64_tr_b16 v[90:91], v139 offset:11552
  v_mfma_f32_16x16x32_bf16 v[56:59], v[76:79], a[176:179], v[56:59]
  ds_read_b64_tr_b16 v[92:93], v139 offset:9280
  v_mfma_f32_16x16x32_bf16 v[60:63], v[76:79], a[180:183], v[60:63]
  ds_read_b64_tr_b16 v[94:95], v139 offset:11584
  s_waitcnt lgkmcnt(4)
  v_mfma_f32_16x16x32_bf16 v[64:67], v[80:83], a[176:179], v[64:67]
  ds_read_b64_tr_b16 v[72:73], v139 offset:9312
  v_mfma_f32_16x16x32_bf16 v[68:71], v[80:83], a[180:183], v[68:71]
  ds_read_b64_tr_b16 v[74:75], v139 offset:11616
  s_waitcnt vmcnt(6)
  v_mfma_f32_16x16x32_bf16 v[0:3], v[84:87], a[184:187], v[0:3]
  ds_read_b64_tr_b16 v[76:77], v139 offset:9344
  v_mfma_f32_16x16x32_bf16 v[4:7], v[84:87], a[188:191], v[4:7]
  ds_read_b64_tr_b16 v[78:79], v139 offset:11648
  s_waitcnt lgkmcnt(4)
  v_mfma_f32_16x16x32_bf16 v[8:11], v[88:91], a[184:187], v[8:11]
  ds_read_b64_tr_b16 v[80:81], v139 offset:9376
  v_mfma_f32_16x16x32_bf16 v[12:15], v[88:91], a[188:191], v[12:15]
  ds_read_b64_tr_b16 v[82:83], v139 offset:11680
  v_mfma_f32_16x16x32_bf16 v[16:19], v[92:95], a[184:187], v[16:19]
  ds_read_b64_tr_b16 v[84:85], v139 offset:9408
  v_mfma_f32_16x16x32_bf16 v[20:23], v[92:95], a[188:191], v[20:23]
  ds_read_b64_tr_b16 v[86:87], v139 offset:11712
  s_waitcnt lgkmcnt(4)
  v_mfma_f32_16x16x32_bf16 v[24:27], v[72:75], a[184:187], v[24:27]
  ds_read_b64_tr_b16 v[88:89], v139 offset:9440
  v_mfma_f32_16x16x32_bf16 v[28:31], v[72:75], a[188:191], v[28:31]
  ds_read_b64_tr_b16 v[90:91], v139 offset:11744
  s_barrier
  v_mfma_f32_16x16x32_bf16 v[32:35], v[76:79], a[184:187], v[32:35]
  ds_read_b64_tr_b16 v[92:93], v139 offset:9472
  s_add_u32 s65, s60, 1179648
  s_add_u32 m0, s61, 0
  v_mfma_f32_16x16x32_bf16 v[36:39], v[76:79], a[188:191], v[36:39]
  ds_read_b64_tr_b16 v[94:95], v139 offset:11776
  buffer_load_dwordx4 v226, s[24:27], s65 offen lds
  s_waitcnt lgkmcnt(4)
  v_mfma_f32_16x16x32_bf16 v[40:43], v[80:83], a[184:187], v[40:43]
  ds_read_b64_tr_b16 v[72:73], v139 offset:18432
  s_add_u32 m0, s61, 1024
  v_mfma_f32_16x16x32_bf16 v[44:47], v[80:83], a[188:191], v[44:47]
  ds_read_b64_tr_b16 v[74:75], v139 offset:20736
  buffer_load_dwordx4 v227, s[24:27], s65 offen lds
  v_mfma_f32_16x16x32_bf16 v[48:51], v[84:87], a[184:187], v[48:51]
  ds_read_b64_tr_b16 v[76:77], v139 offset:18464
  s_add_u32 m0, s61, 2048
  v_mfma_f32_16x16x32_bf16 v[52:55], v[84:87], a[188:191], v[52:55]
  ds_read_b64_tr_b16 v[78:79], v139 offset:20768
  buffer_load_dwordx4 v228, s[24:27], s65 offen lds
  s_waitcnt lgkmcnt(4)
  v_mfma_f32_16x16x32_bf16 v[56:59], v[88:91], a[184:187], v[56:59]
  ds_read_b64_tr_b16 v[80:81], v139 offset:18496
  s_add_u32 m0, s61, 3072
  v_mfma_f32_16x16x32_bf16 v[60:63], v[88:91], a[188:191], v[60:63]
  ds_read_b64_tr_b16 v[82:83], v139 offset:20800
  buffer_load_dwordx4 v229, s[24:27], s65 offen lds
  v_mfma_f32_16x16x32_bf16 v[64:67], v[92:95], a[184:187], v[64:67]
  ds_read_b64_tr_b16 v[84:85], v139 offset:18528
  s_add_u32 m0, s61, 4096
  v_mfma_f32_16x16x32_bf16 v[68:71], v[92:95], a[188:191], v[68:71]
  ds_read_b64_tr_b16 v[86:87], v139 offset:20832
  buffer_load_dwordx4 v230, s[24:27], s65 offen lds
  s_waitcnt vmcnt(9) lgkmcnt(4)
  v_mfma_f32_16x16x32_bf16 v[0:3], v[72:75], a[192:195], v[0:3]
  ds_read_b64_tr_b16 v[88:89], v139 offset:18560
  s_add_u32 m0, s61, 5120
  v_mfma_f32_16x16x32_bf16 v[4:7], v[72:75], a[196:199], v[4:7]
  ds_read_b64_tr_b16 v[90:91], v139 offset:20864
  buffer_load_dwordx4 v231, s[24:27], s65 offen lds
  v_mfma_f32_16x16x32_bf16 v[8:11], v[76:79], a[192:195], v[8:11]
  ds_read_b64_tr_b16 v[92:93], v139 offset:18592
  s_add_u32 m0, s61, 6144
  v_mfma_f32_16x16x32_bf16 v[12:15], v[76:79], a[196:199], v[12:15]
  ds_read_b64_tr_b16 v[94:95], v139 offset:20896
  buffer_load_dwordx4 v232, s[24:27], s65 offen lds
  s_waitcnt lgkmcnt(4)
  v_mfma_f32_16x16x32_bf16 v[16:19], v[80:83], a[192:195], v[16:19]
  ds_read_b64_tr_b16 v[72:73], v139 offset:18624
  s_add_u32 m0, s61, 7168
  v_mfma_f32_16x16x32_bf16 v[20:23], v[80:83], a[196:199], v[20:23]
  ds_read_b64_tr_b16 v[74:75], v139 offset:20928
  buffer_load_dwordx4 v233, s[24:27], s65 offen lds
  v_mfma_f32_16x16x32_bf16 v[24:27], v[84:87], a[192:195], v[24:27]
  ds_read_b64_tr_b16 v[76:77], v139 offset:18656
  s_add_u32 m0, s61, 8192
  v_mfma_f32_16x16x32_bf16 v[28:31], v[84:87], a[196:199], v[28:31]
  ds_read_b64_tr_b16 v[78:79], v139 offset:20960
  buffer_load_dwordx4 v234, s[24:27], s65 offen lds
  s_waitcnt lgkmcnt(4)
  v_mfma_f32_16x16x32_bf16 v[32:35], v[88:91], a[192:195], v[32:35]
  ds_read_b64_tr_b16 v[80:81], v139 offset:18688
  buffer_load_dwordx4 a[216:219], v140, s[20:23], s67 offen offset:3072 sc1
  v_mfma_f32_16x16x32_bf16 v[36:39], v[88:91], a[196:199], v[36:39]
  ds_read_b64_tr_b16 v[82:83], v139 offset:20992
  buffer_load_dwordx4 a[220:223], v151, s[20:23], s67 offen offset:3072 sc1
  v_mfma_f32_16x16x32_bf16 v[40:43], v[92:95], a[192:195], v[40:43]
  ds_read_b64_tr_b16 v[84:85], v139 offset:27648
  s_mov_b32 s67, 28672
  v_mfma_f32_16x16x32_bf16 v[44:47], v[92:95], a[196:199], v[44:47]
  ds_read_b64_tr_b16 v[86:87], v139 offset:29952
  buffer_load_dwordx4 a[224:227], v140, s[20:23], s67 offen offset:0 sc1
  s_waitcnt lgkmcnt(4)
  v_mfma_f32_16x16x32_bf16 v[48:51], v[72:75], a[192:195], v[48:51]
  ds_read_b64_tr_b16 v[88:89], v139 offset:27680
  buffer_load_dwordx4 a[228:231], v151, s[20:23], s67 offen offset:0 sc1
  v_mfma_f32_16x16x32_bf16 v[52:55], v[72:75], a[196:199], v[52:55]
  ds_read_b64_tr_b16 v[90:91], v139 offset:29984
  v_mfma_f32_16x16x32_bf16 v[56:59], v[76:79], a[192:195], v[56:59]
  ds_read_b64_tr_b16 v[92:93], v139 offset:27712
  v_mfma_f32_16x16x32_bf16 v[60:63], v[76:79], a[196:199], v[60:63]
  ds_read_b64_tr_b16 v[94:95], v139 offset:30016
  s_waitcnt lgkmcnt(4)
  v_mfma_f32_16x16x32_bf16 v[64:67], v[80:83], a[192:195], v[64:67]
  ds_read_b64_tr_b16 v[72:73], v139 offset:27744
  v_mfma_f32_16x16x32_bf16 v[68:71], v[80:83], a[196:199], v[68:71]
  ds_read_b64_tr_b16 v[74:75], v139 offset:30048
  s_waitcnt vmcnt(15)
  v_mfma_f32_16x16x32_bf16 v[0:3], v[84:87], a[200:203], v[0:3]
  ds_read_b64_tr_b16 v[76:77], v139 offset:27776
  v_mfma_f32_16x16x32_bf16 v[4:7], v[84:87], a[204:207], v[4:7]
  ds_read_b64_tr_b16 v[78:79], v139 offset:30080
  s_waitcnt lgkmcnt(4)
  v_mfma_f32_16x16x32_bf16 v[8:11], v[88:91], a[200:203], v[8:11]
  ds_read_b64_tr_b16 v[80:81], v139 offset:27808
  v_mfma_f32_16x16x32_bf16 v[12:15], v[88:91], a[204:207], v[12:15]
  ds_read_b64_tr_b16 v[82:83], v139 offset:30112
  v_mfma_f32_16x16x32_bf16 v[16:19], v[92:95], a[200:203], v[16:19]
  ds_read_b64_tr_b16 v[84:85], v139 offset:27840
  v_mfma_f32_16x16x32_bf16 v[20:23], v[92:95], a[204:207], v[20:23]
  ds_read_b64_tr_b16 v[86:87], v139 offset:30144
  s_waitcnt lgkmcnt(4)
  v_mfma_f32_16x16x32_bf16 v[24:27], v[72:75], a[200:203], v[24:27]
  ds_read_b64_tr_b16 v[88:89], v139 offset:27872
  v_mfma_f32_16x16x32_bf16 v[28:31], v[72:75], a[204:207], v[28:31]
  ds_read_b64_tr_b16 v[90:91], v139 offset:30176
  v_mfma_f32_16x16x32_bf16 v[32:35], v[76:79], a[200:203], v[32:35]
  ds_read_b64_tr_b16 v[92:93], v139 offset:27904
  buffer_load_dwordx4 a[232:235], v140, s[20:23], s67 offen offset:1024 sc1
  v_mfma_f32_16x16x32_bf16 v[36:39], v[76:79], a[204:207], v[36:39]
  ds_read_b64_tr_b16 v[94:95], v139 offset:30208
  buffer_load_dwordx4 a[236:239], v151, s[20:23], s67 offen offset:1024 sc1
  s_waitcnt lgkmcnt(4)
  v_mfma_f32_16x16x32_bf16 v[40:43], v[80:83], a[200:203], v[40:43]
  ds_read_b64_tr_b16 v[72:73], v137 offset:0
  v_mfma_f32_16x16x32_bf16 v[44:47], v[80:83], a[204:207], v[44:47]
  ds_read_b64_tr_b16 v[74:75], v137 offset:2304
  v_mfma_f32_16x16x32_bf16 v[48:51], v[84:87], a[200:203], v[48:51]
  ds_read_b64_tr_b16 v[76:77], v137 offset:32
  v_mfma_f32_16x16x32_bf16 v[52:55], v[84:87], a[204:207], v[52:55]
  ds_read_b64_tr_b16 v[78:79], v137 offset:2336
  s_waitcnt lgkmcnt(4)
  v_mfma_f32_16x16x32_bf16 v[56:59], v[88:91], a[200:203], v[56:59]
  ds_read_b64_tr_b16 v[80:81], v137 offset:64
  v_mfma_f32_16x16x32_bf16 v[60:63], v[88:91], a[204:207], v[60:63]
  ds_read_b64_tr_b16 v[82:83], v137 offset:2368
  v_mfma_f32_16x16x32_bf16 v[64:67], v[92:95], a[200:203], v[64:67]
  ds_read_b64_tr_b16 v[84:85], v137 offset:96
  v_mfma_f32_16x16x32_bf16 v[68:71], v[92:95], a[204:207], v[68:71]
  ds_read_b64_tr_b16 v[86:87], v137 offset:2400
  s_waitcnt vmcnt(15) lgkmcnt(4)
  v_mfma_f32_16x16x32_bf16 v[0:3], v[72:75], a[208:211], v[0:3]
  ds_read_b64_tr_b16 v[88:89], v137 offset:128
  v_mfma_f32_16x16x32_bf16 v[4:7], v[72:75], a[212:215], v[4:7]
  ds_read_b64_tr_b16 v[90:91], v137 offset:2432
  v_mfma_f32_16x16x32_bf16 v[8:11], v[76:79], a[208:211], v[8:11]
  ds_read_b64_tr_b16 v[92:93], v137 offset:160
  v_mfma_f32_16x16x32_bf16 v[12:15], v[76:79], a[212:215], v[12:15]
  ds_read_b64_tr_b16 v[94:95], v137 offset:2464
  s_waitcnt lgkmcnt(4)
  v_mfma_f32_16x16x32_bf16 v[16:19], v[80:83], a[208:211], v[16:19]
  ds_read_b64_tr_b16 v[72:73], v137 offset:192
  v_mfma_f32_16x16x32_bf16 v[20:23], v[80:83], a[212:215], v[20:23]
  ds_read_b64_tr_b16 v[74:75], v137 offset:2496
  v_mfma_f32_16x16x32_bf16 v[24:27], v[84:87], a[208:211], v[24:27]
  ds_read_b64_tr_b16 v[76:77], v137 offset:224
  v_mfma_f32_16x16x32_bf16 v[28:31], v[84:87], a[212:215], v[28:31]
  ds_read_b64_tr_b16 v[78:79], v137 offset:2528
  s_waitcnt lgkmcnt(4)
  v_mfma_f32_16x16x32_bf16 v[32:35], v[88:91], a[208:211], v[32:35]
  ds_read_b64_tr_b16 v[80:81], v137 offset:256
  buffer_load_dwordx4 a[240:243], v140, s[20:23], s67 offen offset:2048 sc1
  v_mfma_f32_16x16x32_bf16 v[36:39], v[88:91], a[212:215], v[36:39]
  ds_read_b64_tr_b16 v[82:83], v137 offset:2560
  buffer_load_dwordx4 a[244:247], v151, s[20:23], s67 offen offset:2048 sc1
  v_mfma_f32_16x16x32_bf16 v[40:43], v[92:95], a[208:211], v[40:43]
  ds_read_b64_tr_b16 v[84:85], v137 offset:9216
  v_mfma_f32_16x16x32_bf16 v[44:47], v[92:95], a[212:215], v[44:47]
  ds_read_b64_tr_b16 v[86:87], v137 offset:11520
  s_waitcnt lgkmcnt(4)
  v_mfma_f32_16x16x32_bf16 v[48:51], v[72:75], a[208:211], v[48:51]
  ds_read_b64_tr_b16 v[88:89], v137 offset:9248
  v_mfma_f32_16x16x32_bf16 v[52:55], v[72:75], a[212:215], v[52:55]
  ds_read_b64_tr_b16 v[90:91], v137 offset:11552
  v_mfma_f32_16x16x32_bf16 v[56:59], v[76:79], a[208:211], v[56:59]
  ds_read_b64_tr_b16 v[92:93], v137 offset:9280
  v_mfma_f32_16x16x32_bf16 v[60:63], v[76:79], a[212:215], v[60:63]
  ds_read_b64_tr_b16 v[94:95], v137 offset:11584
  s_waitcnt lgkmcnt(4)
  v_mfma_f32_16x16x32_bf16 v[64:67], v[80:83], a[208:211], v[64:67]
  ds_read_b64_tr_b16 v[72:73], v137 offset:9312
  v_mfma_f32_16x16x32_bf16 v[68:71], v[80:83], a[212:215], v[68:71]
  ds_read_b64_tr_b16 v[74:75], v137 offset:11616
  s_waitcnt vmcnt(6)
  v_mfma_f32_16x16x32_bf16 v[0:3], v[84:87], a[216:219], v[0:3]
  ds_read_b64_tr_b16 v[76:77], v137 offset:9344
  v_mfma_f32_16x16x32_bf16 v[4:7], v[84:87], a[220:223], v[4:7]
  ds_read_b64_tr_b16 v[78:79], v137 offset:11648
  s_waitcnt lgkmcnt(4)
  v_mfma_f32_16x16x32_bf16 v[8:11], v[88:91], a[216:219], v[8:11]
  ds_read_b64_tr_b16 v[80:81], v137 offset:9376
  v_mfma_f32_16x16x32_bf16 v[12:15], v[88:91], a[220:223], v[12:15]
  ds_read_b64_tr_b16 v[82:83], v137 offset:11680
  v_mfma_f32_16x16x32_bf16 v[16:19], v[92:95], a[216:219], v[16:19]
  ds_read_b64_tr_b16 v[84:85], v137 offset:9408
  v_mfma_f32_16x16x32_bf16 v[20:23], v[92:95], a[220:223], v[20:23]
  ds_read_b64_tr_b16 v[86:87], v137 offset:11712
  s_waitcnt lgkmcnt(4)
  v_mfma_f32_16x16x32_bf16 v[24:27], v[72:75], a[216:219], v[24:27]
  ds_read_b64_tr_b16 v[88:89], v137 offset:9440
  v_mfma_f32_16x16x32_bf16 v[28:31], v[72:75], a[220:223], v[28:31]
  ds_read_b64_tr_b16 v[90:91], v137 offset:11744
  s_barrier
  v_mfma_f32_16x16x32_bf16 v[32:35], v[76:79], a[216:219], v[32:35]
  ds_read_b64_tr_b16 v[92:93], v137 offset:9472
  buffer_load_dwordx4 a[248:251], v140, s[20:23], s67 offen offset:3072 sc1
  v_mfma_f32_16x16x32_bf16 v[36:39], v[76:79], a[220:223], v[36:39]
  ds_read_b64_tr_b16 v[94:95], v137 offset:11776
  buffer_load_dwordx4 a[252:255], v151, s[20:23], s67 offen offset:3072 sc1
  s_waitcnt lgkmcnt(4)
  v_mfma_f32_16x16x32_bf16 v[40:43], v[80:83], a[216:219], v[40:43]
  ds_read_b64_tr_b16 v[72:73], v137 offset:18432
  v_mfma_f32_16x16x32_bf16 v[44:47], v[80:83], a[220:223], v[44:47]
  ds_read_b64_tr_b16 v[74:75], v137 offset:20736
  v_mfma_f32_16x16x32_bf16 v[48:51], v[84:87], a[216:219], v[48:51]
  ds_read_b64_tr_b16 v[76:77], v137 offset:18464
  v_mfma_f32_16x16x32_bf16 v[52:55], v[84:87], a[220:223], v[52:55]
  ds_read_b64_tr_b16 v[78:79], v137 offset:20768
  s_waitcnt lgkmcnt(4)
  v_mfma_f32_16x16x32_bf16 v[56:59], v[88:91], a[216:219], v[56:59]
  ds_read_b64_tr_b16 v[80:81], v137 offset:18496
  v_mfma_f32_16x16x32_bf16 v[60:63], v[88:91], a[220:223], v[60:63]
  ds_read_b64_tr_b16 v[82:83], v137 offset:20800
  v_mfma_f32_16x16x32_bf16 v[64:67], v[92:95], a[216:219], v[64:67]
  ds_read_b64_tr_b16 v[84:85], v137 offset:18528
  v_mfma_f32_16x16x32_bf16 v[68:71], v[92:95], a[220:223], v[68:71]
  ds_read_b64_tr_b16 v[86:87], v137 offset:20832
  s_waitcnt vmcnt(6) lgkmcnt(4)
  v_mfma_f32_16x16x32_bf16 v[0:3], v[72:75], a[224:227], v[0:3]
  ds_read_b64_tr_b16 v[88:89], v137 offset:18560
  v_mfma_f32_16x16x32_bf16 v[4:7], v[72:75], a[228:231], v[4:7]
  ds_read_b64_tr_b16 v[90:91], v137 offset:20864
  v_mfma_f32_16x16x32_bf16 v[8:11], v[76:79], a[224:227], v[8:11]
  ds_read_b64_tr_b16 v[92:93], v137 offset:18592
  v_mfma_f32_16x16x32_bf16 v[12:15], v[76:79], a[228:231], v[12:15]
  ds_read_b64_tr_b16 v[94:95], v137 offset:20896
  s_waitcnt lgkmcnt(4)
  v_mfma_f32_16x16x32_bf16 v[16:19], v[80:83], a[224:227], v[16:19]
  ds_read_b64_tr_b16 v[72:73], v137 offset:18624
  v_mfma_f32_16x16x32_bf16 v[20:23], v[80:83], a[228:231], v[20:23]
  ds_read_b64_tr_b16 v[74:75], v137 offset:20928
  v_mfma_f32_16x16x32_bf16 v[24:27], v[84:87], a[224:227], v[24:27]
  ds_read_b64_tr_b16 v[76:77], v137 offset:18656
  v_mfma_f32_16x16x32_bf16 v[28:31], v[84:87], a[228:231], v[28:31]
  ds_read_b64_tr_b16 v[78:79], v137 offset:20960
  s_waitcnt lgkmcnt(4)
  v_mfma_f32_16x16x32_bf16 v[32:35], v[88:91], a[224:227], v[32:35]
  ds_read_b64_tr_b16 v[80:81], v137 offset:18688
  s_mov_b32 s67, 32768
  v_mfma_f32_16x16x32_bf16 v[36:39], v[88:91], a[228:231], v[36:39]
  ds_read_b64_tr_b16 v[82:83], v137 offset:20992
  buffer_load_dwordx4 v[96:99], v140, s[20:23], s67 offen offset:0 sc1
  v_mfma_f32_16x16x32_bf16 v[40:43], v[92:95], a[224:227], v[40:43]
  ds_read_b64_tr_b16 v[84:85], v137 offset:27648
  buffer_load_dwordx4 v[100:103], v151, s[20:23], s67 offen offset:0 sc1
  v_mfma_f32_16x16x32_bf16 v[44:47], v[92:95], a[228:231], v[44:47]
  ds_read_b64_tr_b16 v[86:87], v137 offset:29952
  s_waitcnt lgkmcnt(4)
  v_mfma_f32_16x16x32_bf16 v[48:51], v[72:75], a[224:227], v[48:51]
  ds_read_b64_tr_b16 v[88:89], v137 offset:27680
  v_mfma_f32_16x16x32_bf16 v[52:55], v[72:75], a[228:231], v[52:55]
  ds_read_b64_tr_b16 v[90:91], v137 offset:29984
  v_mfma_f32_16x16x32_bf16 v[56:59], v[76:79], a[224:227], v[56:59]
  ds_read_b64_tr_b16 v[92:93], v137 offset:27712
  v_mfma_f32_16x16x32_bf16 v[60:63], v[76:79], a[228:231], v[60:63]
  ds_read_b64_tr_b16 v[94:95], v137 offset:30016
  s_waitcnt lgkmcnt(4)
  v_mfma_f32_16x16x32_bf16 v[64:67], v[80:83], a[224:227], v[64:67]
  ds_read_b64_tr_b16 v[72:73], v137 offset:27744
  v_mfma_f32_16x16x32_bf16 v[68:71], v[80:83], a[228:231], v[68:71]
  ds_read_b64_tr_b16 v[74:75], v137 offset:30048
  s_waitcnt vmcnt(6)
  v_mfma_f32_16x16x32_bf16 v[0:3], v[84:87], a[232:235], v[0:3]
  ds_read_b64_tr_b16 v[76:77], v137 offset:27776
  v_mfma_f32_16x16x32_bf16 v[4:7], v[84:87], a[236:239], v[4:7]
  ds_read_b64_tr_b16 v[78:79], v137 offset:30080
  s_waitcnt lgkmcnt(4)
  v_mfma_f32_16x16x32_bf16 v[8:11], v[88:91], a[232:235], v[8:11]
  ds_read_b64_tr_b16 v[80:81], v137 offset:27808
  v_mfma_f32_16x16x32_bf16 v[12:15], v[88:91], a[236:239], v[12:15]
  ds_read_b64_tr_b16 v[82:83], v137 offset:30112
  v_mfma_f32_16x16x32_bf16 v[16:19], v[92:95], a[232:235], v[16:19]
  ds_read_b64_tr_b16 v[84:85], v137 offset:27840
  v_mfma_f32_16x16x32_bf16 v[20:23], v[92:95], a[236:239], v[20:23]
  ds_read_b64_tr_b16 v[86:87], v137 offset:30144
  s_waitcnt lgkmcnt(4)
  v_mfma_f32_16x16x32_bf16 v[24:27], v[72:75], a[232:235], v[24:27]
  ds_read_b64_tr_b16 v[88:89], v137 offset:27872
  buffer_load_dwordx4 v[184:187], v167, s[8:11], 0 offen sc1
  v_mfma_f32_16x16x32_bf16 v[28:31], v[72:75], a[236:239], v[28:31]
  ds_read_b64_tr_b16 v[90:91], v137 offset:30176
  buffer_load_dwordx4 v[196:199], v170, s[16:19], 0 offen
  v_mfma_f32_16x16x32_bf16 v[32:35], v[76:79], a[232:235], v[32:35]
  ds_read_b64_tr_b16 v[92:93], v137 offset:27904
  buffer_load_dwordx4 v[200:203], v170, s[16:19], 0 offen offset:16
  v_mfma_f32_16x16x32_bf16 v[36:39], v[76:79], a[236:239], v[36:39]
  ds_read_b64_tr_b16 v[94:95], v137 offset:30208
  buffer_load_dwordx4 v[188:191], v168, s[8:11], 0 offen sc1
  s_waitcnt lgkmcnt(4)
  v_mfma_f32_16x16x32_bf16 v[40:43], v[80:83], a[232:235], v[40:43]
  ds_read_b64_tr_b16 v[72:73], v137 offset:36864
  buffer_load_dwordx4 v[204:207], v171, s[16:19], 0 offen
  v_mfma_f32_16x16x32_bf16 v[44:47], v[80:83], a[236:239], v[44:47]
  ds_read_b64_tr_b16 v[74:75], v137 offset:39168
  buffer_load_dwordx4 v[208:211], v171, s[16:19], 0 offen offset:16
  v_mfma_f32_16x16x32_bf16 v[48:51], v[84:87], a[232:235], v[48:51]
  ds_read_b64_tr_b16 v[76:77], v137 offset:36896
  buffer_load_dwordx4 v[192:195], v169, s[8:11], 0 offen sc1
  v_mfma_f32_16x16x32_bf16 v[52:55], v[84:87], a[236:239], v[52:55]
  ds_read_b64_tr_b16 v[78:79], v137 offset:39200
  buffer_load_dwordx4 v[218:221], v172, s[16:19], 0 offen
  s_waitcnt lgkmcnt(4)
  v_mfma_f32_16x16x32_bf16 v[56:59], v[88:91], a[232:235], v[56:59]
  ds_read_b64_tr_b16 v[80:81], v137 offset:36928
  buffer_load_dwordx4 v[222:225], v172, s[16:19], 0 offen offset:16
  v_mfma_f32_16x16x32_bf16 v[60:63], v[88:91], a[236:239], v[60:63]
  ds_read_b64_tr_b16 v[82:83], v137 offset:39232
  buffer_load_dwordx4 v[104:107], v140, s[20:23], s67 offen offset:1024 sc1
  v_mfma_f32_16x16x32_bf16 v[64:67], v[92:95], a[232:235], v[64:67]
  ds_read_b64_tr_b16 v[84:85], v137 offset:36960
  buffer_load_dwordx4 v[108:111], v151, s[20:23], s67 offen offset:1024 sc1
  v_mfma_f32_16x16x32_bf16 v[68:71], v[92:95], a[236:239], v[68:71]
  ds_read_b64_tr_b16 v[86:87], v137 offset:39264
  s_waitcnt vmcnt(15) lgkmcnt(4)
  v_mfma_f32_16x16x32_bf16 v[0:3], v[72:75], a[240:243], v[0:3]
  ds_read_b64_tr_b16 v[88:89], v137 offset:36992
  v_mfma_f32_16x16x32_bf16 v[4:7], v[72:75], a[244:247], v[4:7]
  ds_read_b64_tr_b16 v[90:91], v137 offset:39296
  v_mfma_f32_16x16x32_bf16 v[8:11], v[76:79], a[240:243], v[8:11]
  ds_read_b64_tr_b16 v[92:93], v137 offset:37024
  v_mfma_f32_16x16x32_bf16 v[12:15], v[76:79], a[244:247], v[12:15]
  ds_read_b64_tr_b16 v[94:95], v137 offset:39328
  s_waitcnt lgkmcnt(4)
  v_mfma_f32_16x16x32_bf16 v[16:19], v[80:83], a[240:243], v[16:19]
  ds_read_b64_tr_b16 v[72:73], v137 offset:37056
  v_mfma_f32_16x16x32_bf16 v[20:23], v[80:83], a[244:247], v[20:23]
  ds_read_b64_tr_b16 v[74:75], v137 offset:39360
  v_mfma_f32_16x16x32_bf16 v[24:27], v[84:87], a[240:243], v[24:27]
  ds_read_b64_tr_b16 v[76:77], v137 offset:37088
  v_mfma_f32_16x16x32_bf16 v[28:31], v[84:87], a[244:247], v[28:31]
  ds_read_b64_tr_b16 v[78:79], v137 offset:39392
  s_waitcnt lgkmcnt(4)
  v_mfma_f32_16x16x32_bf16 v[32:35], v[88:91], a[240:243], v[32:35]
  ds_read_b64_tr_b16 v[80:81], v137 offset:37120
  buffer_load_dwordx4 v[112:115], v140, s[20:23], s67 offen offset:2048 sc1
  v_mfma_f32_16x16x32_bf16 v[36:39], v[88:91], a[244:247], v[36:39]
  ds_read_b64_tr_b16 v[82:83], v137 offset:39424
  buffer_load_dwordx4 v[116:119], v151, s[20:23], s67 offen offset:2048 sc1
  v_mfma_f32_16x16x32_bf16 v[40:43], v[92:95], a[240:243], v[40:43]
  ds_read_b64_tr_b16 v[84:85], v137 offset:46080
  v_mfma_f32_16x16x32_bf16 v[44:47], v[92:95], a[244:247], v[44:47]
  ds_read_b64_tr_b16 v[86:87], v137 offset:48384
  s_waitcnt lgkmcnt(4)
  v_mfma_f32_16x16x32_bf16 v[48:51], v[72:75], a[240:243], v[48:51]
  ds_read_b64_tr_b16 v[88:89], v137 offset:46112
  v_mfma_f32_16x16x32_bf16 v[52:55], v[72:75], a[244:247], v[52:55]
  ds_read_b64_tr_b16 v[90:91], v137 offset:48416
  v_mfma_f32_16x16x32_bf16 v[56:59], v[76:79], a[240:243], v[56:59]
  ds_read_b64_tr_b16 v[92:93], v137 offset:46144
  v_mfma_f32_16x16x32_bf16 v[60:63], v[76:79], a[244:247], v[60:63]
  ds_read_b64_tr_b16 v[94:95], v137 offset:48448
  s_waitcnt lgkmcnt(4)
  v_mfma_f32_16x16x32_bf16 v[64:67], v[80:83], a[240:243], v[64:67]
  ds_read_b64_tr_b16 v[72:73], v137 offset:46176
  v_mfma_f32_16x16x32_bf16 v[68:71], v[80:83], a[244:247], v[68:71]
  ds_read_b64_tr_b16 v[74:75], v137 offset:48480
  s_waitcnt vmcnt(15)
  v_mfma_f32_16x16x32_bf16 v[0:3], v[84:87], a[248:251], v[0:3]
  ds_read_b64_tr_b16 v[76:77], v137 offset:46208
  v_mfma_f32_16x16x32_bf16 v[4:7], v[84:87], a[252:255], v[4:7]
  ds_read_b64_tr_b16 v[78:79], v137 offset:48512
  s_waitcnt lgkmcnt(4)
  v_mfma_f32_16x16x32_bf16 v[8:11], v[88:91], a[248:251], v[8:11]
  ds_read_b64_tr_b16 v[80:81], v137 offset:46240
  v_mfma_f32_16x16x32_bf16 v[12:15], v[88:91], a[252:255], v[12:15]
  ds_read_b64_tr_b16 v[82:83], v137 offset:48544
  v_mfma_f32_16x16x32_bf16 v[16:19], v[92:95], a[248:251], v[16:19]
  ds_read_b64_tr_b16 v[84:85], v137 offset:46272
  v_mfma_f32_16x16x32_bf16 v[20:23], v[92:95], a[252:255], v[20:23]
  ds_read_b64_tr_b16 v[86:87], v137 offset:48576
  s_waitcnt lgkmcnt(4)
  v_mfma_f32_16x16x32_bf16 v[24:27], v[72:75], a[248:251], v[24:27]
  ds_read_b64_tr_b16 v[88:89], v137 offset:46304
  v_mfma_f32_16x16x32_bf16 v[28:31], v[72:75], a[252:255], v[28:31]
  ds_read_b64_tr_b16 v[90:91], v137 offset:48608
  s_barrier
  v_mfma_f32_16x16x32_bf16 v[32:35], v[76:79], a[248:251], v[32:35]
  ds_read_b64_tr_b16 v[92:93], v137 offset:46336
  buffer_load_dwordx4 v[120:123], v140, s[20:23], s67 offen offset:3072 sc1
  v_mfma_f32_16x16x32_bf16 v[36:39], v[76:79], a[252:255], v[36:39]
  ds_read_b64_tr_b16 v[94:95], v137 offset:48640
  buffer_load_dwordx4 v[124:127], v151, s[20:23], s67 offen offset:3072 sc1
  s_waitcnt lgkmcnt(4)
  v_mfma_f32_16x16x32_bf16 v[40:43], v[80:83], a[248:251], v[40:43]
  ds_read_b64_tr_b16 v[72:73], v138 offset:0
  v_mfma_f32_16x16x32_bf16 v[44:47], v[80:83], a[252:255], v[44:47]
  ds_read_b64_tr_b16 v[74:75], v138 offset:2304
  v_mfma_f32_16x16x32_bf16 v[48:51], v[84:87], a[248:251], v[48:51]
  ds_read_b64_tr_b16 v[76:77], v138 offset:32
  v_mfma_f32_16x16x32_bf16 v[52:55], v[84:87], a[252:255], v[52:55]
  ds_read_b64_tr_b16 v[78:79], v138 offset:2336
  s_waitcnt lgkmcnt(4)
  v_mfma_f32_16x16x32_bf16 v[56:59], v[88:91], a[248:251], v[56:59]
  ds_read_b64_tr_b16 v[80:81], v138 offset:64
  v_mfma_f32_16x16x32_bf16 v[60:63], v[88:91], a[252:255], v[60:63]
  ds_read_b64_tr_b16 v[82:83], v138 offset:2368
  v_mfma_f32_16x16x32_bf16 v[64:67], v[92:95], a[248:251], v[64:67]
  ds_read_b64_tr_b16 v[84:85], v138 offset:96
  v_mfma_f32_16x16x32_bf16 v[68:71], v[92:95], a[252:255], v[68:71]
  ds_read_b64_tr_b16 v[86:87], v138 offset:2400
  s_waitcnt vmcnt(15) lgkmcnt(4)
  v_mfma_f32_16x16x32_bf16 v[0:3], v[72:75], v[96:99], v[0:3]
  ds_read_b64_tr_b16 v[88:89], v138 offset:128
  v_mfma_f32_16x16x32_bf16 v[4:7], v[72:75], v[100:103], v[4:7]
  ds_read_b64_tr_b16 v[90:91], v138 offset:2432
  v_mfma_f32_16x16x32_bf16 v[8:11], v[76:79], v[96:99], v[8:11]
  ds_read_b64_tr_b16 v[92:93], v138 offset:160
  v_mfma_f32_16x16x32_bf16 v[12:15], v[76:79], v[100:103], v[12:15]
  ds_read_b64_tr_b16 v[94:95], v138 offset:2464
  s_waitcnt lgkmcnt(4)
  v_mfma_f32_16x16x32_bf16 v[16:19], v[80:83], v[96:99], v[16:19]
  ds_read_b64_tr_b16 v[72:73], v138 offset:192
  v_mfma_f32_16x16x32_bf16 v[20:23], v[80:83], v[100:103], v[20:23]
  ds_read_b64_tr_b16 v[74:75], v138 offset:2496
  v_mfma_f32_16x16x32_bf16 v[24:27], v[84:87], v[96:99], v[24:27]
  ds_read_b64_tr_b16 v[76:77], v138 offset:224
  v_mfma_f32_16x16x32_bf16 v[28:31], v[84:87], v[100:103], v[28:31]
  ds_read_b64_tr_b16 v[78:79], v138 offset:2528
  s_waitcnt lgkmcnt(4)
  v_mfma_f32_16x16x32_bf16 v[32:35], v[88:91], v[96:99], v[32:35]
  ds_read_b64_tr_b16 v[80:81], v138 offset:256
  v_mfma_f32_16x16x32_bf16 v[36:39], v[88:91], v[100:103], v[36:39]
  ds_read_b64_tr_b16 v[82:83], v138 offset:2560
  v_mfma_f32_16x16x32_bf16 v[40:43], v[92:95], v[96:99], v[40:43]
  ds_read_b64_tr_b16 v[84:85], v138 offset:9216
  v_mfma_f32_16x16x32_bf16 v[44:47], v[92:95], v[100:103], v[44:47]
  ds_read_b64_tr_b16 v[86:87], v138 offset:11520
  s_waitcnt lgkmcnt(4)
  v_mfma_f32_16x16x32_bf16 v[48:51], v[72:75], v[96:99], v[48:51]
  ds_read_b64_tr_b16 v[88:89], v138 offset:9248
  v_mfma_f32_16x16x32_bf16 v[52:55], v[72:75], v[100:103], v[52:55]
  ds_read_b64_tr_b16 v[90:91], v138 offset:11552
  v_mfma_f32_16x16x32_bf16 v[56:59], v[76:79], v[96:99], v[56:59]
  ds_read_b64_tr_b16 v[92:93], v138 offset:9280
  v_mfma_f32_16x16x32_bf16 v[60:63], v[76:79], v[100:103], v[60:63]
  ds_read_b64_tr_b16 v[94:95], v138 offset:11584
  s_waitcnt lgkmcnt(4)
  v_mfma_f32_16x16x32_bf16 v[64:67], v[80:83], v[96:99], v[64:67]
  ds_read_b64_tr_b16 v[72:73], v138 offset:9312
  v_mfma_f32_16x16x32_bf16 v[68:71], v[80:83], v[100:103], v[68:71]
  ds_read_b64_tr_b16 v[74:75], v138 offset:11616
  s_waitcnt vmcnt(4)
  v_mfma_f32_16x16x32_bf16 v[0:3], v[84:87], v[104:107], v[0:3]
  ds_read_b64_tr_b16 v[76:77], v138 offset:9344
  v_mfma_f32_16x16x32_bf16 v[4:7], v[84:87], v[108:111], v[4:7]
  ds_read_b64_tr_b16 v[78:79], v138 offset:11648
  s_waitcnt lgkmcnt(4)
  v_mfma_f32_16x16x32_bf16 v[8:11], v[88:91], v[104:107], v[8:11]
  ds_read_b64_tr_b16 v[80:81], v138 offset:9376
  v_mfma_f32_16x16x32_bf16 v[12:15], v[88:91], v[108:111], v[12:15]
  ds_read_b64_tr_b16 v[82:83], v138 offset:11680
  v_mfma_f32_16x16x32_bf16 v[16:19], v[92:95], v[104:107], v[16:19]
  ds_read_b64_tr_b16 v[84:85], v138 offset:9408
  v_mfma_f32_16x16x32_bf16 v[20:23], v[92:95], v[108:111], v[20:23]
  ds_read_b64_tr_b16 v[86:87], v138 offset:11712
  s_waitcnt lgkmcnt(4)
  v_mfma_f32_16x16x32_bf16 v[24:27], v[72:75], v[104:107], v[24:27]
  ds_read_b64_tr_b16 v[88:89], v138 offset:9440
  v_mfma_f32_16x16x32_bf16 v[28:31], v[72:75], v[108:111], v[28:31]
  ds_read_b64_tr_b16 v[90:91], v138 offset:11744
  v_mfma_f32_16x16x32_bf16 v[32:35], v[76:79], v[104:107], v[32:35]
  ds_read_b64_tr_b16 v[92:93], v138 offset:9472
  v_mfma_f32_16x16x32_bf16 v[36:39], v[76:79], v[108:111], v[36:39]
  ds_read_b64_tr_b16 v[94:95], v138 offset:11776
  s_waitcnt lgkmcnt(4)
  v_mfma_f32_16x16x32_bf16 v[40:43], v[80:83], v[104:107], v[40:43]
  ds_read_b64_tr_b16 v[72:73], v138 offset:18432
  v_mfma_f32_16x16x32_bf16 v[44:47], v[80:83], v[108:111], v[44:47]
  ds_read_b64_tr_b16 v[74:75], v138 offset:20736
  v_mfma_f32_16x16x32_bf16 v[48:51], v[84:87], v[104:107], v[48:51]
  ds_read_b64_tr_b16 v[76:77], v138 offset:18464
  v_mfma_f32_16x16x32_bf16 v[52:55], v[84:87], v[108:111], v[52:55]
  ds_read_b64_tr_b16 v[78:79], v138 offset:20768
  s_waitcnt lgkmcnt(4)
  v_mfma_f32_16x16x32_bf16 v[56:59], v[88:91], v[104:107], v[56:59]
  ds_read_b64_tr_b16 v[80:81], v138 offset:18496
  v_mfma_f32_16x16x32_bf16 v[60:63], v[88:91], v[108:111], v[60:63]
  ds_read_b64_tr_b16 v[82:83], v138 offset:20800
  v_mfma_f32_16x16x32_bf16 v[64:67], v[92:95], v[104:107], v[64:67]
  ds_read_b64_tr_b16 v[84:85], v138 offset:18528
  v_mfma_f32_16x16x32_bf16 v[68:71], v[92:95], v[108:111], v[68:71]
  ds_read_b64_tr_b16 v[86:87], v138 offset:20832
  s_waitcnt vmcnt(2) lgkmcnt(4)
  v_mfma_f32_16x16x32_bf16 v[0:3], v[72:75], v[112:115], v[0:3]
  ds_read_b64_tr_b16 v[88:89], v138 offset:18560
  v_mfma_f32_16x16x32_bf16 v[4:7], v[72:75], v[116:119], v[4:7]
  ds_read_b64_tr_b16 v[90:91], v138 offset:20864
  v_mfma_f32_16x16x32_bf16 v[8:11], v[76:79], v[112:115], v[8:11]
  ds_read_b64_tr_b16 v[92:93], v138 offset:18592
  v_mfma_f32_16x16x32_bf16 v[12:15], v[76:79], v[116:119], v[12:15]
  ds_read_b64_tr_b16 v[94:95], v138 offset:20896
  s_waitcnt lgkmcnt(4)
  v_mfma_f32_16x16x32_bf16 v[16:19], v[80:83], v[112:115], v[16:19]
  ds_read_b64_tr_b16 v[72:73], v138 offset:18624
  v_mfma_f32_16x16x32_bf16 v[20:23], v[80:83], v[116:119], v[20:23]
  ds_read_b64_tr_b16 v[74:75], v138 offset:20928
  v_mfma_f32_16x16x32_bf16 v[24:27], v[84:87], v[112:115], v[24:27]
  ds_read_b64_tr_b16 v[76:77], v138 offset:18656
  v_mfma_f32_16x16x32_bf16 v[28:31], v[84:87], v[116:119], v[28:31]
  ds_read_b64_tr_b16 v[78:79], v138 offset:20960
  s_waitcnt lgkmcnt(4)
  v_mfma_f32_16x16x32_bf16 v[32:35], v[88:91], v[112:115], v[32:35]
  ds_read_b64_tr_b16 v[80:81], v138 offset:18688
  v_mfma_f32_16x16x32_bf16 v[36:39], v[88:91], v[116:119], v[36:39]
  ds_read_b64_tr_b16 v[82:83], v138 offset:20992
  v_mfma_f32_16x16x32_bf16 v[40:43], v[92:95], v[112:115], v[40:43]
  ds_read_b64_tr_b16 v[84:85], v138 offset:27648
  v_mfma_f32_16x16x32_bf16 v[44:47], v[92:95], v[116:119], v[44:47]
  ds_read_b64_tr_b16 v[86:87], v138 offset:29952
  s_waitcnt lgkmcnt(4)
  v_mfma_f32_16x16x32_bf16 v[48:51], v[72:75], v[112:115], v[48:51]
  ds_read_b64_tr_b16 v[88:89], v138 offset:27680
  v_mfma_f32_16x16x32_bf16 v[52:55], v[72:75], v[116:119], v[52:55]
  ds_read_b64_tr_b16 v[90:91], v138 offset:29984
  v_mfma_f32_16x16x32_bf16 v[56:59], v[76:79], v[112:115], v[56:59]
  ds_read_b64_tr_b16 v[92:93], v138 offset:27712
  v_mfma_f32_16x16x32_bf16 v[60:63], v[76:79], v[116:119], v[60:63]
  ds_read_b64_tr_b16 v[94:95], v138 offset:30016
  s_waitcnt lgkmcnt(4)
  v_mfma_f32_16x16x32_bf16 v[64:67], v[80:83], v[112:115], v[64:67]
  ds_read_b64_tr_b16 v[72:73], v138 offset:27744
  v_mfma_f32_16x16x32_bf16 v[68:71], v[80:83], v[116:119], v[68:71]
  ds_read_b64_tr_b16 v[74:75], v138 offset:30048
  s_waitcnt vmcnt(0)
  v_mfma_f32_16x16x32_bf16 v[0:3], v[84:87], v[120:123], v[0:3]
  ds_read_b64_tr_b16 v[76:77], v138 offset:27776
  v_mfma_f32_16x16x32_bf16 v[4:7], v[84:87], v[124:127], v[4:7]
  ds_read_b64_tr_b16 v[78:79], v138 offset:30080
  s_waitcnt lgkmcnt(4)
  v_mfma_f32_16x16x32_bf16 v[8:11], v[88:91], v[120:123], v[8:11]
  ds_read_b64_tr_b16 v[80:81], v138 offset:27808
  v_mfma_f32_16x16x32_bf16 v[12:15], v[88:91], v[124:127], v[12:15]
  ds_read_b64_tr_b16 v[82:83], v138 offset:30112
  v_mfma_f32_16x16x32_bf16 v[16:19], v[92:95], v[120:123], v[16:19]
  ds_read_b64_tr_b16 v[84:85], v138 offset:27840
  v_mfma_f32_16x16x32_bf16 v[20:23], v[92:95], v[124:127], v[20:23]
  ds_read_b64_tr_b16 v[86:87], v138 offset:30144
  s_waitcnt lgkmcnt(4)
  v_mfma_f32_16x16x32_bf16 v[24:27], v[72:75], v[120:123], v[24:27]
  ds_read_b64_tr_b16 v[88:89], v138 offset:27872
  v_cvt_pk_bf16_f32 v156, v0, v1
  v_cvt_pk_bf16_f32 v157, v2, v3
  v_mfma_f32_16x16x32_bf16 v[28:31], v[72:75], v[124:127], v[28:31]
  ds_read_b64_tr_b16 v[90:91], v138 offset:30176
  ds_write_b64 v154, v[156:157] offset:0
  v_cvt_pk_bf16_f32 v158, v4, v5
  v_mfma_f32_16x16x32_bf16 v[32:35], v[76:79], v[120:123], v[32:35]
  ds_read_b64_tr_b16 v[92:93], v138 offset:27904
  v_cvt_pk_bf16_f32 v159, v6, v7
  ds_write_b64 v154, v[158:159] offset:4864
  v_mfma_f32_16x16x32_bf16 v[36:39], v[76:79], v[124:127], v[36:39]
  ds_read_b64_tr_b16 v[94:95], v138 offset:30208
  v_cvt_pk_bf16_f32 v160, v8, v9
  v_cvt_pk_bf16_f32 v161, v10, v11
  s_waitcnt lgkmcnt(4)
  v_mfma_f32_16x16x32_bf16 v[40:43], v[80:83], v[120:123], v[40:43]
  ds_write_b64 v154, v[160:161] offset:32
  v_cvt_pk_bf16_f32 v162, v12, v13
  v_mfma_f32_16x16x32_bf16 v[44:47], v[80:83], v[124:127], v[44:47]
  v_cvt_pk_bf16_f32 v163, v14, v15
  ds_write_b64 v154, v[162:163] offset:4896
  v_mfma_f32_16x16x32_bf16 v[48:51], v[84:87], v[120:123], v[48:51]
  v_cvt_pk_bf16_f32 v156, v16, v17
  v_cvt_pk_bf16_f32 v157, v18, v19
  v_mfma_f32_16x16x32_bf16 v[52:55], v[84:87], v[124:127], v[52:55]
  ds_write_b64 v154, v[156:157] offset:64
  v_cvt_pk_bf16_f32 v158, v20, v21
  s_waitcnt lgkmcnt(0)
  v_mfma_f32_16x16x32_bf16 v[56:59], v[88:91], v[120:123], v[56:59]
  v_cvt_pk_bf16_f32 v159, v22, v23
  ds_write_b64 v154, v[158:159] offset:4928
  v_mfma_f32_16x16x32_bf16 v[60:63], v[88:91], v[124:127], v[60:63]
  v_cvt_pk_bf16_f32 v160, v24, v25
  v_cvt_pk_bf16_f32 v161, v26, v27
  v_mfma_f32_16x16x32_bf16 v[64:67], v[92:95], v[120:123], v[64:67]
  ds_write_b64 v154, v[160:161] offset:96
  v_cvt_pk_bf16_f32 v162, v28, v29
  v_mfma_f32_16x16x32_bf16 v[68:71], v[92:95], v[124:127], v[68:71]
  v_cvt_pk_bf16_f32 v163, v30, v31
  ds_write_b64 v154, v[162:163] offset:4960
  v_cvt_pk_bf16_f32 v156, v32, v33
  v_cvt_pk_bf16_f32 v157, v34, v35
  ds_write_b64 v154, v[156:157] offset:128
  v_cvt_pk_bf16_f32 v158, v36, v37
  v_cvt_pk_bf16_f32 v159, v38, v39
  ds_write_b64 v154, v[158:159] offset:4992
  v_cvt_pk_bf16_f32 v160, v40, v41
  v_cvt_pk_bf16_f32 v161, v42, v43
  ds_write_b64 v154, v[160:161] offset:160
  v_cvt_pk_bf16_f32 v162, v44, v45
  v_cvt_pk_bf16_f32 v163, v46, v47
  ds_write_b64 v154, v[162:163] offset:5024
  v_cvt_pk_bf16_f32 v156, v48, v49
  v_cvt_pk_bf16_f32 v157, v50, v51
  ds_write_b64 v154, v[156:157] offset:192
  v_cvt_pk_bf16_f32 v158, v52, v53
  v_cvt_pk_bf16_f32 v159, v54, v55
  ds_write_b64 v154, v[158:159] offset:5056
  v_cvt_pk_bf16_f32 v160, v56, v57
  v_cvt_pk_bf16_f32 v161, v58, v59
  ds_write_b64 v154, v[160:161] offset:224
  v_cvt_pk_bf16_f32 v162, v60, v61
  v_cvt_pk_bf16_f32 v163, v62, v63
  ds_write_b64 v154, v[162:163] offset:5088
  v_cvt_pk_bf16_f32 v156, v64, v65
  v_cvt_pk_bf16_f32 v157, v66, v67
  ds_write_b64 v154, v[156:157] offset:256
  v_cvt_pk_bf16_f32 v158, v68, v69
  v_cvt_pk_bf16_f32 v159, v70, v71
  ds_write_b64 v154, v[158:159] offset:5120
  s_waitcnt lgkmcnt(0)
  s_cmp_eq_u32 s38, s39
  s_cbranch_scc1 nopub_m_kernel
  ds_read_b128 v[0:3], v142
  ds_read_b128 v[4:7], v143
  ds_read_b128 v[8:11], v144
  ds_read_b128 v[12:15], v145
  ds_read_b128 v[16:19], v146
  ds_read_b128 v[20:23], v147
  ds_read_b128 v[24:27], v148
  ds_read_b128 v[28:31], v149
  ds_read_b128 v[32:35], v150
  s_waitcnt lgkmcnt(8)
  s_add_u32 s65, s66, 0
  buffer_store_dwordx4 v[0:3], v141, s[4:7], s65 offen sc1
  s_waitcnt lgkmcnt(7)
  s_add_u32 s65, s66, 1024
  buffer_store_dwordx4 v[4:7], v141, s[4:7], s65 offen sc1
  s_waitcnt lgkmcnt(6)
  s_add_u32 s65, s66, 2048
  buffer_store_dwordx4 v[8:11], v141, s[4:7], s65 offen sc1
  s_waitcnt lgkmcnt(5)
  s_add_u32 s65, s66, 3072
  buffer_store_dwordx4 v[12:15], v141, s[4:7], s65 offen sc1
  s_waitcnt lgkmcnt(4)
  s_add_u32 s65, s66, 4096
  buffer_store_dwordx4 v[16:19], v141, s[4:7], s65 offen sc1
  s_waitcnt lgkmcnt(3)
  s_add_u32 s65, s66, 5120
  buffer_store_dwordx4 v[20:23], v141, s[4:7], s65 offen sc1
  s_waitcnt lgkmcnt(2)
  s_add_u32 s65, s66, 6144
  buffer_store_dwordx4 v[24:27], v141, s[4:7], s65 offen sc1
  s_waitcnt lgkmcnt(1)
  s_add_u32 s65, s66, 7168
  buffer_store_dwordx4 v[28:31], v141, s[4:7], s65 offen sc1
  s_waitcnt lgkmcnt(0)
  s_add_u32 s65, s66, 8192
  buffer_store_dwordx4 v[32:35], v141, s[4:7], s65 offen sc1
nopub_m_kernel:
  s_waitcnt vmcnt(0)
  s_barrier
  s_cmp_lg_u32 s38, 0
  s_cbranch_scc1 handoff3_m_kernel
  s_lshl_b32 s46, s42, 2
  s_add_u32 s46, s46, s41
  s_lshl_b32 s46, s46, 7
  s_add_u32 s46, s46, 40960
  s_mov_b64 exec, 1
  v_mov_b32 v1, s46
  v_mov_b32 v2, 1
  global_atomic_add v1, v2, s[52:53]
  s_mov_b32 s47, 0
poll3_m_kernel:
  global_load_dword v2, v1, s[52:53] sc1
  s_waitcnt vmcnt(0)
  v_readfirstlane_b32 s46, v2
  s_add_u32 s47, s47, 1
  s_nop 0
  s_cmp_ge_u32 s46, 4
  s_cbranch_scc1 polled3_m_kernel
  s_sleep 1
  s_cmp_lt_u32 s47, 40000
  s_cbranch_scc1 poll3_m_kernel
polled3_m_kernel:
  s_mov_b64 exec, -1
handoff3_m_kernel:
  s_barrier
  s_lshl_b32 s46, s42, 2
  s_add_u32 s46, s46, s41
  s_lshl_b32 s46, s46, 2
  s_add_u32 s46, s46, s39
  s_mul_i32 s46, s46, 9216
  s_add_u32 s47, s39, 1
  s_and_b32 s47, s47, 3
  s_mul_i32 s47, s47, 2359296
  s_add_u32 s48, s46, s47
  s_add_u32 s47, s39, 2
  s_and_b32 s47, s47, 3
  s_mul_i32 s47, s47, 2359296
  s_add_u32 s49, s46, s47
  s_add_u32 s47, s39, 3
  s_and_b32 s47, s47, 3
  s_mul_i32 s47, s47, 2359296
  s_add_u32 s50, s46, s47
  buffer_load_dwordx4 v[0:3], v180, s[4:7], s48 offen sc1
  buffer_load_dwordx4 v[4:7], v180, s[4:7], s49 offen sc1
  buffer_load_dwordx4 v[8:11], v180, s[4:7], s50 offen sc1
  s_add_u32 s47, s48, 4096
  buffer_load_dwordx4 v[12:15], v180, s[4:7], s47 offen sc1
  s_add_u32 s47, s49, 4096
  buffer_load_dwordx4 v[16:19], v180, s[4:7], s47 offen sc1
  s_add_u32 s47, s50, 4096
  buffer_load_dwordx4 v[20:23], v180, s[4:7], s47 offen sc1
  buffer_load_dwordx4 v[24:27], v181, s[4:7], s48 offen sc1
  buffer_load_dwordx4 v[28:31], v181, s[4:7], s49 offen sc1
  buffer_load_dwordx4 v[32:35], v181, s[4:7], s50 offen sc1
  ds_read_b128 v[36:39], v164
  ds_read_b128 v[40:43], v165
  ds_read_b128 v[44:47], v166
  s_waitcnt lgkmcnt(0)
  s_waitcnt vmcnt(6)
  v_lshlrev_b32 v48, 16, v36
  v_and_b32 v49, 0xffff0000, v36
  v_lshlrev_b32 v50, 16, v37
  v_and_b32 v51, 0xffff0000, v37
  v_lshlrev_b32 v52, 16, v38
  v_and_b32 v53, 0xffff0000, v38
  v_lshlrev_b32 v54, 16, v39
  v_and_b32 v55, 0xffff0000, v39
  v_lshlrev_b32 v56, 16, v0
  v_and_b32 v57, 0xffff0000, v0
  v_lshlrev_b32 v58, 16, v1
  v_and_b32 v59, 0xffff0000, v1
  v_lshlrev_b32 v60, 16, v2
  v_and_b32 v61, 0xffff0000, v2
  v_lshlrev_b32 v62, 16, v3
  v_and_b32 v63, 0xffff0000, v3
  v_pk_add_f32 v[48:49], v[48:49], v[56:57]
  v_pk_add_f32 v[50:51], v[50:51], v[58:59]
  v_pk_add_f32 v[52:53], v[52:53], v[60:61]
  v_pk_add_f32 v[54:55], v[54:55], v[62:63]
  v_lshlrev_b32 v56, 16, v4
  v_and_b32 v57, 0xffff0000, v4
  v_lshlrev_b32 v58, 16, v5
  v_and_b32 v59, 0xffff0000, v5
  v_lshlrev_b32 v60, 16, v6
  v_and_b32 v61, 0xffff0000, v6
  v_lshlrev_b32 v62, 16, v7
  v_and_b32 v63, 0xffff0000, v7
  v_pk_add_f32 v[48:49], v[48:49], v[56:57]
  v_pk_add_f32 v[50:51], v[50:51], v[58:59]
  v_pk_add_f32 v[52:53], v[52:53], v[60:61]
  v_pk_add_f32 v[54:55], v[54:55], v[62:63]
  v_lshlrev_b32 v56, 16, v8
  v_and_b32 v57, 0xffff0000, v8
  v_lshlrev_b32 v58, 16, v9
  v_and_b32 v59, 0xffff0000, v9
  v_lshlrev_b32 v60, 16, v10
  v_and_b32 v61, 0xffff0000, v10
  v_lshlrev_b32 v62, 16, v11
  v_and_b32 v63, 0xffff0000, v11
  v_pk_add_f32 v[48:49], v[48:49], v[56:57]
  v_pk_add_f32 v[50:51], v[50:51], v[58:59]
  v_pk_add_f32 v[52:53], v[52:53], v[60:61]
  v_pk_add_f32 v[54:55], v[54:55], v[62:63]
  v_lshlrev_b32 v56, 16, v184
  v_and_b32 v57, 0xffff0000, v184
  v_lshlrev_b32 v58, 16, v185
  v_and_b32 v59, 0xffff0000, v185
  v_lshlrev_b32 v60, 16, v186
  v_and_b32 v61, 0xffff0000, v186
  v_lshlrev_b32 v62, 16, v187
  v_and_b32 v63, 0xffff0000, v187
  v_pk_fma_f32 v[56:57], v[48:49], v[196:197], v[56:57]
  v_pk_fma_f32 v[58:59], v[50:51], v[198:199], v[58:59]
  v_pk_fma_f32 v[60:61], v[52:53], v[200:201], v[60:61]
  v_pk_fma_f32 v[62:63], v[54:55], v[202:203], v[62:63]
  v_cvt_pk_bf16_f32 v64, v56, v57
  v_cvt_pk_bf16_f32 v65, v58, v59
  v_cvt_pk_bf16_f32 v66, v60, v61
  v_cvt_pk_bf16_f32 v67, v62, v63
  buffer_store_dwordx4 v[64:67], v167, s[12:15], 0 offen
  s_waitcnt vmcnt(4)
  v_lshlrev_b32 v48, 16, v40
  v_and_b32 v49, 0xffff0000, v40
  v_lshlrev_b32 v50, 16, v41
  v_and_b32 v51, 0xffff0000, v41
  v_lshlrev_b32 v52, 16, v42
  v_and_b32 v53, 0xffff0000, v42
  v_lshlrev_b32 v54, 16, v43
  v_and_b32 v55, 0xffff0000, v43
  v_lshlrev_b32 v56, 16, v12
  v_and_b32 v57, 0xffff0000, v12
  v_lshlrev_b32 v58, 16, v13
  v_and_b32 v59, 0xffff0000, v13
  v_lshlrev_b32 v60, 16, v14
  v_and_b32 v61, 0xffff0000, v14
  v_lshlrev_b32 v62, 16, v15
  v_and_b32 v63, 0xffff0000, v15
  v_pk_add_f32 v[48:49], v[48:49], v[56:57]
  v_pk_add_f32 v[50:51], v[50:51], v[58:59]
  v_pk_add_f32 v[52:53], v[52:53], v[60:61]
  v_pk_add_f32 v[54:55], v[54:55], v[62:63]
  v_lshlrev_b32 v56, 16, v16
  v_and_b32 v57, 0xffff0000, v16
  v_lshlrev_b32 v58, 16, v17
  v_and_b32 v59, 0xffff0000, v17
  v_lshlrev_b32 v60, 16, v18
  v_and_b32 v61, 0xffff0000, v18
  v_lshlrev_b32 v62, 16, v19
  v_and_b32 v63, 0xffff0000, v19
  v_pk_add_f32 v[48:49], v[48:49], v[56:57]
  v_pk_add_f32 v[50:51], v[50:51], v[58:59]
  v_pk_add_f32 v[52:53], v[52:53], v[60:61]
  v_pk_add_f32 v[54:55], v[54:55], v[62:63]
  v_lshlrev_b32 v56, 16, v20
  v_and_b32 v57, 0xffff0000, v20
  v_lshlrev_b32 v58, 16, v21
  v_and_b32 v59, 0xffff0000, v21
  v_lshlrev_b32 v60, 16, v22
  v_and_b32 v61, 0xffff0000, v22
  v_lshlrev_b32 v62, 16, v23
  v_and_b32 v63, 0xffff0000, v23
  v_pk_add_f32 v[48:49], v[48:49], v[56:57]
  v_pk_add_f32 v[50:51], v[50:51], v[58:59]
  v_pk_add_f32 v[52:53], v[52:53], v[60:61]
  v_pk_add_f32 v[54:55], v[54:55], v[62:63]
  v_lshlrev_b32 v56, 16, v188
  v_and_b32 v57, 0xffff0000, v188
  v_lshlrev_b32 v58, 16, v189
  v_and_b32 v59, 0xffff0000, v189
  v_lshlrev_b32 v60, 16, v190
  v_and_b32 v61, 0xffff0000, v190
  v_lshlrev_b32 v62, 16, v191
  v_and_b32 v63, 0xffff0000, v191
  v_pk_fma_f32 v[56:57], v[48:49], v[204:205], v[56:57]
  v_pk_fma_f32 v[58:59], v[50:51], v[206:207], v[58:59]
  v_pk_fma_f32 v[60:61], v[52:53], v[208:209], v[60:61]
  v_pk_fma_f32 v[62:63], v[54:55], v[210:211], v[62:63]
  v_cvt_pk_bf16_f32 v68, v56, v57
  v_cvt_pk_bf16_f32 v69, v58, v59
  v_cvt_pk_bf16_f32 v70, v60, v61
  v_cvt_pk_bf16_f32 v71, v62, v63
  buffer_store_dwordx4 v[68:71], v168, s[12:15], 0 offen
  s_waitcnt vmcnt(2)
  v_lshlrev_b32 v48, 16, v44
  v_and_b32 v49, 0xffff0000, v44
  v_lshlrev_b32 v50, 16, v45
  v_and_b32 v51, 0xffff0000, v45
  v_lshlrev_b32 v52, 16, v46
  v_and_b32 v53, 0xffff0000, v46
  v_lshlrev_b32 v54, 16, v47
  v_and_b32 v55, 0xffff0000, v47
  v_lshlrev_b32 v56, 16, v24
  v_and_b32 v57, 0xffff0000, v24
  v_lshlrev_b32 v58, 16, v25
  v_and_b32 v59, 0xffff0000, v25
  v_lshlrev_b32 v60, 16, v26
  v_and_b32 v61, 0xffff0000, v26
  v_lshlrev_b32 v62, 16, v27
  v_and_b32 v63, 0xffff0000, v27
  v_pk_add_f32 v[48:49], v[48:49], v[56:57]
  v_pk_add_f32 v[50:51], v[50:51], v[58:59]
  v_pk_add_f32 v[52:53], v[52:53], v[60:61]
  v_pk_add_f32 v[54:55], v[54:55], v[62:63]
  v_lshlrev_b32 v56, 16, v28
  v_and_b32 v57, 0xffff0000, v28
  v_lshlrev_b32 v58, 16, v29
  v_and_b32 v59, 0xffff0000, v29
  v_lshlrev_b32 v60, 16, v30
  v_and_b32 v61, 0xffff0000, v30
  v_lshlrev_b32 v62, 16, v31
  v_and_b32 v63, 0xffff0000, v31
  v_pk_add_f32 v[48:49], v[48:49], v[56:57]
  v_pk_add_f32 v[50:51], v[50:51], v[58:59]
  v_pk_add_f32 v[52:53], v[52:53], v[60:61]
  v_pk_add_f32 v[54:55], v[54:55], v[62:63]
  v_lshlrev_b32 v56, 16, v32
  v_and_b32 v57, 0xffff0000, v32
  v_lshlrev_b32 v58, 16, v33
  v_and_b32 v59, 0xffff0000, v33
  v_lshlrev_b32 v60, 16, v34
  v_and_b32 v61, 0xffff0000, v34
  v_lshlrev_b32 v62, 16, v35
  v_and_b32 v63, 0xffff0000, v35
  v_pk_add_f32 v[48:49], v[48:49], v[56:57]
  v_pk_add_f32 v[50:51], v[50:51], v[58:59]
  v_pk_add_f32 v[52:53], v[52:53], v[60:61]
  v_pk_add_f32 v[54:55], v[54:55], v[62:63]
  v_lshlrev_b32 v56, 16, v192
  v_and_b32 v57, 0xffff0000, v192
  v_lshlrev_b32 v58, 16, v193
  v_and_b32 v59, 0xffff0000, v193
  v_lshlrev_b32 v60, 16, v194
  v_and_b32 v61, 0xffff0000, v194
  v_lshlrev_b32 v62, 16, v195
  v_and_b32 v63, 0xffff0000, v195
  v_pk_fma_f32 v[56:57], v[48:49], v[218:219], v[56:57]
  v_pk_fma_f32 v[58:59], v[50:51], v[220:221], v[58:59]
  v_pk_fma_f32 v[60:61], v[52:53], v[222:223], v[60:61]
  v_pk_fma_f32 v[62:63], v[54:55], v[224:225], v[62:63]
  v_cvt_pk_bf16_f32 v72, v56, v57
  v_cvt_pk_bf16_f32 v73, v58, v59
  v_cvt_pk_bf16_f32 v74, v60, v61
  v_cvt_pk_bf16_f32 v75, v62, v63
  buffer_store_dwordx4 v[72:75], v169, s[12:15], 0 offen
end_m_kernel:
  s_endpgm
m_kernel_codeend:
.section .rodata,"a"
.p2align 6
.amdhsa_kernel m_kernel
  .amdhsa_next_free_vgpr 512
  .amdhsa_next_free_sgpr 80
  .amdhsa_accum_offset 256
  .amdhsa_group_segment_fixed_size 0
  .amdhsa_kernarg_size 120
  .amdhsa_user_sgpr_count 2
  .amdhsa_user_sgpr_kernarg_segment_ptr 1
  .amdhsa_system_sgpr_workgroup_id_x 1
  .amdhsa_float_denorm_mode_32 3
.end_amdhsa_kernel
.text
```
